```python
import torch

def _softmax(x, axis=-1):
    return torch.softmax(x, dim=axis)
def _gelu(x):
    return torch.nn.functional.gelu(x, approximate="tanh")
def _silu(x):
    return torch.nn.functional.silu(x)
def _sigmoid(x):
    return torch.sigmoid(x)
def _layernorm(x, axis=-1, eps=1e-5):
    m = x.mean(dim=axis, keepdim=True)
    v = x.var(dim=axis, keepdim=True, unbiased=False)
    return (x - m) / torch.sqrt(v + eps)
def _scatter_add(tgt, idx, src, axis=0):
    return tgt.clone().index_add_(axis, idx, src)
def _segment_sum(src, seg, n):
    out = torch.zeros((n,) + src.shape[1:], dtype=src.dtype)
    return out.index_add_(0, seg, src)
def _pad(x, pw):
    flat = tuple(v for pair in reversed(pw) for v in pair)
    return torch.nn.functional.pad(x, flat)

kernel_name = 'concat_heads__linear_kernel_hedgehog__ssm_conv_s5__prompt'

def setup_inputs():

    _w = (lambda a: (lambda t: t.to(torch.bfloat16) if t.is_floating_point() else t)(torch.as_tensor(a)))
    def _A_setup():
        B, S, D, H = 1, 2048, 1024, 32
        Dh = D // H
        return {
            "x": _w((lambda *s: torch.randn(*s, dtype=torch.bfloat16) * 0.4)(B, S, D)),
            "wqkv": _w((lambda *s: torch.randn(*s, dtype=torch.bfloat16) * 0.4)(D, 3 * D)),
            "w_phi": _w((lambda *s: torch.randn(*s, dtype=torch.bfloat16) * 0.4)(H, Dh, Dh) * (Dh ** -0.5)),
            "wo": _w((lambda *s: torch.randn(*s, dtype=torch.bfloat16) * 0.05)(D, D)),
        }
    _A_in = _A_setup()

    def _B_setup():
        B, S, D = 1, 2048, 1024
        P = D
        Lambda_re = -0.5 * (lambda _x: torch.exp(torch.as_tensor(_x)))((lambda *s: torch.randn(*s, dtype=torch.bfloat16) * 0.8)(P))
        Lambda_im = (lambda *s: torch.randn(*s, dtype=torch.bfloat16) * 0.8)(P) * 1.0
        B_re = (lambda *s: torch.randn(*s, dtype=torch.bfloat16) * 0.8)(P, D) * (D ** -0.5)
        B_im = (lambda *s: torch.randn(*s, dtype=torch.bfloat16) * 0.8)(P, D) * (D ** -0.5)
        C_re = (lambda *s: torch.randn(*s, dtype=torch.bfloat16) * 0.8)(D, P) * (P ** -0.5)
        C_im = (lambda *s: torch.randn(*s, dtype=torch.bfloat16) * 0.8)(D, P) * (P ** -0.5)
        log_dt = (lambda *s: torch.randn(*s, dtype=torch.bfloat16) * 0.8)(P) * 0.3 - 2.0
        Dskip = (lambda *s: torch.randn(*s, dtype=torch.bfloat16) * 0.8)(D)
        return {
            "x": _w((lambda *s: torch.randn(*s, dtype=torch.bfloat16) * 0.05)(B, S, D)),
            "Lambda_re": _w(Lambda_re),
            "Lambda_im": _w(Lambda_im),
            "B_re": _w(B_re),
            "B_im": _w(B_im),
            "C_re": _w(C_re),
            "C_im": _w(C_im),
            "log_dt": _w(log_dt),
            "Dskip": _w(Dskip),
        }
    _B_in = _B_setup()

    return {
        "A_x": _A_in["x"],
        "A_wqkv": _A_in["wqkv"],
        "A_w_phi": _A_in["w_phi"],
        "A_wo": _A_in["wo"],
        "B_x": _B_in["x"],
        "B_Lambda_re": _B_in["Lambda_re"],
        "B_Lambda_im": _B_in["Lambda_im"],
        "B_B_re": _B_in["B_re"],
        "B_B_im": _B_in["B_im"],
        "B_C_re": _B_in["C_re"],
        "B_C_im": _B_in["C_im"],
        "B_log_dt": _B_in["log_dt"],
        "B_Dskip": _B_in["Dskip"],
    }

def reference(A_x, A_wqkv, A_w_phi, A_wo, B_x, B_Lambda_re, B_Lambda_im, B_B_re, B_B_im, B_C_re, B_C_im, B_log_dt, B_Dskip):
    def _A_ref(x, wqkv, w_phi, wo):
        B, S, D = x.shape
        H = 32; Dh = D // H
        qkv = (lambda x, *d: x.permute(*d))((x @ wqkv).reshape(B, S, 3, H, Dh), 2, 0, 3, 1, 4)
        q, k, v = qkv[0], qkv[1], qkv[2]
        pq = torch.einsum("bhsd,hdf->bhsf", q, w_phi)
        pk = torch.einsum("bhsd,hdf->bhsf", k, w_phi)
        phi_q = torch.concatenate([_softmax(pq, axis=-1), _softmax(-pq, axis=-1)], axis=-1)
        phi_k = torch.concatenate([_softmax(pk, axis=-1), _softmax(-pk, axis=-1)], axis=-1)
        kv = torch.einsum("bhsf,bhsd->bhfd", phi_k, v)
        z  = torch.einsum("bhsf->bhf", phi_k)
        num = torch.einsum("bhqf,bhfd->bhqd", phi_q, kv)
        den = torch.einsum("bhqf,bhf->bhq", phi_q, z)[..., None] + 1e-6
        o = num / den
        return (lambda x, *d: x.permute(*d))(o, 0, 2, 1, 3).reshape(B, S, D) @ wo

    def _B_ref(x, Lambda_re, Lambda_im, B_re, B_im, C_re, C_im, log_dt, Dskip):
        Bsz, L, H = x.shape
        Lam = Lambda_re + 1j * Lambda_im
        Bmat = B_re + 1j * B_im
        Cmat = C_re + 1j * C_im
        dt = torch.exp(log_dt)
        Lam_bar = torch.exp(dt * Lam)
        B_bar = ((Lam_bar - 1.0) / Lam)[:, None] * Bmat
        Bu = torch.einsum("bld,pd->blp", x + 0j, B_bar)
        h = torch.zeros_like(Bu[:, 0, :])
        hs = []
        for t in range(L):
            h = Lam_bar[None, :] * h + Bu[:, t, :]
            hs.append(h)
        hseq = torch.stack(hs, 1)
        y = 2.0 * torch.einsum("blp,dp->bld", hseq, Cmat).real + x * Dskip[None, None, :]
        return y

    a = _A_ref(A_x, A_wqkv, A_w_phi, A_wo)
    b = _B_ref(B_x, B_Lambda_re, B_Lambda_im, B_B_re, B_B_im, B_C_re, B_C_im, B_log_dt, B_Dskip)
    return torch.concatenate([a, b], axis=-1)
```

```asm
; @launch grid=(256,1,1) block=(512,1,1) lds=147456
.amdgcn_target "amdgcn-amd-amdhsa--gfx950"
.text
.globl concat_heads__linear_kernel_hedgehog__ssm_conv_s5__prompt_kernel
.p2align 8
.type concat_heads__linear_kernel_hedgehog__ssm_conv_s5__prompt_kernel,@function
concat_heads__linear_kernel_hedgehog__ssm_conv_s5__prompt_kernel:
    s_cmp_ge_u32 s2, 256
    s_cbranch_scc1 concat_heads__linear_kernel_hedgehog__ssm_conv_s5__prompt_kernel_exit
    s_load_dwordx16 s[16:31], s[0:1], 0
    s_load_dwordx16 s[32:47], s[0:1], 64
    v_and_b32 v1, 63, v0
    v_and_b32 v2, 31, v0
    v_bfe_u32 v3, v0, 5, 1
    v_lshrrev_b32 v4, 6, v0
    s_nop 0
    v_readfirstlane_b32 s64, v4
    s_and_b32 s3, s2, 7
    s_lshr_b32 s4, s2, 3
    s_and_b32 s5, s4, 3
    s_and_b32 s6, s3, 1
    s_lshl_b32 s6, s6, 2
    s_add_u32 s74, s6, s5
    s_bfe_u32 s5, s4, 0x20002
    s_lshr_b32 s6, s3, 1
    s_lshl_b32 s6, s6, 2
    s_add_u32 s75, s6, s5
    s_lshr_b32 s76, s64, 1
    s_and_b32 s77, s64, 1
    s_lshl_b32 s72, s64, 13
    s_add_u32 s73, s72, 4096
    s_lshl_b32 s5, s3, 1
    s_bfe_u32 s6, s4, 0x10004
    s_add_u32 s7, s5, s6
    s_mov_b32 s3, s7
    s_mov_b32 s8, 0x3fb8aa3b
    s_mov_b32 s9, 0x3fb8aa3b
    s_lshl_b32 s69, s76, 13
    v_bfe_u32 v4, v1, 1, 3
    v_and_b32 v5, 15, v1
    v_lshlrev_b32 v5, 7, v5
    v_add_u32 v5, s69, v5
    v_lshrrev_b32 v8, 4, v1
    v_xor_b32 v8, v8, v4
    v_lshl_add_u32 v8, v8, 4, v5
    v_lshrrev_b32 v9, 4, v1
    v_or_b32 v9, 4, v9
    v_xor_b32 v9, v9, v4
    v_lshl_add_u32 v9, v9, 4, v5
    s_waitcnt lgkmcnt(0)
    s_bitcmp1_b32 s4, 4
    s_cbranch_scc1 k1_B
    s_mov_b32 s56, s20
    s_and_b32 s57, s21, 0xffff
    s_mov_b32 s58, 0x10000
    s_mov_b32 s59, 0x00020000
    s_lshl_b32 s10, s75, 1
    s_add_u32 s10, s10, s77
    v_lshlrev_b32 v4, 9, v3
    v_lshl_add_u32 v4, v2, 1, v4
    s_lshl_b32 s5, s10, 11
    buffer_load_ushort v48, v4, s[56:59], s5 offen offset:0
    buffer_load_ushort v49, v4, s[56:59], s5 offen offset:64
    buffer_load_ushort v50, v4, s[56:59], s5 offen offset:128
    buffer_load_ushort v51, v4, s[56:59], s5 offen offset:192
    buffer_load_ushort v52, v4, s[56:59], s5 offen offset:256
    buffer_load_ushort v53, v4, s[56:59], s5 offen offset:320
    buffer_load_ushort v54, v4, s[56:59], s5 offen offset:384
    buffer_load_ushort v55, v4, s[56:59], s5 offen offset:448
    buffer_load_ushort v56, v4, s[56:59], s5 offen offset:1024
    buffer_load_ushort v57, v4, s[56:59], s5 offen offset:1088
    buffer_load_ushort v58, v4, s[56:59], s5 offen offset:1152
    buffer_load_ushort v59, v4, s[56:59], s5 offen offset:1216
    buffer_load_ushort v60, v4, s[56:59], s5 offen offset:1280
    buffer_load_ushort v61, v4, s[56:59], s5 offen offset:1344
    buffer_load_ushort v62, v4, s[56:59], s5 offen offset:1408
    buffer_load_ushort v63, v4, s[56:59], s5 offen offset:1472
    s_mov_b32 s48, s16
    s_and_b32 s49, s17, 0xffff
    s_mov_b32 s50, 0x400000
    s_mov_b32 s51, 0x00020000
    s_mov_b32 s52, s18
    s_and_b32 s53, s19, 0xffff
    s_mov_b32 s54, 0x600000
    s_mov_b32 s55, 0x00020000
    s_and_b32 s4, s64, 3
    s_lshl_b32 s5, s74, 8
    s_lshl_b32 s6, s4, 6
    s_add_u32 s6, s5, s6
    v_lshrrev_b32 v4, 3, v1
    v_add_u32 v4, s6, v4
    v_lshlrev_b32 v4, 11, v4
    v_lshrrev_b32 v5, 4, v1
    v_and_b32 v6, 7, v1
    v_xor_b32 v5, v5, v6
    v_xor_b32 v6, 0, v5
    v_lshl_add_u32 v13, v6, 4, v4
    v_xor_b32 v6, 4, v5
    v_lshl_add_u32 v14, v6, 4, v4
    v_add_u32 v14, 0x3c00, v14
    v_xor_b32 v6, 0, v5
    v_lshl_add_u32 v15, v6, 4, v4
    v_add_u32 v15, 0x7800, v15
    v_xor_b32 v6, 4, v5
    v_lshl_add_u32 v16, v6, 4, v4
    v_add_u32 v16, 0xb400, v16
    v_xor_b32 v6, 0, v5
    v_lshl_add_u32 v17, v6, 4, v4
    v_add_u32 v17, 0x10000, v17
    v_xor_b32 v6, 4, v5
    v_lshl_add_u32 v18, v6, 4, v4
    v_add_u32 v18, 0x13c00, v18
    v_xor_b32 v6, 0, v5
    v_lshl_add_u32 v19, v6, 4, v4
    v_add_u32 v19, 0x17800, v19
    v_xor_b32 v6, 4, v5
    v_lshl_add_u32 v20, v6, 4, v4
    v_add_u32 v20, 0x1b400, v20
    s_lshl_b32 s70, s7, 7
    s_and_b32 s4, s64, 3
    v_lshrrev_b32 v4, 3, v1
    v_mul_u32_u24 v4, 6144, v4
    v_bfe_u32 v5, v1, 4, 1
    v_lshlrev_b32 v5, 1, v5
    v_and_b32 v6, 7, v1
    v_xor_b32 v5, v5, v6
    v_lshl_add_u32 v4, v5, 4, v4
    v_xor_b32 v5, 64, v4
    s_mul_i32 s4, s4, 6
    s_lshl_b32 s66, s4, 10
    s_add_u32 s66, s66, 65536
    s_add_u32 s78, s66, 4096
    s_add_u32 s5, s4, 0
    s_lshr_b32 s6, s5, 3
    s_and_b32 s5, s5, 7
    s_mul_i32 s5, s5, 49152
    s_lshl_b32 s6, s6, 11
    s_add_u32 s5, s5, s6
    s_lshl_b32 s6, s75, 7
    s_add_u32 s5, s5, s6
    v_add_u32 v224, s5, v4
    s_add_u32 s5, s4, 1
    s_lshr_b32 s6, s5, 3
    s_and_b32 s5, s5, 7
    s_mul_i32 s5, s5, 49152
    s_lshl_b32 s6, s6, 11
    s_add_u32 s5, s5, s6
    s_lshl_b32 s6, s75, 7
    s_add_u32 s5, s5, s6
    s_sub_u32 s5, s5, 1024
    v_add_u32 v225, s5, v5
    s_add_u32 s5, s4, 2
    s_lshr_b32 s6, s5, 3
    s_and_b32 s5, s5, 7
    s_mul_i32 s5, s5, 49152
    s_lshl_b32 s6, s6, 11
    s_add_u32 s5, s5, s6
    s_lshl_b32 s6, s75, 7
    s_add_u32 s5, s5, s6
    s_sub_u32 s5, s5, 2048
    v_add_u32 v226, s5, v4
    s_add_u32 s5, s4, 3
    s_lshr_b32 s6, s5, 3
    s_and_b32 s5, s5, 7
    s_mul_i32 s5, s5, 49152
    s_lshl_b32 s6, s6, 11
    s_add_u32 s5, s5, s6
    s_lshl_b32 s6, s75, 7
    s_add_u32 s5, s5, s6
    s_sub_u32 s5, s5, 3072
    v_add_u32 v227, s5, v5
    s_add_u32 s5, s4, 4
    s_lshr_b32 s6, s5, 3
    s_and_b32 s5, s5, 7
    s_mul_i32 s5, s5, 49152
    s_lshl_b32 s6, s6, 11
    s_add_u32 s5, s5, s6
    s_lshl_b32 s6, s75, 7
    s_add_u32 s5, s5, s6
    v_add_u32 v228, s5, v4
    s_add_u32 s5, s4, 5
    s_lshr_b32 s6, s5, 3
    s_and_b32 s5, s5, 7
    s_mul_i32 s5, s5, 49152
    s_lshl_b32 s6, s6, 11
    s_add_u32 s5, s5, s6
    s_lshl_b32 s6, s75, 7
    s_add_u32 s5, s5, s6
    s_sub_u32 s5, s5, 1024
    v_add_u32 v229, s5, v5
    s_mov_b32 s7, s3
    s_add_u32 s5, s7, 0
    s_and_b32 s5, s5, 15
    s_mul_i32 s71, s5, 0x60000
    s_mov_b32 s11, 0x60000
    s_mov_b32 s15, 0x600000
    s_mov_b32 s69, 0
    s_lshl_b32 s5, s77, 6
    v_lshrrev_b32 v4, 4, v1
    v_lshlrev_b32 v12, 10, v4
    v_bfe_u32 v4, v1, 2, 2
    v_lshl_add_u32 v12, v4, 7, v12
    v_bfe_u32 v4, v1, 3, 2
    v_lshl_add_u32 v12, v4, 5, v12
    v_and_b32 v4, 3, v1
    v_lshl_add_u32 v12, v4, 3, v12
    v_xor_b32 v12, s5, v12
    v_add_u32 v12, s69, v12
    v_add_u32 v12, 0x10000, v12
    v_xor_b32 v10, 32, v12
    s_cmp_ge_u32 s64, 4
    s_cbranch_scc1 k1a_r1
    s_mov_b32 m0, s72
    s_add_u32 s72, s72, 0x8000
    buffer_load_dwordx4 v13, s[48:51], s70 offen offset:0 lds
    buffer_load_dwordx4 v14, s[48:51], s70 offen offset:1024 lds
    buffer_load_dwordx4 v15, s[48:51], s70 offen offset:2048 lds
    buffer_load_dwordx4 v16, s[48:51], s70 offen offset:3072 lds
    s_mov_b32 m0, s73
    s_add_u32 s73, s73, 0x8000
    buffer_load_dwordx4 v17, s[48:51], s70 offen offset:0 lds
    buffer_load_dwordx4 v18, s[48:51], s70 offen offset:1024 lds
    buffer_load_dwordx4 v19, s[48:51], s70 offen offset:2048 lds
    buffer_load_dwordx4 v20, s[48:51], s70 offen offset:3072 lds
    s_add_u32 s70, s70, 128
    s_and_b32 s70, s70, 0x7ff
    s_mov_b32 m0, s66
    s_add_u32 s66, s66, 0x6000
    buffer_load_dwordx4 v224, s[52:55], s71 offen offset:0 lds
    buffer_load_dwordx4 v225, s[52:55], s71 offen offset:1024 lds
    buffer_load_dwordx4 v226, s[52:55], s71 offen offset:2048 lds
    buffer_load_dwordx4 v227, s[52:55], s71 offen offset:3072 lds
    s_mov_b32 m0, s78
    s_add_u32 s78, s78, 0x6000
    buffer_load_dwordx4 v228, s[52:55], s71 offen offset:0 lds
    buffer_load_dwordx4 v229, s[52:55], s71 offen offset:1024 lds
    s_add_u32 s71, s71, s11
    s_cmp_eq_u32 s71, s15
    s_cselect_b32 s71, 0, s71
    s_mov_b32 m0, s72
    s_add_u32 s72, s72, 0xffff8000
    buffer_load_dwordx4 v13, s[48:51], s70 offen offset:0 lds
    buffer_load_dwordx4 v14, s[48:51], s70 offen offset:1024 lds
    buffer_load_dwordx4 v15, s[48:51], s70 offen offset:2048 lds
    buffer_load_dwordx4 v16, s[48:51], s70 offen offset:3072 lds
    s_mov_b32 m0, s73
    s_add_u32 s73, s73, 0xffff8000
    buffer_load_dwordx4 v17, s[48:51], s70 offen offset:0 lds
    buffer_load_dwordx4 v18, s[48:51], s70 offen offset:1024 lds
    buffer_load_dwordx4 v19, s[48:51], s70 offen offset:2048 lds
    buffer_load_dwordx4 v20, s[48:51], s70 offen offset:3072 lds
    s_add_u32 s70, s70, 128
    s_and_b32 s70, s70, 0x7ff
    s_mov_b32 m0, s66
    s_add_u32 s66, s66, 0x6000
    buffer_load_dwordx4 v224, s[52:55], s71 offen offset:0 lds
    buffer_load_dwordx4 v225, s[52:55], s71 offen offset:1024 lds
    buffer_load_dwordx4 v226, s[52:55], s71 offen offset:2048 lds
    buffer_load_dwordx4 v227, s[52:55], s71 offen offset:3072 lds
    s_mov_b32 m0, s78
    s_add_u32 s78, s78, 0x6000
    buffer_load_dwordx4 v228, s[52:55], s71 offen offset:0 lds
    buffer_load_dwordx4 v229, s[52:55], s71 offen offset:1024 lds
    s_add_u32 s71, s71, s11
    s_cmp_eq_u32 s71, s15
    s_cselect_b32 s71, 0, s71
    s_mov_b32 m0, s66
    s_add_u32 s66, s66, 0xffff4000
    buffer_load_dwordx4 v224, s[52:55], s71 offen offset:0 lds
    buffer_load_dwordx4 v225, s[52:55], s71 offen offset:1024 lds
    buffer_load_dwordx4 v226, s[52:55], s71 offen offset:2048 lds
    buffer_load_dwordx4 v227, s[52:55], s71 offen offset:3072 lds
    s_mov_b32 m0, s78
    s_add_u32 s78, s78, 0xffff4000
    buffer_load_dwordx4 v228, s[52:55], s71 offen offset:0 lds
    buffer_load_dwordx4 v229, s[52:55], s71 offen offset:1024 lds
    s_add_u32 s71, s71, s11
    s_cmp_eq_u32 s71, s15
    s_cselect_b32 s71, 0, s71
    s_mov_b32 s67, 0x8000
    s_mov_b32 s68, 0xffff8000
    s_mov_b32 s12, 0x6000
    s_mov_b32 s13, 0x6000
    s_mov_b32 s14, 0xffff4000
    s_lshl_b32 s5, s64, 13
    v_and_b32 v4, 5, v2
    v_bfe_u32 v5, v2, 1, 1
    v_lshl_or_b32 v4, v5, 3, v4
    v_bfe_u32 v5, v2, 3, 1
    v_lshl_or_b32 v4, v5, 1, v4
    v_xor_b32 v4, v4, v3
    v_lshlrev_b32 v4, 3, v4
    v_lshl_add_u32 v4, v2, 7, v4
    v_add_u32 v4, s5, v4
    v_xor_b32 v32, 0, v4
    v_xor_b32 v33, 16, v4
    v_xor_b32 v34, 32, v4
    v_xor_b32 v35, 48, v4
    v_xor_b32 v36, 64, v4
    v_xor_b32 v37, 80, v4
    v_xor_b32 v38, 96, v4
    v_xor_b32 v39, 112, v4
    v_bfe_u32 v4, v1, 2, 2
    v_and_b32 v5, 1, v4
    v_bfe_u32 v6, v4, 1, 1
    v_lshl_or_b32 v5, v6, 3, v5
    v_lshl_or_b32 v5, v3, 1, v5
    v_lshl_add_u32 v4, v3, 3, v4
    v_and_b32 v6, 3, v1
    v_bfe_u32 v7, v1, 4, 1
    v_lshl_or_b32 v6, v7, 2, v6
    v_xor_b32 v5, v5, v6
    v_lshlrev_b32 v5, 3, v5
    v_lshl_add_u32 v5, v4, 7, v5
    v_add_u32 v5, s5, v5
    v_xor_b32 v40, 0, v5
    v_xor_b32 v41, 32, v5
    v_xor_b32 v42, 64, v5
    v_xor_b32 v43, 96, v5
    s_lshl_b32 s5, s75, 2
    v_mov_b32 v44, s5
    v_mov_b32 v45, 1
    s_lshl_b32 s5, s64, 12
    v_lshrrev_b32 v4, 3, v1
    v_and_b32 v5, 7, v1
    v_xor_b32 v6, v4, v5
    v_lshlrev_b32 v6, 4, v6
    v_lshl_add_u32 v6, v4, 7, v6
    v_add_u32 v47, s5, v6
    s_lshl_b32 s5, s74, 8
    s_lshl_b32 s6, s64, 5
    s_add_u32 s5, s5, s6
    v_add_u32 v4, s5, v4
    v_lshlrev_b32 v4, 11, v4
    v_lshl_add_u32 v4, v5, 4, v4
    s_lshl_b32 s5, s75, 7
    v_add_u32 v46, s5, v4
    s_waitcnt vmcnt(34)
    v_lshl_or_b32 v24, v49, 16, v48
    v_lshl_or_b32 v25, v51, 16, v50
    v_lshl_or_b32 v26, v53, 16, v52
    v_lshl_or_b32 v27, v55, 16, v54
    v_lshl_or_b32 v28, v57, 16, v56
    v_lshl_or_b32 v29, v59, 16, v58
    v_lshl_or_b32 v30, v61, 16, v60
    v_lshl_or_b32 v31, v63, 16, v62
    s_waitcnt vmcnt(20)
    s_barrier
    ds_read_b128 v[144:147], v8 offset:0
    ds_read_b64_tr_b16 v[160:161], v12 offset:0
    ds_read_b64_tr_b16 v[162:163], v12 offset:512
    ds_read_b64_tr_b16 v[164:165], v10 offset:0
    ds_read_b64_tr_b16 v[166:167], v10 offset:512
    ds_read_b64_tr_b16 v[168:169], v12 offset:8192
    ds_read_b64_tr_b16 v[170:171], v12 offset:8704
    ds_read_b64_tr_b16 v[172:173], v10 offset:8192
    ds_read_b64_tr_b16 v[174:175], v10 offset:8704
    ds_read_b64_tr_b16 v[176:177], v12 offset:16384
    ds_read_b64_tr_b16 v[178:179], v12 offset:16896
    ds_read_b64_tr_b16 v[180:181], v10 offset:16384
    ds_read_b64_tr_b16 v[182:183], v10 offset:16896
    ds_read_b128 v[148:151], v8 offset:2048
    ds_read_b128 v[152:155], v8 offset:4096
    ds_read_b128 v[156:159], v8 offset:6144
    v_add_u32 v8, s67, v8
    s_waitcnt lgkmcnt(0)
    v_mfma_f32_16x16x32_bf16 v[48:51], v[160:163], v[144:147], 0
    ds_read_b128 v[184:187], v9 offset:0
    v_mfma_f32_16x16x32_bf16 v[52:55], v[164:167], v[144:147], 0
    ds_read_b64_tr_b16 v[200:201], v12 offset:4096
    v_mfma_f32_16x16x32_bf16 v[80:83], v[168:171], v[144:147], 0
    ds_read_b64_tr_b16 v[202:203], v12 offset:4608
    v_mfma_f32_16x16x32_bf16 v[84:87], v[172:175], v[144:147], 0
    ds_read_b64_tr_b16 v[204:205], v10 offset:4096
    v_mfma_f32_16x16x32_bf16 v[112:115], v[144:147], v[176:179], 0
    v_mfma_f32_16x16x32_bf16 v[116:119], v[144:147], v[180:183], 0
    ds_read_b64_tr_b16 v[206:207], v10 offset:4608
    v_mfma_f32_16x16x32_bf16 v[56:59], v[160:163], v[148:151], 0
    ds_read_b64_tr_b16 v[208:209], v12 offset:12288
    v_mfma_f32_16x16x32_bf16 v[60:63], v[164:167], v[148:151], 0
    ds_read_b64_tr_b16 v[210:211], v12 offset:12800
    v_mfma_f32_16x16x32_bf16 v[88:91], v[168:171], v[148:151], 0
    ds_read_b64_tr_b16 v[212:213], v10 offset:12288
    v_mfma_f32_16x16x32_bf16 v[92:95], v[172:175], v[148:151], 0
    v_mfma_f32_16x16x32_bf16 v[120:123], v[148:151], v[176:179], 0
    ds_read_b64_tr_b16 v[214:215], v10 offset:12800
    v_mfma_f32_16x16x32_bf16 v[124:127], v[148:151], v[180:183], 0
    ds_read_b64_tr_b16 v[216:217], v12 offset:20480
    v_mfma_f32_16x16x32_bf16 v[64:67], v[160:163], v[152:155], 0
    ds_read_b64_tr_b16 v[218:219], v12 offset:20992
    v_mfma_f32_16x16x32_bf16 v[68:71], v[164:167], v[152:155], 0
    ds_read_b64_tr_b16 v[220:221], v10 offset:20480
    v_mfma_f32_16x16x32_bf16 v[96:99], v[168:171], v[152:155], 0
    v_mfma_f32_16x16x32_bf16 v[100:103], v[172:175], v[152:155], 0
    ds_read_b64_tr_b16 v[222:223], v10 offset:20992
    v_mfma_f32_16x16x32_bf16 v[128:131], v[152:155], v[176:179], 0
    ds_read_b128 v[188:191], v9 offset:2048
    v_mfma_f32_16x16x32_bf16 v[132:135], v[152:155], v[180:183], 0
    ds_read_b128 v[192:195], v9 offset:4096
    v_mfma_f32_16x16x32_bf16 v[72:75], v[160:163], v[156:159], 0
    ds_read_b128 v[196:199], v9 offset:6144
    v_mfma_f32_16x16x32_bf16 v[76:79], v[164:167], v[156:159], 0
    v_mfma_f32_16x16x32_bf16 v[104:107], v[168:171], v[156:159], 0
    v_add_u32 v9, s67, v9
    v_mfma_f32_16x16x32_bf16 v[108:111], v[172:175], v[156:159], 0
    v_add_u32 v12, s12, v12
    v_mfma_f32_16x16x32_bf16 v[136:139], v[156:159], v[176:179], 0
    v_add_u32 v10, s12, v10
    v_mfma_f32_16x16x32_bf16 v[140:143], v[156:159], v[180:183], 0
    s_waitcnt vmcnt(6) lgkmcnt(0)
    s_barrier
    v_mfma_f32_16x16x32_bf16 v[48:51], v[200:203], v[184:187], v[48:51]
    ds_read_b128 v[144:147], v8 offset:0
    ds_read_b64_tr_b16 v[160:161], v12 offset:0
    v_mfma_f32_16x16x32_bf16 v[52:55], v[204:207], v[184:187], v[52:55]
    ds_read_b64_tr_b16 v[162:163], v12 offset:512
    v_mfma_f32_16x16x32_bf16 v[80:83], v[208:211], v[184:187], v[80:83]
    ds_read_b64_tr_b16 v[164:165], v10 offset:0
    v_mfma_f32_16x16x32_bf16 v[84:87], v[212:215], v[184:187], v[84:87]
    ds_read_b64_tr_b16 v[166:167], v10 offset:512
    ds_read_b64_tr_b16 v[168:169], v12 offset:8192
    v_mfma_f32_16x16x32_bf16 v[112:115], v[184:187], v[216:219], v[112:115]
    ds_read_b64_tr_b16 v[170:171], v12 offset:8704
    v_mfma_f32_16x16x32_bf16 v[116:119], v[184:187], v[220:223], v[116:119]
    ds_read_b64_tr_b16 v[172:173], v10 offset:8192
    v_mfma_f32_16x16x32_bf16 v[56:59], v[200:203], v[188:191], v[56:59]
    ds_read_b64_tr_b16 v[174:175], v10 offset:8704
    ds_read_b64_tr_b16 v[176:177], v12 offset:16384
    v_mfma_f32_16x16x32_bf16 v[60:63], v[204:207], v[188:191], v[60:63]
    ds_read_b64_tr_b16 v[178:179], v12 offset:16896
    v_mfma_f32_16x16x32_bf16 v[88:91], v[208:211], v[188:191], v[88:91]
    ds_read_b64_tr_b16 v[180:181], v10 offset:16384
    v_mfma_f32_16x16x32_bf16 v[92:95], v[212:215], v[188:191], v[92:95]
    ds_read_b64_tr_b16 v[182:183], v10 offset:16896
    v_mfma_f32_16x16x32_bf16 v[120:123], v[188:191], v[216:219], v[120:123]
    ds_read_b128 v[148:151], v8 offset:2048
    ds_read_b128 v[152:155], v8 offset:4096
    v_mfma_f32_16x16x32_bf16 v[124:127], v[188:191], v[220:223], v[124:127]
    ds_read_b128 v[156:159], v8 offset:6144
    v_mfma_f32_16x16x32_bf16 v[64:67], v[200:203], v[192:195], v[64:67]
    v_add_u32 v8, s68, v8
    v_mfma_f32_16x16x32_bf16 v[68:71], v[204:207], v[192:195], v[68:71]
    s_mov_b32 m0, s72
    s_add_u32 s72, s72, s67
    buffer_load_dwordx4 v13, s[48:51], s70 offen offset:0 lds
    buffer_load_dwordx4 v14, s[48:51], s70 offen offset:1024 lds
    v_mfma_f32_16x16x32_bf16 v[96:99], v[208:211], v[192:195], v[96:99]
    buffer_load_dwordx4 v15, s[48:51], s70 offen offset:2048 lds
    v_mfma_f32_16x16x32_bf16 v[100:103], v[212:215], v[192:195], v[100:103]
    buffer_load_dwordx4 v16, s[48:51], s70 offen offset:3072 lds
    v_mfma_f32_16x16x32_bf16 v[128:131], v[192:195], v[216:219], v[128:131]
    s_mov_b32 m0, s73
    s_add_u32 s73, s73, s67
    buffer_load_dwordx4 v17, s[48:51], s70 offen offset:0 lds
    v_mfma_f32_16x16x32_bf16 v[132:135], v[192:195], v[220:223], v[132:135]
    buffer_load_dwordx4 v18, s[48:51], s70 offen offset:1024 lds
    buffer_load_dwordx4 v19, s[48:51], s70 offen offset:2048 lds
    v_mfma_f32_16x16x32_bf16 v[72:75], v[200:203], v[196:199], v[72:75]
    buffer_load_dwordx4 v20, s[48:51], s70 offen offset:3072 lds
    s_add_u32 s70, s70, 128
    s_and_b32 s70, s70, 0x7ff
    v_mfma_f32_16x16x32_bf16 v[76:79], v[204:207], v[196:199], v[76:79]
    s_sub_u32 s67, 0, s67
    v_mfma_f32_16x16x32_bf16 v[104:107], v[208:211], v[196:199], v[104:107]
    s_sub_u32 s68, 0, s68
    s_mov_b32 s69, s12
    v_mfma_f32_16x16x32_bf16 v[108:111], v[212:215], v[196:199], v[108:111]
    s_mov_b32 s12, s13
    v_mfma_f32_16x16x32_bf16 v[136:139], v[196:199], v[216:219], v[136:139]
    s_mov_b32 s13, s14
    v_mfma_f32_16x16x32_bf16 v[140:143], v[196:199], v[220:223], v[140:143]
    s_mov_b32 s14, s69
    s_mov_b32 s65, 12
k1ad_L0:
    s_waitcnt lgkmcnt(0)
    v_mfma_f32_16x16x32_bf16 v[48:51], v[160:163], v[144:147], v[48:51]
    ds_read_b128 v[184:187], v9 offset:0
    ds_read_b64_tr_b16 v[200:201], v12 offset:4096
    v_mfma_f32_16x16x32_bf16 v[52:55], v[164:167], v[144:147], v[52:55]
    ds_read_b64_tr_b16 v[202:203], v12 offset:4608
    v_mfma_f32_16x16x32_bf16 v[80:83], v[168:171], v[144:147], v[80:83]
    ds_read_b64_tr_b16 v[204:205], v10 offset:4096
    v_mfma_f32_16x16x32_bf16 v[84:87], v[172:175], v[144:147], v[84:87]
    ds_read_b64_tr_b16 v[206:207], v10 offset:4608
    v_mfma_f32_16x16x32_bf16 v[112:115], v[144:147], v[176:179], v[112:115]
    ds_read_b64_tr_b16 v[208:209], v12 offset:12288
    v_mfma_f32_16x16x32_bf16 v[116:119], v[144:147], v[180:183], v[116:119]
    ds_read_b64_tr_b16 v[210:211], v12 offset:12800
    v_mfma_f32_16x16x32_bf16 v[56:59], v[160:163], v[148:151], v[56:59]
    ds_read_b64_tr_b16 v[212:213], v10 offset:12288
    v_mfma_f32_16x16x32_bf16 v[60:63], v[164:167], v[148:151], v[60:63]
    ds_read_b64_tr_b16 v[214:215], v10 offset:12800
    v_mfma_f32_16x16x32_bf16 v[88:91], v[168:171], v[148:151], v[88:91]
    ds_read_b64_tr_b16 v[216:217], v12 offset:20480
    v_mfma_f32_16x16x32_bf16 v[92:95], v[172:175], v[148:151], v[92:95]
    ds_read_b64_tr_b16 v[218:219], v12 offset:20992
    v_mfma_f32_16x16x32_bf16 v[120:123], v[148:151], v[176:179], v[120:123]
    ds_read_b64_tr_b16 v[220:221], v10 offset:20480
    v_mfma_f32_16x16x32_bf16 v[124:127], v[148:151], v[180:183], v[124:127]
    ds_read_b64_tr_b16 v[222:223], v10 offset:20992
    v_mfma_f32_16x16x32_bf16 v[64:67], v[160:163], v[152:155], v[64:67]
    ds_read_b128 v[188:191], v9 offset:2048
    v_mfma_f32_16x16x32_bf16 v[68:71], v[164:167], v[152:155], v[68:71]
    ds_read_b128 v[192:195], v9 offset:4096
    v_mfma_f32_16x16x32_bf16 v[96:99], v[168:171], v[152:155], v[96:99]
    ds_read_b128 v[196:199], v9 offset:6144
    v_mfma_f32_16x16x32_bf16 v[100:103], v[172:175], v[152:155], v[100:103]
    v_add_u32 v9, s67, v9
    v_mfma_f32_16x16x32_bf16 v[128:131], v[152:155], v[176:179], v[128:131]
    v_add_u32 v12, s12, v12
    v_mfma_f32_16x16x32_bf16 v[132:135], v[152:155], v[180:183], v[132:135]
    v_add_u32 v10, s12, v10
    v_mfma_f32_16x16x32_bf16 v[72:75], v[160:163], v[156:159], v[72:75]
    s_mov_b32 m0, s66
    s_add_u32 s66, s66, s14
    buffer_load_dwordx4 v224, s[52:55], s71 offen offset:0 lds
    v_mfma_f32_16x16x32_bf16 v[76:79], v[164:167], v[156:159], v[76:79]
    buffer_load_dwordx4 v225, s[52:55], s71 offen offset:1024 lds
    v_mfma_f32_16x16x32_bf16 v[104:107], v[168:171], v[156:159], v[104:107]
    buffer_load_dwordx4 v226, s[52:55], s71 offen offset:2048 lds
    v_mfma_f32_16x16x32_bf16 v[108:111], v[172:175], v[156:159], v[108:111]
    buffer_load_dwordx4 v227, s[52:55], s71 offen offset:3072 lds
    v_mfma_f32_16x16x32_bf16 v[136:139], v[156:159], v[176:179], v[136:139]
    s_mov_b32 m0, s78
    s_add_u32 s78, s78, s14
    buffer_load_dwordx4 v228, s[52:55], s71 offen offset:0 lds
    v_mfma_f32_16x16x32_bf16 v[140:143], v[156:159], v[180:183], v[140:143]
    buffer_load_dwordx4 v229, s[52:55], s71 offen offset:1024 lds
    s_add_u32 s71, s71, s11
    s_cmp_eq_u32 s71, s15
    s_cselect_b32 s71, 0, s71
    s_waitcnt vmcnt(6) lgkmcnt(0)
    s_barrier
    v_mfma_f32_16x16x32_bf16 v[48:51], v[200:203], v[184:187], v[48:51]
    ds_read_b128 v[144:147], v8 offset:0
    ds_read_b64_tr_b16 v[160:161], v12 offset:0
    v_mfma_f32_16x16x32_bf16 v[52:55], v[204:207], v[184:187], v[52:55]
    ds_read_b64_tr_b16 v[162:163], v12 offset:512
    v_mfma_f32_16x16x32_bf16 v[80:83], v[208:211], v[184:187], v[80:83]
    ds_read_b64_tr_b16 v[164:165], v10 offset:0
    v_mfma_f32_16x16x32_bf16 v[84:87], v[212:215], v[184:187], v[84:87]
    ds_read_b64_tr_b16 v[166:167], v10 offset:512
    ds_read_b64_tr_b16 v[168:169], v12 offset:8192
    v_mfma_f32_16x16x32_bf16 v[112:115], v[184:187], v[216:219], v[112:115]
    ds_read_b64_tr_b16 v[170:171], v12 offset:8704
    v_mfma_f32_16x16x32_bf16 v[116:119], v[184:187], v[220:223], v[116:119]
    ds_read_b64_tr_b16 v[172:173], v10 offset:8192
    v_mfma_f32_16x16x32_bf16 v[56:59], v[200:203], v[188:191], v[56:59]
    ds_read_b64_tr_b16 v[174:175], v10 offset:8704
    ds_read_b64_tr_b16 v[176:177], v12 offset:16384
    v_mfma_f32_16x16x32_bf16 v[60:63], v[204:207], v[188:191], v[60:63]
    ds_read_b64_tr_b16 v[178:179], v12 offset:16896
    v_mfma_f32_16x16x32_bf16 v[88:91], v[208:211], v[188:191], v[88:91]
    ds_read_b64_tr_b16 v[180:181], v10 offset:16384
    v_mfma_f32_16x16x32_bf16 v[92:95], v[212:215], v[188:191], v[92:95]
    ds_read_b64_tr_b16 v[182:183], v10 offset:16896
    v_mfma_f32_16x16x32_bf16 v[120:123], v[188:191], v[216:219], v[120:123]
    ds_read_b128 v[148:151], v8 offset:2048
    ds_read_b128 v[152:155], v8 offset:4096
    v_mfma_f32_16x16x32_bf16 v[124:127], v[188:191], v[220:223], v[124:127]
    ds_read_b128 v[156:159], v8 offset:6144
    v_mfma_f32_16x16x32_bf16 v[64:67], v[200:203], v[192:195], v[64:67]
    v_add_u32 v8, s68, v8
    v_mfma_f32_16x16x32_bf16 v[68:71], v[204:207], v[192:195], v[68:71]
    s_mov_b32 m0, s72
    s_add_u32 s72, s72, s67
    buffer_load_dwordx4 v13, s[48:51], s70 offen offset:0 lds
    buffer_load_dwordx4 v14, s[48:51], s70 offen offset:1024 lds
    v_mfma_f32_16x16x32_bf16 v[96:99], v[208:211], v[192:195], v[96:99]
    buffer_load_dwordx4 v15, s[48:51], s70 offen offset:2048 lds
    v_mfma_f32_16x16x32_bf16 v[100:103], v[212:215], v[192:195], v[100:103]
    buffer_load_dwordx4 v16, s[48:51], s70 offen offset:3072 lds
    v_mfma_f32_16x16x32_bf16 v[128:131], v[192:195], v[216:219], v[128:131]
    s_mov_b32 m0, s73
    s_add_u32 s73, s73, s67
    buffer_load_dwordx4 v17, s[48:51], s70 offen offset:0 lds
    v_mfma_f32_16x16x32_bf16 v[132:135], v[192:195], v[220:223], v[132:135]
    buffer_load_dwordx4 v18, s[48:51], s70 offen offset:1024 lds
    buffer_load_dwordx4 v19, s[48:51], s70 offen offset:2048 lds
    v_mfma_f32_16x16x32_bf16 v[72:75], v[200:203], v[196:199], v[72:75]
    buffer_load_dwordx4 v20, s[48:51], s70 offen offset:3072 lds
    s_add_u32 s70, s70, 128
    s_and_b32 s70, s70, 0x7ff
    v_mfma_f32_16x16x32_bf16 v[76:79], v[204:207], v[196:199], v[76:79]
    s_sub_u32 s67, 0, s67
    v_mfma_f32_16x16x32_bf16 v[104:107], v[208:211], v[196:199], v[104:107]
    s_sub_u32 s68, 0, s68
    s_mov_b32 s69, s12
    v_mfma_f32_16x16x32_bf16 v[108:111], v[212:215], v[196:199], v[108:111]
    s_mov_b32 s12, s13
    v_mfma_f32_16x16x32_bf16 v[136:139], v[196:199], v[216:219], v[136:139]
    s_mov_b32 s13, s14
    v_mfma_f32_16x16x32_bf16 v[140:143], v[196:199], v[220:223], v[140:143]
    s_mov_b32 s14, s69
    s_sub_u32 s65, s65, 1
    s_cmp_lg_u32 s65, 0
    s_cbranch_scc1 k1ad_L0
    s_waitcnt lgkmcnt(0)
    v_mfma_f32_16x16x32_bf16 v[48:51], v[160:163], v[144:147], v[48:51]
    ds_read_b128 v[184:187], v9 offset:0
    ds_read_b64_tr_b16 v[200:201], v12 offset:4096
    v_mfma_f32_16x16x32_bf16 v[52:55], v[164:167], v[144:147], v[52:55]
    ds_read_b64_tr_b16 v[202:203], v12 offset:4608
    v_mfma_f32_16x16x32_bf16 v[80:83], v[168:171], v[144:147], v[80:83]
    ds_read_b64_tr_b16 v[204:205], v10 offset:4096
    v_mfma_f32_16x16x32_bf16 v[84:87], v[172:175], v[144:147], v[84:87]
    ds_read_b64_tr_b16 v[206:207], v10 offset:4608
    v_mfma_f32_16x16x32_bf16 v[112:115], v[144:147], v[176:179], v[112:115]
    ds_read_b64_tr_b16 v[208:209], v12 offset:12288
    v_mfma_f32_16x16x32_bf16 v[116:119], v[144:147], v[180:183], v[116:119]
    ds_read_b64_tr_b16 v[210:211], v12 offset:12800
    v_mfma_f32_16x16x32_bf16 v[56:59], v[160:163], v[148:151], v[56:59]
    ds_read_b64_tr_b16 v[212:213], v10 offset:12288
    v_mfma_f32_16x16x32_bf16 v[60:63], v[164:167], v[148:151], v[60:63]
    ds_read_b64_tr_b16 v[214:215], v10 offset:12800
    v_mfma_f32_16x16x32_bf16 v[88:91], v[168:171], v[148:151], v[88:91]
    ds_read_b64_tr_b16 v[216:217], v12 offset:20480
    v_mfma_f32_16x16x32_bf16 v[92:95], v[172:175], v[148:151], v[92:95]
    ds_read_b64_tr_b16 v[218:219], v12 offset:20992
    v_mfma_f32_16x16x32_bf16 v[120:123], v[148:151], v[176:179], v[120:123]
    ds_read_b64_tr_b16 v[220:221], v10 offset:20480
    v_mfma_f32_16x16x32_bf16 v[124:127], v[148:151], v[180:183], v[124:127]
    ds_read_b64_tr_b16 v[222:223], v10 offset:20992
    v_mfma_f32_16x16x32_bf16 v[64:67], v[160:163], v[152:155], v[64:67]
    ds_read_b128 v[188:191], v9 offset:2048
    v_mfma_f32_16x16x32_bf16 v[68:71], v[164:167], v[152:155], v[68:71]
    ds_read_b128 v[192:195], v9 offset:4096
    v_mfma_f32_16x16x32_bf16 v[96:99], v[168:171], v[152:155], v[96:99]
    ds_read_b128 v[196:199], v9 offset:6144
    v_mfma_f32_16x16x32_bf16 v[100:103], v[172:175], v[152:155], v[100:103]
    v_add_u32 v9, s67, v9
    v_mfma_f32_16x16x32_bf16 v[128:131], v[152:155], v[176:179], v[128:131]
    v_add_u32 v12, s12, v12
    v_mfma_f32_16x16x32_bf16 v[132:135], v[152:155], v[180:183], v[132:135]
    v_add_u32 v10, s12, v10
    v_mfma_f32_16x16x32_bf16 v[72:75], v[160:163], v[156:159], v[72:75]
    s_mov_b32 m0, s66
    s_add_u32 s66, s66, s14
    buffer_load_dwordx4 v224, s[52:55], s71 offen offset:0 lds
    v_mfma_f32_16x16x32_bf16 v[76:79], v[164:167], v[156:159], v[76:79]
    buffer_load_dwordx4 v225, s[52:55], s71 offen offset:1024 lds
    v_mfma_f32_16x16x32_bf16 v[104:107], v[168:171], v[156:159], v[104:107]
    buffer_load_dwordx4 v226, s[52:55], s71 offen offset:2048 lds
    v_mfma_f32_16x16x32_bf16 v[108:111], v[172:175], v[156:159], v[108:111]
    buffer_load_dwordx4 v227, s[52:55], s71 offen offset:3072 lds
    v_mfma_f32_16x16x32_bf16 v[136:139], v[156:159], v[176:179], v[136:139]
    s_mov_b32 m0, s78
    s_add_u32 s78, s78, s14
    buffer_load_dwordx4 v228, s[52:55], s71 offen offset:0 lds
    v_mfma_f32_16x16x32_bf16 v[140:143], v[156:159], v[180:183], v[140:143]
    buffer_load_dwordx4 v229, s[52:55], s71 offen offset:1024 lds
    s_add_u32 s71, s71, s11
    s_cmp_eq_u32 s71, s15
    s_cselect_b32 s71, 0, s71
    s_waitcnt vmcnt(6) lgkmcnt(0)
    s_barrier
    v_mfma_f32_16x16x32_bf16 v[48:51], v[200:203], v[184:187], v[48:51]
    ds_read_b128 v[144:147], v8 offset:0
    ds_read_b64_tr_b16 v[160:161], v12 offset:0
    v_mfma_f32_16x16x32_bf16 v[52:55], v[204:207], v[184:187], v[52:55]
    ds_read_b64_tr_b16 v[162:163], v12 offset:512
    v_mfma_f32_16x16x32_bf16 v[80:83], v[208:211], v[184:187], v[80:83]
    ds_read_b64_tr_b16 v[164:165], v10 offset:0
    v_mfma_f32_16x16x32_bf16 v[84:87], v[212:215], v[184:187], v[84:87]
    ds_read_b64_tr_b16 v[166:167], v10 offset:512
    ds_read_b64_tr_b16 v[168:169], v12 offset:8192
    v_mfma_f32_16x16x32_bf16 v[112:115], v[184:187], v[216:219], v[112:115]
    ds_read_b64_tr_b16 v[170:171], v12 offset:8704
    v_mfma_f32_16x16x32_bf16 v[116:119], v[184:187], v[220:223], v[116:119]
    ds_read_b64_tr_b16 v[172:173], v10 offset:8192
    v_mfma_f32_16x16x32_bf16 v[56:59], v[200:203], v[188:191], v[56:59]
    ds_read_b64_tr_b16 v[174:175], v10 offset:8704
    ds_read_b64_tr_b16 v[176:177], v12 offset:16384
    v_mfma_f32_16x16x32_bf16 v[60:63], v[204:207], v[188:191], v[60:63]
    ds_read_b64_tr_b16 v[178:179], v12 offset:16896
    v_mfma_f32_16x16x32_bf16 v[88:91], v[208:211], v[188:191], v[88:91]
    ds_read_b64_tr_b16 v[180:181], v10 offset:16384
    v_mfma_f32_16x16x32_bf16 v[92:95], v[212:215], v[188:191], v[92:95]
    ds_read_b64_tr_b16 v[182:183], v10 offset:16896
    v_mfma_f32_16x16x32_bf16 v[120:123], v[188:191], v[216:219], v[120:123]
    ds_read_b128 v[148:151], v8 offset:2048
    ds_read_b128 v[152:155], v8 offset:4096
    v_mfma_f32_16x16x32_bf16 v[124:127], v[188:191], v[220:223], v[124:127]
    ds_read_b128 v[156:159], v8 offset:6144
    v_mfma_f32_16x16x32_bf16 v[64:67], v[200:203], v[192:195], v[64:67]
    v_add_u32 v8, s68, v8
    v_mfma_f32_16x16x32_bf16 v[68:71], v[204:207], v[192:195], v[68:71]
    s_mov_b32 m0, s72
    s_add_u32 s72, s72, s67
    buffer_load_dwordx4 v13, s[48:51], s70 offen offset:0 lds
    buffer_load_dwordx4 v14, s[48:51], s70 offen offset:1024 lds
    v_mfma_f32_16x16x32_bf16 v[96:99], v[208:211], v[192:195], v[96:99]
    buffer_load_dwordx4 v15, s[48:51], s70 offen offset:2048 lds
    v_mfma_f32_16x16x32_bf16 v[100:103], v[212:215], v[192:195], v[100:103]
    buffer_load_dwordx4 v16, s[48:51], s70 offen offset:3072 lds
    v_mfma_f32_16x16x32_bf16 v[128:131], v[192:195], v[216:219], v[128:131]
    s_mov_b32 m0, s73
    s_add_u32 s73, s73, s67
    buffer_load_dwordx4 v17, s[48:51], s70 offen offset:0 lds
    v_mfma_f32_16x16x32_bf16 v[132:135], v[192:195], v[220:223], v[132:135]
    buffer_load_dwordx4 v18, s[48:51], s70 offen offset:1024 lds
    buffer_load_dwordx4 v19, s[48:51], s70 offen offset:2048 lds
    v_mfma_f32_16x16x32_bf16 v[72:75], v[200:203], v[196:199], v[72:75]
    buffer_load_dwordx4 v20, s[48:51], s70 offen offset:3072 lds
    s_add_u32 s70, s70, 128
    s_and_b32 s70, s70, 0x7ff
    v_mfma_f32_16x16x32_bf16 v[76:79], v[204:207], v[196:199], v[76:79]
    s_sub_u32 s67, 0, s67
    v_mfma_f32_16x16x32_bf16 v[104:107], v[208:211], v[196:199], v[104:107]
    s_sub_u32 s68, 0, s68
    s_mov_b32 s69, s12
    v_mfma_f32_16x16x32_bf16 v[108:111], v[212:215], v[196:199], v[108:111]
    s_mov_b32 s12, s13
    v_mfma_f32_16x16x32_bf16 v[136:139], v[196:199], v[216:219], v[136:139]
    s_mov_b32 s13, s14
    v_mfma_f32_16x16x32_bf16 v[140:143], v[196:199], v[220:223], v[140:143]
    s_mov_b32 s14, s69
    s_waitcnt lgkmcnt(0)
    v_mfma_f32_16x16x32_bf16 v[48:51], v[160:163], v[144:147], v[48:51]
    ds_read_b128 v[184:187], v9 offset:0
    v_mfma_f32_16x16x32_bf16 v[52:55], v[164:167], v[144:147], v[52:55]
    ds_read_b64_tr_b16 v[200:201], v12 offset:4096
    v_mfma_f32_16x16x32_bf16 v[80:83], v[168:171], v[144:147], v[80:83]
    ds_read_b64_tr_b16 v[202:203], v12 offset:4608
    v_mfma_f32_16x16x32_bf16 v[84:87], v[172:175], v[144:147], v[84:87]
    ds_read_b64_tr_b16 v[204:205], v10 offset:4096
    v_mfma_f32_16x16x32_bf16 v[112:115], v[144:147], v[176:179], v[112:115]
    v_mfma_f32_16x16x32_bf16 v[116:119], v[144:147], v[180:183], v[116:119]
    ds_read_b64_tr_b16 v[206:207], v10 offset:4608
    v_mfma_f32_16x16x32_bf16 v[56:59], v[160:163], v[148:151], v[56:59]
    ds_read_b64_tr_b16 v[208:209], v12 offset:12288
    v_mfma_f32_16x16x32_bf16 v[60:63], v[164:167], v[148:151], v[60:63]
    ds_read_b64_tr_b16 v[210:211], v12 offset:12800
    v_mfma_f32_16x16x32_bf16 v[88:91], v[168:171], v[148:151], v[88:91]
    ds_read_b64_tr_b16 v[212:213], v10 offset:12288
    v_mfma_f32_16x16x32_bf16 v[92:95], v[172:175], v[148:151], v[92:95]
    v_mfma_f32_16x16x32_bf16 v[120:123], v[148:151], v[176:179], v[120:123]
    ds_read_b64_tr_b16 v[214:215], v10 offset:12800
    v_mfma_f32_16x16x32_bf16 v[124:127], v[148:151], v[180:183], v[124:127]
    ds_read_b64_tr_b16 v[216:217], v12 offset:20480
    v_mfma_f32_16x16x32_bf16 v[64:67], v[160:163], v[152:155], v[64:67]
    ds_read_b64_tr_b16 v[218:219], v12 offset:20992
    v_mfma_f32_16x16x32_bf16 v[68:71], v[164:167], v[152:155], v[68:71]
    ds_read_b64_tr_b16 v[220:221], v10 offset:20480
    v_mfma_f32_16x16x32_bf16 v[96:99], v[168:171], v[152:155], v[96:99]
    v_mfma_f32_16x16x32_bf16 v[100:103], v[172:175], v[152:155], v[100:103]
    ds_read_b64_tr_b16 v[222:223], v10 offset:20992
    v_mfma_f32_16x16x32_bf16 v[128:131], v[152:155], v[176:179], v[128:131]
    ds_read_b128 v[188:191], v9 offset:2048
    v_mfma_f32_16x16x32_bf16 v[132:135], v[152:155], v[180:183], v[132:135]
    ds_read_b128 v[192:195], v9 offset:4096
    v_mfma_f32_16x16x32_bf16 v[72:75], v[160:163], v[156:159], v[72:75]
    ds_read_b128 v[196:199], v9 offset:6144
    v_mfma_f32_16x16x32_bf16 v[76:79], v[164:167], v[156:159], v[76:79]
    v_mfma_f32_16x16x32_bf16 v[104:107], v[168:171], v[156:159], v[104:107]
    v_add_u32 v9, s67, v9
    v_mfma_f32_16x16x32_bf16 v[108:111], v[172:175], v[156:159], v[108:111]
    v_add_u32 v12, s12, v12
    v_mfma_f32_16x16x32_bf16 v[136:139], v[156:159], v[176:179], v[136:139]
    v_add_u32 v10, s12, v10
    v_mfma_f32_16x16x32_bf16 v[140:143], v[156:159], v[180:183], v[140:143]
    s_waitcnt vmcnt(0) lgkmcnt(0)
    s_barrier
    v_mfma_f32_16x16x32_bf16 v[48:51], v[200:203], v[184:187], v[48:51]
    ds_read_b128 v[144:147], v8 offset:0
    v_mfma_f32_16x16x32_bf16 v[52:55], v[204:207], v[184:187], v[52:55]
    ds_read_b64_tr_b16 v[160:161], v12 offset:0
    v_mfma_f32_16x16x32_bf16 v[80:83], v[208:211], v[184:187], v[80:83]
    ds_read_b64_tr_b16 v[162:163], v12 offset:512
    v_mfma_f32_16x16x32_bf16 v[84:87], v[212:215], v[184:187], v[84:87]
    ds_read_b64_tr_b16 v[164:165], v10 offset:0
    v_mfma_f32_16x16x32_bf16 v[112:115], v[184:187], v[216:219], v[112:115]
    ds_read_b64_tr_b16 v[166:167], v10 offset:512
    v_mfma_f32_16x16x32_bf16 v[116:119], v[184:187], v[220:223], v[116:119]
    ds_read_b64_tr_b16 v[168:169], v12 offset:8192
    v_mfma_f32_16x16x32_bf16 v[56:59], v[200:203], v[188:191], v[56:59]
    ds_read_b64_tr_b16 v[170:171], v12 offset:8704
    v_mfma_f32_16x16x32_bf16 v[60:63], v[204:207], v[188:191], v[60:63]
    ds_read_b64_tr_b16 v[172:173], v10 offset:8192
    v_mfma_f32_16x16x32_bf16 v[88:91], v[208:211], v[188:191], v[88:91]
    ds_read_b64_tr_b16 v[174:175], v10 offset:8704
    v_mfma_f32_16x16x32_bf16 v[92:95], v[212:215], v[188:191], v[92:95]
    ds_read_b64_tr_b16 v[176:177], v12 offset:16384
    v_mfma_f32_16x16x32_bf16 v[120:123], v[188:191], v[216:219], v[120:123]
    ds_read_b64_tr_b16 v[178:179], v12 offset:16896
    v_mfma_f32_16x16x32_bf16 v[124:127], v[188:191], v[220:223], v[124:127]
    ds_read_b64_tr_b16 v[180:181], v10 offset:16384
    v_mfma_f32_16x16x32_bf16 v[64:67], v[200:203], v[192:195], v[64:67]
    ds_read_b64_tr_b16 v[182:183], v10 offset:16896
    v_mfma_f32_16x16x32_bf16 v[68:71], v[204:207], v[192:195], v[68:71]
    ds_read_b128 v[148:151], v8 offset:2048
    v_mfma_f32_16x16x32_bf16 v[96:99], v[208:211], v[192:195], v[96:99]
    ds_read_b128 v[152:155], v8 offset:4096
    v_mfma_f32_16x16x32_bf16 v[100:103], v[212:215], v[192:195], v[100:103]
    ds_read_b128 v[156:159], v8 offset:6144
    v_mfma_f32_16x16x32_bf16 v[128:131], v[192:195], v[216:219], v[128:131]
    v_add_u32 v8, s68, v8
    v_mfma_f32_16x16x32_bf16 v[132:135], v[192:195], v[220:223], v[132:135]
    s_sub_u32 s67, 0, s67
    v_mfma_f32_16x16x32_bf16 v[72:75], v[200:203], v[196:199], v[72:75]
    s_sub_u32 s68, 0, s68
    v_mfma_f32_16x16x32_bf16 v[76:79], v[204:207], v[196:199], v[76:79]
    s_mov_b32 s69, s12
    v_mfma_f32_16x16x32_bf16 v[104:107], v[208:211], v[196:199], v[104:107]
    s_mov_b32 s12, s13
    v_mfma_f32_16x16x32_bf16 v[108:111], v[212:215], v[196:199], v[108:111]
    s_mov_b32 s13, s14
    v_mfma_f32_16x16x32_bf16 v[136:139], v[196:199], v[216:219], v[136:139]
    s_mov_b32 s14, s69
    v_mfma_f32_16x16x32_bf16 v[140:143], v[196:199], v[220:223], v[140:143]
    s_waitcnt lgkmcnt(0)
    v_mfma_f32_16x16x32_bf16 v[48:51], v[160:163], v[144:147], v[48:51]
    ds_read_b128 v[184:187], v9 offset:0
    v_mfma_f32_16x16x32_bf16 v[52:55], v[164:167], v[144:147], v[52:55]
    ds_read_b64_tr_b16 v[200:201], v12 offset:4096
    v_mfma_f32_16x16x32_bf16 v[80:83], v[168:171], v[144:147], v[80:83]
    ds_read_b64_tr_b16 v[202:203], v12 offset:4608
    v_mfma_f32_16x16x32_bf16 v[84:87], v[172:175], v[144:147], v[84:87]
    ds_read_b64_tr_b16 v[204:205], v10 offset:4096
    v_mfma_f32_16x16x32_bf16 v[112:115], v[144:147], v[176:179], v[112:115]
    v_mfma_f32_16x16x32_bf16 v[116:119], v[144:147], v[180:183], v[116:119]
    ds_read_b64_tr_b16 v[206:207], v10 offset:4608
    v_mfma_f32_16x16x32_bf16 v[56:59], v[160:163], v[148:151], v[56:59]
    ds_read_b64_tr_b16 v[208:209], v12 offset:12288
    v_mfma_f32_16x16x32_bf16 v[60:63], v[164:167], v[148:151], v[60:63]
    ds_read_b64_tr_b16 v[210:211], v12 offset:12800
    v_mfma_f32_16x16x32_bf16 v[88:91], v[168:171], v[148:151], v[88:91]
    ds_read_b64_tr_b16 v[212:213], v10 offset:12288
    v_mfma_f32_16x16x32_bf16 v[92:95], v[172:175], v[148:151], v[92:95]
    v_mfma_f32_16x16x32_bf16 v[120:123], v[148:151], v[176:179], v[120:123]
    ds_read_b64_tr_b16 v[214:215], v10 offset:12800
    v_mfma_f32_16x16x32_bf16 v[124:127], v[148:151], v[180:183], v[124:127]
    ds_read_b64_tr_b16 v[216:217], v12 offset:20480
    v_mfma_f32_16x16x32_bf16 v[64:67], v[160:163], v[152:155], v[64:67]
    ds_read_b64_tr_b16 v[218:219], v12 offset:20992
    v_mfma_f32_16x16x32_bf16 v[68:71], v[164:167], v[152:155], v[68:71]
    ds_read_b64_tr_b16 v[220:221], v10 offset:20480
    v_mfma_f32_16x16x32_bf16 v[96:99], v[168:171], v[152:155], v[96:99]
    v_mfma_f32_16x16x32_bf16 v[100:103], v[172:175], v[152:155], v[100:103]
    ds_read_b64_tr_b16 v[222:223], v10 offset:20992
    v_mfma_f32_16x16x32_bf16 v[128:131], v[152:155], v[176:179], v[128:131]
    ds_read_b128 v[188:191], v9 offset:2048
    v_mfma_f32_16x16x32_bf16 v[132:135], v[152:155], v[180:183], v[132:135]
    ds_read_b128 v[192:195], v9 offset:4096
    v_mfma_f32_16x16x32_bf16 v[72:75], v[160:163], v[156:159], v[72:75]
    ds_read_b128 v[196:199], v9 offset:6144
    v_mfma_f32_16x16x32_bf16 v[76:79], v[164:167], v[156:159], v[76:79]
    v_mfma_f32_16x16x32_bf16 v[104:107], v[168:171], v[156:159], v[104:107]
    v_add_u32 v9, s67, v9
    v_mfma_f32_16x16x32_bf16 v[108:111], v[172:175], v[156:159], v[108:111]
    v_add_u32 v12, s12, v12
    v_mfma_f32_16x16x32_bf16 v[136:139], v[156:159], v[176:179], v[136:139]
    v_add_u32 v10, s12, v10
    v_mfma_f32_16x16x32_bf16 v[140:143], v[156:159], v[180:183], v[140:143]
    s_waitcnt lgkmcnt(0)
    v_mfma_f32_16x16x32_bf16 v[48:51], v[200:203], v[184:187], v[48:51]
    v_mfma_f32_16x16x32_bf16 v[52:55], v[204:207], v[184:187], v[52:55]
    v_mfma_f32_16x16x32_bf16 v[80:83], v[208:211], v[184:187], v[80:83]
    v_mfma_f32_16x16x32_bf16 v[84:87], v[212:215], v[184:187], v[84:87]
    v_mfma_f32_16x16x32_bf16 v[112:115], v[184:187], v[216:219], v[112:115]
    v_mfma_f32_16x16x32_bf16 v[116:119], v[184:187], v[220:223], v[116:119]
    v_mfma_f32_16x16x32_bf16 v[56:59], v[200:203], v[188:191], v[56:59]
    v_mfma_f32_16x16x32_bf16 v[60:63], v[204:207], v[188:191], v[60:63]
    v_mfma_f32_16x16x32_bf16 v[88:91], v[208:211], v[188:191], v[88:91]
    v_mfma_f32_16x16x32_bf16 v[92:95], v[212:215], v[188:191], v[92:95]
    v_mfma_f32_16x16x32_bf16 v[120:123], v[188:191], v[216:219], v[120:123]
    v_mfma_f32_16x16x32_bf16 v[124:127], v[188:191], v[220:223], v[124:127]
    v_mfma_f32_16x16x32_bf16 v[64:67], v[200:203], v[192:195], v[64:67]
    v_mfma_f32_16x16x32_bf16 v[68:71], v[204:207], v[192:195], v[68:71]
    v_mfma_f32_16x16x32_bf16 v[96:99], v[208:211], v[192:195], v[96:99]
    v_mfma_f32_16x16x32_bf16 v[100:103], v[212:215], v[192:195], v[100:103]
    v_mfma_f32_16x16x32_bf16 v[128:131], v[192:195], v[216:219], v[128:131]
    v_mfma_f32_16x16x32_bf16 v[132:135], v[192:195], v[220:223], v[132:135]
    v_mfma_f32_16x16x32_bf16 v[72:75], v[200:203], v[196:199], v[72:75]
    v_mfma_f32_16x16x32_bf16 v[76:79], v[204:207], v[196:199], v[76:79]
    v_mfma_f32_16x16x32_bf16 v[104:107], v[208:211], v[196:199], v[104:107]
    v_mfma_f32_16x16x32_bf16 v[108:111], v[212:215], v[196:199], v[108:111]
    v_mfma_f32_16x16x32_bf16 v[136:139], v[196:199], v[216:219], v[136:139]
    v_mfma_f32_16x16x32_bf16 v[140:143], v[196:199], v[220:223], v[140:143]
    s_branch k1a_join
k1a_r1:
    s_mov_b32 s67, 0x8000
    s_mov_b32 s68, 0xffff8000
    s_mov_b32 s12, 0x6000
    s_mov_b32 s13, 0x6000
    s_mov_b32 s14, 0xffff4000
    s_lshl_b32 s5, s64, 13
    v_and_b32 v4, 5, v2
    v_bfe_u32 v5, v2, 1, 1
    v_lshl_or_b32 v4, v5, 3, v4
    v_bfe_u32 v5, v2, 3, 1
    v_lshl_or_b32 v4, v5, 1, v4
    v_xor_b32 v4, v4, v3
    v_lshlrev_b32 v4, 3, v4
    v_lshl_add_u32 v4, v2, 7, v4
    v_add_u32 v4, s5, v4
    v_xor_b32 v32, 0, v4
    v_xor_b32 v33, 16, v4
    v_xor_b32 v34, 32, v4
    v_xor_b32 v35, 48, v4
    v_xor_b32 v36, 64, v4
    v_xor_b32 v37, 80, v4
    v_xor_b32 v38, 96, v4
    v_xor_b32 v39, 112, v4
    v_bfe_u32 v4, v1, 2, 2
    v_and_b32 v5, 1, v4
    v_bfe_u32 v6, v4, 1, 1
    v_lshl_or_b32 v5, v6, 3, v5
    v_lshl_or_b32 v5, v3, 1, v5
    v_lshl_add_u32 v4, v3, 3, v4
    v_and_b32 v6, 3, v1
    v_bfe_u32 v7, v1, 4, 1
    v_lshl_or_b32 v6, v7, 2, v6
    v_xor_b32 v5, v5, v6
    v_lshlrev_b32 v5, 3, v5
    v_lshl_add_u32 v5, v4, 7, v5
    v_add_u32 v5, s5, v5
    v_xor_b32 v40, 0, v5
    v_xor_b32 v41, 32, v5
    v_xor_b32 v42, 64, v5
    v_xor_b32 v43, 96, v5
    s_lshl_b32 s5, s75, 2
    v_mov_b32 v44, s5
    v_mov_b32 v45, 1
    s_lshl_b32 s5, s64, 12
    v_lshrrev_b32 v4, 3, v1
    v_and_b32 v5, 7, v1
    v_xor_b32 v6, v4, v5
    v_lshlrev_b32 v6, 4, v6
    v_lshl_add_u32 v6, v4, 7, v6
    v_add_u32 v47, s5, v6
    s_lshl_b32 s5, s74, 8
    s_lshl_b32 s6, s64, 5
    s_add_u32 s5, s5, s6
    v_add_u32 v4, s5, v4
    v_lshlrev_b32 v4, 11, v4
    v_lshl_add_u32 v4, v5, 4, v4
    s_lshl_b32 s5, s75, 7
    v_add_u32 v46, s5, v4
    s_waitcnt vmcnt(0)
    v_lshl_or_b32 v24, v49, 16, v48
    v_lshl_or_b32 v25, v51, 16, v50
    v_lshl_or_b32 v26, v53, 16, v52
    v_lshl_or_b32 v27, v55, 16, v54
    v_lshl_or_b32 v28, v57, 16, v56
    v_lshl_or_b32 v29, v59, 16, v58
    v_lshl_or_b32 v30, v61, 16, v60
    v_lshl_or_b32 v31, v63, 16, v62
    s_barrier
    ds_read_b128 v[144:147], v8 offset:0
    ds_read_b64_tr_b16 v[160:161], v12 offset:0
    ds_read_b64_tr_b16 v[162:163], v12 offset:512
    ds_read_b64_tr_b16 v[164:165], v10 offset:0
    ds_read_b64_tr_b16 v[166:167], v10 offset:512
    ds_read_b64_tr_b16 v[168:169], v12 offset:8192
    ds_read_b64_tr_b16 v[170:171], v12 offset:8704
    ds_read_b64_tr_b16 v[172:173], v10 offset:8192
    ds_read_b64_tr_b16 v[174:175], v10 offset:8704
    ds_read_b64_tr_b16 v[176:177], v12 offset:16384
    ds_read_b64_tr_b16 v[178:179], v12 offset:16896
    ds_read_b64_tr_b16 v[180:181], v10 offset:16384
    ds_read_b64_tr_b16 v[182:183], v10 offset:16896
    ds_read_b128 v[148:151], v8 offset:2048
    ds_read_b128 v[152:155], v8 offset:4096
    ds_read_b128 v[156:159], v8 offset:6144
    v_add_u32 v8, s67, v8
    s_waitcnt lgkmcnt(0)
    v_mfma_f32_16x16x32_bf16 v[48:51], v[160:163], v[144:147], 0
    ds_read_b128 v[184:187], v9 offset:0
    v_mfma_f32_16x16x32_bf16 v[52:55], v[164:167], v[144:147], 0
    ds_read_b64_tr_b16 v[200:201], v12 offset:4096
    v_mfma_f32_16x16x32_bf16 v[80:83], v[168:171], v[144:147], 0
    ds_read_b64_tr_b16 v[202:203], v12 offset:4608
    v_mfma_f32_16x16x32_bf16 v[84:87], v[172:175], v[144:147], 0
    ds_read_b64_tr_b16 v[204:205], v10 offset:4096
    v_mfma_f32_16x16x32_bf16 v[112:115], v[144:147], v[176:179], 0
    v_mfma_f32_16x16x32_bf16 v[116:119], v[144:147], v[180:183], 0
    ds_read_b64_tr_b16 v[206:207], v10 offset:4608
    v_mfma_f32_16x16x32_bf16 v[56:59], v[160:163], v[148:151], 0
    ds_read_b64_tr_b16 v[208:209], v12 offset:12288
    v_mfma_f32_16x16x32_bf16 v[60:63], v[164:167], v[148:151], 0
    ds_read_b64_tr_b16 v[210:211], v12 offset:12800
    v_mfma_f32_16x16x32_bf16 v[88:91], v[168:171], v[148:151], 0
    ds_read_b64_tr_b16 v[212:213], v10 offset:12288
    v_mfma_f32_16x16x32_bf16 v[92:95], v[172:175], v[148:151], 0
    v_mfma_f32_16x16x32_bf16 v[120:123], v[148:151], v[176:179], 0
    ds_read_b64_tr_b16 v[214:215], v10 offset:12800
    v_mfma_f32_16x16x32_bf16 v[124:127], v[148:151], v[180:183], 0
    ds_read_b64_tr_b16 v[216:217], v12 offset:20480
    v_mfma_f32_16x16x32_bf16 v[64:67], v[160:163], v[152:155], 0
    ds_read_b64_tr_b16 v[218:219], v12 offset:20992
    v_mfma_f32_16x16x32_bf16 v[68:71], v[164:167], v[152:155], 0
    ds_read_b64_tr_b16 v[220:221], v10 offset:20480
    v_mfma_f32_16x16x32_bf16 v[96:99], v[168:171], v[152:155], 0
    v_mfma_f32_16x16x32_bf16 v[100:103], v[172:175], v[152:155], 0
    ds_read_b64_tr_b16 v[222:223], v10 offset:20992
    v_mfma_f32_16x16x32_bf16 v[128:131], v[152:155], v[176:179], 0
    ds_read_b128 v[188:191], v9 offset:2048
    v_mfma_f32_16x16x32_bf16 v[132:135], v[152:155], v[180:183], 0
    ds_read_b128 v[192:195], v9 offset:4096
    v_mfma_f32_16x16x32_bf16 v[72:75], v[160:163], v[156:159], 0
    ds_read_b128 v[196:199], v9 offset:6144
    v_mfma_f32_16x16x32_bf16 v[76:79], v[164:167], v[156:159], 0
    v_mfma_f32_16x16x32_bf16 v[104:107], v[168:171], v[156:159], 0
    v_add_u32 v9, s67, v9
    v_mfma_f32_16x16x32_bf16 v[108:111], v[172:175], v[156:159], 0
    v_add_u32 v12, s12, v12
    v_mfma_f32_16x16x32_bf16 v[136:139], v[156:159], v[176:179], 0
    v_add_u32 v10, s12, v10
    v_mfma_f32_16x16x32_bf16 v[140:143], v[156:159], v[180:183], 0
    s_waitcnt lgkmcnt(0)
    s_barrier
    v_mfma_f32_16x16x32_bf16 v[48:51], v[200:203], v[184:187], v[48:51]
    ds_read_b128 v[144:147], v8 offset:0
    v_mfma_f32_16x16x32_bf16 v[52:55], v[204:207], v[184:187], v[52:55]
    ds_read_b64_tr_b16 v[160:161], v12 offset:0
    v_mfma_f32_16x16x32_bf16 v[80:83], v[208:211], v[184:187], v[80:83]
    ds_read_b64_tr_b16 v[162:163], v12 offset:512
    v_mfma_f32_16x16x32_bf16 v[84:87], v[212:215], v[184:187], v[84:87]
    ds_read_b64_tr_b16 v[164:165], v10 offset:0
    v_mfma_f32_16x16x32_bf16 v[112:115], v[184:187], v[216:219], v[112:115]
    ds_read_b64_tr_b16 v[166:167], v10 offset:512
    v_mfma_f32_16x16x32_bf16 v[116:119], v[184:187], v[220:223], v[116:119]
    ds_read_b64_tr_b16 v[168:169], v12 offset:8192
    v_mfma_f32_16x16x32_bf16 v[56:59], v[200:203], v[188:191], v[56:59]
    ds_read_b64_tr_b16 v[170:171], v12 offset:8704
    v_mfma_f32_16x16x32_bf16 v[60:63], v[204:207], v[188:191], v[60:63]
    ds_read_b64_tr_b16 v[172:173], v10 offset:8192
    v_mfma_f32_16x16x32_bf16 v[88:91], v[208:211], v[188:191], v[88:91]
    ds_read_b64_tr_b16 v[174:175], v10 offset:8704
    v_mfma_f32_16x16x32_bf16 v[92:95], v[212:215], v[188:191], v[92:95]
    ds_read_b64_tr_b16 v[176:177], v12 offset:16384
    v_mfma_f32_16x16x32_bf16 v[120:123], v[188:191], v[216:219], v[120:123]
    ds_read_b64_tr_b16 v[178:179], v12 offset:16896
    v_mfma_f32_16x16x32_bf16 v[124:127], v[188:191], v[220:223], v[124:127]
    ds_read_b64_tr_b16 v[180:181], v10 offset:16384
    v_mfma_f32_16x16x32_bf16 v[64:67], v[200:203], v[192:195], v[64:67]
    ds_read_b64_tr_b16 v[182:183], v10 offset:16896
    v_mfma_f32_16x16x32_bf16 v[68:71], v[204:207], v[192:195], v[68:71]
    ds_read_b128 v[148:151], v8 offset:2048
    v_mfma_f32_16x16x32_bf16 v[96:99], v[208:211], v[192:195], v[96:99]
    ds_read_b128 v[152:155], v8 offset:4096
    v_mfma_f32_16x16x32_bf16 v[100:103], v[212:215], v[192:195], v[100:103]
    ds_read_b128 v[156:159], v8 offset:6144
    v_mfma_f32_16x16x32_bf16 v[128:131], v[192:195], v[216:219], v[128:131]
    v_add_u32 v8, s68, v8
    v_mfma_f32_16x16x32_bf16 v[132:135], v[192:195], v[220:223], v[132:135]
    s_sub_u32 s67, 0, s67
    v_mfma_f32_16x16x32_bf16 v[72:75], v[200:203], v[196:199], v[72:75]
    s_sub_u32 s68, 0, s68
    v_mfma_f32_16x16x32_bf16 v[76:79], v[204:207], v[196:199], v[76:79]
    s_mov_b32 s69, s12
    v_mfma_f32_16x16x32_bf16 v[104:107], v[208:211], v[196:199], v[104:107]
    s_mov_b32 s12, s13
    v_mfma_f32_16x16x32_bf16 v[108:111], v[212:215], v[196:199], v[108:111]
    s_mov_b32 s13, s14
    v_mfma_f32_16x16x32_bf16 v[136:139], v[196:199], v[216:219], v[136:139]
    s_mov_b32 s14, s69
    v_mfma_f32_16x16x32_bf16 v[140:143], v[196:199], v[220:223], v[140:143]
    s_mov_b32 s65, 14
k1an_L0:
    s_waitcnt lgkmcnt(0)
    v_mfma_f32_16x16x32_bf16 v[48:51], v[160:163], v[144:147], v[48:51]
    ds_read_b128 v[184:187], v9 offset:0
    v_mfma_f32_16x16x32_bf16 v[52:55], v[164:167], v[144:147], v[52:55]
    ds_read_b64_tr_b16 v[200:201], v12 offset:4096
    v_mfma_f32_16x16x32_bf16 v[80:83], v[168:171], v[144:147], v[80:83]
    ds_read_b64_tr_b16 v[202:203], v12 offset:4608
    v_mfma_f32_16x16x32_bf16 v[84:87], v[172:175], v[144:147], v[84:87]
    ds_read_b64_tr_b16 v[204:205], v10 offset:4096
    v_mfma_f32_16x16x32_bf16 v[112:115], v[144:147], v[176:179], v[112:115]
    v_mfma_f32_16x16x32_bf16 v[116:119], v[144:147], v[180:183], v[116:119]
    ds_read_b64_tr_b16 v[206:207], v10 offset:4608
    v_mfma_f32_16x16x32_bf16 v[56:59], v[160:163], v[148:151], v[56:59]
    ds_read_b64_tr_b16 v[208:209], v12 offset:12288
    v_mfma_f32_16x16x32_bf16 v[60:63], v[164:167], v[148:151], v[60:63]
    ds_read_b64_tr_b16 v[210:211], v12 offset:12800
    v_mfma_f32_16x16x32_bf16 v[88:91], v[168:171], v[148:151], v[88:91]
    ds_read_b64_tr_b16 v[212:213], v10 offset:12288
    v_mfma_f32_16x16x32_bf16 v[92:95], v[172:175], v[148:151], v[92:95]
    v_mfma_f32_16x16x32_bf16 v[120:123], v[148:151], v[176:179], v[120:123]
    ds_read_b64_tr_b16 v[214:215], v10 offset:12800
    v_mfma_f32_16x16x32_bf16 v[124:127], v[148:151], v[180:183], v[124:127]
    ds_read_b64_tr_b16 v[216:217], v12 offset:20480
    v_mfma_f32_16x16x32_bf16 v[64:67], v[160:163], v[152:155], v[64:67]
    ds_read_b64_tr_b16 v[218:219], v12 offset:20992
    v_mfma_f32_16x16x32_bf16 v[68:71], v[164:167], v[152:155], v[68:71]
    ds_read_b64_tr_b16 v[220:221], v10 offset:20480
    v_mfma_f32_16x16x32_bf16 v[96:99], v[168:171], v[152:155], v[96:99]
    v_mfma_f32_16x16x32_bf16 v[100:103], v[172:175], v[152:155], v[100:103]
    ds_read_b64_tr_b16 v[222:223], v10 offset:20992
    v_mfma_f32_16x16x32_bf16 v[128:131], v[152:155], v[176:179], v[128:131]
    ds_read_b128 v[188:191], v9 offset:2048
    v_mfma_f32_16x16x32_bf16 v[132:135], v[152:155], v[180:183], v[132:135]
    ds_read_b128 v[192:195], v9 offset:4096
    v_mfma_f32_16x16x32_bf16 v[72:75], v[160:163], v[156:159], v[72:75]
    ds_read_b128 v[196:199], v9 offset:6144
    v_mfma_f32_16x16x32_bf16 v[76:79], v[164:167], v[156:159], v[76:79]
    v_mfma_f32_16x16x32_bf16 v[104:107], v[168:171], v[156:159], v[104:107]
    v_add_u32 v9, s67, v9
    v_mfma_f32_16x16x32_bf16 v[108:111], v[172:175], v[156:159], v[108:111]
    v_add_u32 v12, s12, v12
    v_mfma_f32_16x16x32_bf16 v[136:139], v[156:159], v[176:179], v[136:139]
    v_add_u32 v10, s12, v10
    v_mfma_f32_16x16x32_bf16 v[140:143], v[156:159], v[180:183], v[140:143]
    s_waitcnt lgkmcnt(0)
    s_barrier
    v_mfma_f32_16x16x32_bf16 v[48:51], v[200:203], v[184:187], v[48:51]
    ds_read_b128 v[144:147], v8 offset:0
    v_mfma_f32_16x16x32_bf16 v[52:55], v[204:207], v[184:187], v[52:55]
    ds_read_b64_tr_b16 v[160:161], v12 offset:0
    v_mfma_f32_16x16x32_bf16 v[80:83], v[208:211], v[184:187], v[80:83]
    ds_read_b64_tr_b16 v[162:163], v12 offset:512
    v_mfma_f32_16x16x32_bf16 v[84:87], v[212:215], v[184:187], v[84:87]
    ds_read_b64_tr_b16 v[164:165], v10 offset:0
    v_mfma_f32_16x16x32_bf16 v[112:115], v[184:187], v[216:219], v[112:115]
    ds_read_b64_tr_b16 v[166:167], v10 offset:512
    v_mfma_f32_16x16x32_bf16 v[116:119], v[184:187], v[220:223], v[116:119]
    ds_read_b64_tr_b16 v[168:169], v12 offset:8192
    v_mfma_f32_16x16x32_bf16 v[56:59], v[200:203], v[188:191], v[56:59]
    ds_read_b64_tr_b16 v[170:171], v12 offset:8704
    v_mfma_f32_16x16x32_bf16 v[60:63], v[204:207], v[188:191], v[60:63]
    ds_read_b64_tr_b16 v[172:173], v10 offset:8192
    v_mfma_f32_16x16x32_bf16 v[88:91], v[208:211], v[188:191], v[88:91]
    ds_read_b64_tr_b16 v[174:175], v10 offset:8704
    v_mfma_f32_16x16x32_bf16 v[92:95], v[212:215], v[188:191], v[92:95]
    ds_read_b64_tr_b16 v[176:177], v12 offset:16384
    v_mfma_f32_16x16x32_bf16 v[120:123], v[188:191], v[216:219], v[120:123]
    ds_read_b64_tr_b16 v[178:179], v12 offset:16896
    v_mfma_f32_16x16x32_bf16 v[124:127], v[188:191], v[220:223], v[124:127]
    ds_read_b64_tr_b16 v[180:181], v10 offset:16384
    v_mfma_f32_16x16x32_bf16 v[64:67], v[200:203], v[192:195], v[64:67]
    ds_read_b64_tr_b16 v[182:183], v10 offset:16896
    v_mfma_f32_16x16x32_bf16 v[68:71], v[204:207], v[192:195], v[68:71]
    ds_read_b128 v[148:151], v8 offset:2048
    v_mfma_f32_16x16x32_bf16 v[96:99], v[208:211], v[192:195], v[96:99]
    ds_read_b128 v[152:155], v8 offset:4096
    v_mfma_f32_16x16x32_bf16 v[100:103], v[212:215], v[192:195], v[100:103]
    ds_read_b128 v[156:159], v8 offset:6144
    v_mfma_f32_16x16x32_bf16 v[128:131], v[192:195], v[216:219], v[128:131]
    v_add_u32 v8, s68, v8
    v_mfma_f32_16x16x32_bf16 v[132:135], v[192:195], v[220:223], v[132:135]
    s_sub_u32 s67, 0, s67
    v_mfma_f32_16x16x32_bf16 v[72:75], v[200:203], v[196:199], v[72:75]
    s_sub_u32 s68, 0, s68
    v_mfma_f32_16x16x32_bf16 v[76:79], v[204:207], v[196:199], v[76:79]
    s_mov_b32 s69, s12
    v_mfma_f32_16x16x32_bf16 v[104:107], v[208:211], v[196:199], v[104:107]
    s_mov_b32 s12, s13
    v_mfma_f32_16x16x32_bf16 v[108:111], v[212:215], v[196:199], v[108:111]
    s_mov_b32 s13, s14
    v_mfma_f32_16x16x32_bf16 v[136:139], v[196:199], v[216:219], v[136:139]
    s_mov_b32 s14, s69
    v_mfma_f32_16x16x32_bf16 v[140:143], v[196:199], v[220:223], v[140:143]
    s_sub_u32 s65, s65, 1
    s_cmp_lg_u32 s65, 0
    s_cbranch_scc1 k1an_L0
    s_waitcnt lgkmcnt(0)
    v_mfma_f32_16x16x32_bf16 v[48:51], v[160:163], v[144:147], v[48:51]
    ds_read_b128 v[184:187], v9 offset:0
    v_mfma_f32_16x16x32_bf16 v[52:55], v[164:167], v[144:147], v[52:55]
    ds_read_b64_tr_b16 v[200:201], v12 offset:4096
    v_mfma_f32_16x16x32_bf16 v[80:83], v[168:171], v[144:147], v[80:83]
    ds_read_b64_tr_b16 v[202:203], v12 offset:4608
    v_mfma_f32_16x16x32_bf16 v[84:87], v[172:175], v[144:147], v[84:87]
    ds_read_b64_tr_b16 v[204:205], v10 offset:4096
    v_mfma_f32_16x16x32_bf16 v[112:115], v[144:147], v[176:179], v[112:115]
    v_mfma_f32_16x16x32_bf16 v[116:119], v[144:147], v[180:183], v[116:119]
    ds_read_b64_tr_b16 v[206:207], v10 offset:4608
    v_mfma_f32_16x16x32_bf16 v[56:59], v[160:163], v[148:151], v[56:59]
    ds_read_b64_tr_b16 v[208:209], v12 offset:12288
    v_mfma_f32_16x16x32_bf16 v[60:63], v[164:167], v[148:151], v[60:63]
    ds_read_b64_tr_b16 v[210:211], v12 offset:12800
    v_mfma_f32_16x16x32_bf16 v[88:91], v[168:171], v[148:151], v[88:91]
    ds_read_b64_tr_b16 v[212:213], v10 offset:12288
    v_mfma_f32_16x16x32_bf16 v[92:95], v[172:175], v[148:151], v[92:95]
    v_mfma_f32_16x16x32_bf16 v[120:123], v[148:151], v[176:179], v[120:123]
    ds_read_b64_tr_b16 v[214:215], v10 offset:12800
    v_mfma_f32_16x16x32_bf16 v[124:127], v[148:151], v[180:183], v[124:127]
    ds_read_b64_tr_b16 v[216:217], v12 offset:20480
    v_mfma_f32_16x16x32_bf16 v[64:67], v[160:163], v[152:155], v[64:67]
    ds_read_b64_tr_b16 v[218:219], v12 offset:20992
    v_mfma_f32_16x16x32_bf16 v[68:71], v[164:167], v[152:155], v[68:71]
    ds_read_b64_tr_b16 v[220:221], v10 offset:20480
    v_mfma_f32_16x16x32_bf16 v[96:99], v[168:171], v[152:155], v[96:99]
    v_mfma_f32_16x16x32_bf16 v[100:103], v[172:175], v[152:155], v[100:103]
    ds_read_b64_tr_b16 v[222:223], v10 offset:20992
    v_mfma_f32_16x16x32_bf16 v[128:131], v[152:155], v[176:179], v[128:131]
    ds_read_b128 v[188:191], v9 offset:2048
    v_mfma_f32_16x16x32_bf16 v[132:135], v[152:155], v[180:183], v[132:135]
    ds_read_b128 v[192:195], v9 offset:4096
    v_mfma_f32_16x16x32_bf16 v[72:75], v[160:163], v[156:159], v[72:75]
    ds_read_b128 v[196:199], v9 offset:6144
    v_mfma_f32_16x16x32_bf16 v[76:79], v[164:167], v[156:159], v[76:79]
    v_mfma_f32_16x16x32_bf16 v[104:107], v[168:171], v[156:159], v[104:107]
    v_add_u32 v9, s67, v9
    v_mfma_f32_16x16x32_bf16 v[108:111], v[172:175], v[156:159], v[108:111]
    v_add_u32 v12, s12, v12
    v_mfma_f32_16x16x32_bf16 v[136:139], v[156:159], v[176:179], v[136:139]
    v_add_u32 v10, s12, v10
    v_mfma_f32_16x16x32_bf16 v[140:143], v[156:159], v[180:183], v[140:143]
    s_waitcnt lgkmcnt(0)
    v_mfma_f32_16x16x32_bf16 v[48:51], v[200:203], v[184:187], v[48:51]
    v_mfma_f32_16x16x32_bf16 v[52:55], v[204:207], v[184:187], v[52:55]
    v_mfma_f32_16x16x32_bf16 v[80:83], v[208:211], v[184:187], v[80:83]
    v_mfma_f32_16x16x32_bf16 v[84:87], v[212:215], v[184:187], v[84:87]
    v_mfma_f32_16x16x32_bf16 v[112:115], v[184:187], v[216:219], v[112:115]
    v_mfma_f32_16x16x32_bf16 v[116:119], v[184:187], v[220:223], v[116:119]
    v_mfma_f32_16x16x32_bf16 v[56:59], v[200:203], v[188:191], v[56:59]
    v_mfma_f32_16x16x32_bf16 v[60:63], v[204:207], v[188:191], v[60:63]
    v_mfma_f32_16x16x32_bf16 v[88:91], v[208:211], v[188:191], v[88:91]
    v_mfma_f32_16x16x32_bf16 v[92:95], v[212:215], v[188:191], v[92:95]
    v_mfma_f32_16x16x32_bf16 v[120:123], v[188:191], v[216:219], v[120:123]
    v_mfma_f32_16x16x32_bf16 v[124:127], v[188:191], v[220:223], v[124:127]
    v_mfma_f32_16x16x32_bf16 v[64:67], v[200:203], v[192:195], v[64:67]
    v_mfma_f32_16x16x32_bf16 v[68:71], v[204:207], v[192:195], v[68:71]
    v_mfma_f32_16x16x32_bf16 v[96:99], v[208:211], v[192:195], v[96:99]
    v_mfma_f32_16x16x32_bf16 v[100:103], v[212:215], v[192:195], v[100:103]
    v_mfma_f32_16x16x32_bf16 v[128:131], v[192:195], v[216:219], v[128:131]
    v_mfma_f32_16x16x32_bf16 v[132:135], v[192:195], v[220:223], v[132:135]
    v_mfma_f32_16x16x32_bf16 v[72:75], v[200:203], v[196:199], v[72:75]
    v_mfma_f32_16x16x32_bf16 v[76:79], v[204:207], v[196:199], v[76:79]
    v_mfma_f32_16x16x32_bf16 v[104:107], v[208:211], v[196:199], v[104:107]
    v_mfma_f32_16x16x32_bf16 v[108:111], v[212:215], v[196:199], v[108:111]
    v_mfma_f32_16x16x32_bf16 v[136:139], v[196:199], v[216:219], v[136:139]
    v_mfma_f32_16x16x32_bf16 v[140:143], v[196:199], v[220:223], v[140:143]
k1a_join:
    v_mov_b32 v21, 0x3f803f80
    v_mov_b32 v22, 0
    v_mov_b32 v23, 0
    s_add_u32 s56, s46, 0xc00000
    s_addc_u32 s57, s47, 0
    s_and_b32 s57, s57, 0xffff
    s_mov_b32 s58, 0x400000
    s_mov_b32 s59, 0x00020000
    s_mov_b32 s60, s46
    s_and_b32 s61, s47, 0xffff
    s_mov_b32 s62, 0x400000
    s_mov_b32 s63, 0x00020000
    v_cvt_pk_bf16_f32 v144, v80, v81
    v_cvt_pk_bf16_f32 v145, v82, v83
    v_cvt_pk_bf16_f32 v148, v84, v85
    v_cvt_pk_bf16_f32 v149, v86, v87
    v_cvt_pk_bf16_f32 v146, v88, v89
    v_cvt_pk_bf16_f32 v147, v90, v91
    v_cvt_pk_bf16_f32 v150, v92, v93
    v_cvt_pk_bf16_f32 v151, v94, v95
    v_permlane16_swap_b32 v144, v146
    v_permlane16_swap_b32 v145, v147
    v_permlane16_swap_b32 v148, v150
    v_permlane16_swap_b32 v149, v151
    v_mfma_f32_32x32x16_bf16 v[152:167], v[24:27], v[144:147], 0
    s_nop 0
    v_mfma_f32_32x32x16_bf16 v[152:167], v[28:31], v[148:151], v[152:167]
    s_nop 11
    v_max3_f32 v248, v152, v153, v154
    v_min3_f32 v250, v152, v153, v154
    v_max3_f32 v248, v248, v155, v156
    v_min3_f32 v250, v250, v155, v156
    v_max3_f32 v248, v248, v157, v158
    v_min3_f32 v250, v250, v157, v158
    v_max3_f32 v248, v248, v159, v160
    v_min3_f32 v250, v250, v159, v160
    v_max3_f32 v248, v248, v161, v162
    v_min3_f32 v250, v250, v161, v162
    v_max3_f32 v248, v248, v163, v164
    v_min3_f32 v250, v250, v163, v164
    v_max3_f32 v248, v248, v165, v166
    v_min3_f32 v250, v250, v165, v166
    v_max_f32 v248, v248, v167
    v_min_f32 v250, v250, v167
    v_mov_b32 v252, v248
    v_mov_b32 v254, v250
    s_nop 0
    v_permlane32_swap_b32 v248, v252
    v_permlane32_swap_b32 v250, v254
    v_max_f32 v248, v248, v252
    v_min_f32 v250, v250, v254
    v_mul_f32 v248, s8, v248
    v_mul_f32 v250, s8, v250
    v_pk_fma_f32 v[168:169], v[152:153], s[8:9], v[248:249] op_sel_hi:[1,1,0] neg_lo:[0,0,1] neg_hi:[0,0,1]
    v_pk_fma_f32 v[184:185], v[152:153], s[8:9], v[250:251] op_sel_hi:[1,1,0] neg_lo:[1,0,0] neg_hi:[1,0,0]
    v_pk_fma_f32 v[170:171], v[154:155], s[8:9], v[248:249] op_sel_hi:[1,1,0] neg_lo:[0,0,1] neg_hi:[0,0,1]
    v_pk_fma_f32 v[186:187], v[154:155], s[8:9], v[250:251] op_sel_hi:[1,1,0] neg_lo:[1,0,0] neg_hi:[1,0,0]
    v_pk_fma_f32 v[172:173], v[156:157], s[8:9], v[248:249] op_sel_hi:[1,1,0] neg_lo:[0,0,1] neg_hi:[0,0,1]
    v_pk_fma_f32 v[188:189], v[156:157], s[8:9], v[250:251] op_sel_hi:[1,1,0] neg_lo:[1,0,0] neg_hi:[1,0,0]
    v_pk_fma_f32 v[174:175], v[158:159], s[8:9], v[248:249] op_sel_hi:[1,1,0] neg_lo:[0,0,1] neg_hi:[0,0,1]
    v_pk_fma_f32 v[190:191], v[158:159], s[8:9], v[250:251] op_sel_hi:[1,1,0] neg_lo:[1,0,0] neg_hi:[1,0,0]
    v_pk_fma_f32 v[176:177], v[160:161], s[8:9], v[248:249] op_sel_hi:[1,1,0] neg_lo:[0,0,1] neg_hi:[0,0,1]
    v_pk_fma_f32 v[192:193], v[160:161], s[8:9], v[250:251] op_sel_hi:[1,1,0] neg_lo:[1,0,0] neg_hi:[1,0,0]
    v_pk_fma_f32 v[178:179], v[162:163], s[8:9], v[248:249] op_sel_hi:[1,1,0] neg_lo:[0,0,1] neg_hi:[0,0,1]
    v_pk_fma_f32 v[194:195], v[162:163], s[8:9], v[250:251] op_sel_hi:[1,1,0] neg_lo:[1,0,0] neg_hi:[1,0,0]
    v_pk_fma_f32 v[180:181], v[164:165], s[8:9], v[248:249] op_sel_hi:[1,1,0] neg_lo:[0,0,1] neg_hi:[0,0,1]
    v_pk_fma_f32 v[196:197], v[164:165], s[8:9], v[250:251] op_sel_hi:[1,1,0] neg_lo:[1,0,0] neg_hi:[1,0,0]
    v_pk_fma_f32 v[182:183], v[166:167], s[8:9], v[248:249] op_sel_hi:[1,1,0] neg_lo:[0,0,1] neg_hi:[0,0,1]
    v_pk_fma_f32 v[198:199], v[166:167], s[8:9], v[250:251] op_sel_hi:[1,1,0] neg_lo:[1,0,0] neg_hi:[1,0,0]
    v_exp_f32 v168, v168
    v_exp_f32 v184, v184
    v_exp_f32 v169, v169
    v_exp_f32 v185, v185
    v_exp_f32 v170, v170
    v_exp_f32 v186, v186
    v_exp_f32 v171, v171
    v_exp_f32 v187, v187
    v_exp_f32 v172, v172
    v_exp_f32 v188, v188
    v_exp_f32 v173, v173
    v_exp_f32 v189, v189
    v_exp_f32 v174, v174
    v_exp_f32 v190, v190
    v_exp_f32 v175, v175
    v_exp_f32 v191, v191
    v_exp_f32 v176, v176
    v_exp_f32 v192, v192
    v_exp_f32 v177, v177
    v_exp_f32 v193, v193
    v_exp_f32 v178, v178
    v_exp_f32 v194, v194
    v_exp_f32 v179, v179
    v_exp_f32 v195, v195
    v_exp_f32 v180, v180
    v_exp_f32 v196, v196
    v_exp_f32 v181, v181
    v_exp_f32 v197, v197
    v_exp_f32 v182, v182
    v_exp_f32 v198, v198
    v_exp_f32 v183, v183
    v_exp_f32 v199, v199
    v_pk_add_f32 v[248:249], v[168:169], v[170:171]
    v_pk_add_f32 v[250:251], v[184:185], v[186:187]
    v_pk_add_f32 v[252:253], v[172:173], v[174:175]
    v_pk_add_f32 v[254:255], v[188:189], v[190:191]
    v_pk_add_f32 v[248:249], v[248:249], v[176:177]
    v_pk_add_f32 v[250:251], v[250:251], v[192:193]
    v_pk_add_f32 v[252:253], v[252:253], v[178:179]
    v_pk_add_f32 v[254:255], v[254:255], v[194:195]
    v_pk_add_f32 v[248:249], v[248:249], v[180:181]
    v_pk_add_f32 v[250:251], v[250:251], v[196:197]
    v_pk_add_f32 v[252:253], v[252:253], v[182:183]
    v_pk_add_f32 v[254:255], v[254:255], v[198:199]
    v_pk_add_f32 v[248:249], v[248:249], v[252:253]
    v_pk_add_f32 v[250:251], v[250:251], v[254:255]
    v_add_f32 v248, v248, v249
    v_add_f32 v250, v250, v251
    v_mov_b32 v252, v248
    v_mov_b32 v254, v250
    s_nop 0
    v_permlane32_swap_b32 v248, v252
    v_permlane32_swap_b32 v250, v254
    v_add_f32 v248, v248, v252
    v_add_f32 v250, v250, v254
    v_rcp_f32 v248, v248
    v_rcp_f32 v250, v250
    v_pk_mul_f32 v[168:169], v[168:169], v[248:249] op_sel_hi:[1,0]
    v_pk_mul_f32 v[184:185], v[184:185], v[250:251] op_sel_hi:[1,0]
    v_pk_mul_f32 v[170:171], v[170:171], v[248:249] op_sel_hi:[1,0]
    v_pk_mul_f32 v[186:187], v[186:187], v[250:251] op_sel_hi:[1,0]
    v_pk_mul_f32 v[172:173], v[172:173], v[248:249] op_sel_hi:[1,0]
    v_pk_mul_f32 v[188:189], v[188:189], v[250:251] op_sel_hi:[1,0]
    v_pk_mul_f32 v[174:175], v[174:175], v[248:249] op_sel_hi:[1,0]
    v_pk_mul_f32 v[190:191], v[190:191], v[250:251] op_sel_hi:[1,0]
    v_pk_mul_f32 v[176:177], v[176:177], v[248:249] op_sel_hi:[1,0]
    v_pk_mul_f32 v[192:193], v[192:193], v[250:251] op_sel_hi:[1,0]
    v_pk_mul_f32 v[178:179], v[178:179], v[248:249] op_sel_hi:[1,0]
    v_pk_mul_f32 v[194:195], v[194:195], v[250:251] op_sel_hi:[1,0]
    v_pk_mul_f32 v[180:181], v[180:181], v[248:249] op_sel_hi:[1,0]
    v_pk_mul_f32 v[196:197], v[196:197], v[250:251] op_sel_hi:[1,0]
    v_pk_mul_f32 v[182:183], v[182:183], v[248:249] op_sel_hi:[1,0]
    v_pk_mul_f32 v[198:199], v[198:199], v[250:251] op_sel_hi:[1,0]
    v_cvt_pk_bf16_f32 v200, v168, v169
    v_cvt_pk_bf16_f32 v208, v184, v185
    v_cvt_pk_bf16_f32 v201, v170, v171
    v_cvt_pk_bf16_f32 v209, v186, v187
    v_cvt_pk_bf16_f32 v202, v172, v173
    v_cvt_pk_bf16_f32 v210, v188, v189
    v_cvt_pk_bf16_f32 v203, v174, v175
    v_cvt_pk_bf16_f32 v211, v190, v191
    v_cvt_pk_bf16_f32 v204, v176, v177
    v_cvt_pk_bf16_f32 v212, v192, v193
    v_cvt_pk_bf16_f32 v205, v178, v179
    v_cvt_pk_bf16_f32 v213, v194, v195
    v_cvt_pk_bf16_f32 v206, v180, v181
    v_cvt_pk_bf16_f32 v214, v196, v197
    v_cvt_pk_bf16_f32 v207, v182, v183
    v_cvt_pk_bf16_f32 v215, v198, v199
    s_barrier
    ds_write_b64 v32, v[200:201] offset:0
    ds_write_b64 v36, v[208:209] offset:0
    ds_write_b64 v33, v[202:203] offset:0
    ds_write_b64 v37, v[210:211] offset:0
    ds_write_b64 v34, v[204:205] offset:0
    ds_write_b64 v38, v[212:213] offset:0
    ds_write_b64 v35, v[206:207] offset:0
    ds_write_b64 v39, v[214:215] offset:0
    v_cvt_pk_bf16_f32 v144, v112, v113
    v_cvt_pk_bf16_f32 v145, v114, v115
    v_cvt_pk_bf16_f32 v146, v116, v117
    v_cvt_pk_bf16_f32 v147, v118, v119
    v_cvt_pk_bf16_f32 v148, v120, v121
    v_cvt_pk_bf16_f32 v149, v122, v123
    v_cvt_pk_bf16_f32 v150, v124, v125
    v_cvt_pk_bf16_f32 v151, v126, v127
    v_permlane16_swap_b32 v144, v146
    v_permlane16_swap_b32 v145, v147
    v_permlane16_swap_b32 v148, v150
    v_permlane16_swap_b32 v149, v151
    s_waitcnt lgkmcnt(0)
    ds_read_b64_tr_b16 v[168:169], v40 offset:0
    ds_read_b64_tr_b16 v[170:171], v41 offset:512
    ds_read_b64_tr_b16 v[172:173], v40 offset:2048
    ds_read_b64_tr_b16 v[174:175], v41 offset:2560
    ds_read_b64_tr_b16 v[176:177], v42 offset:0
    ds_read_b64_tr_b16 v[178:179], v43 offset:512
    ds_read_b64_tr_b16 v[180:181], v42 offset:2048
    ds_read_b64_tr_b16 v[182:183], v43 offset:2560
    s_waitcnt lgkmcnt(6)
    v_mfma_f32_32x32x16_bf16 v[216:231], v[168:171], v[144:147], 0
    v_dot2c_f32_bf16 v22, v168, v21
    v_dot2c_f32_bf16 v22, v169, v21
    v_dot2c_f32_bf16 v22, v170, v21
    v_dot2c_f32_bf16 v22, v171, v21
    s_waitcnt lgkmcnt(4)
    v_mfma_f32_32x32x16_bf16 v[216:231], v[172:175], v[148:151], v[216:231]
    v_dot2c_f32_bf16 v22, v172, v21
    v_dot2c_f32_bf16 v22, v173, v21
    v_dot2c_f32_bf16 v22, v174, v21
    v_dot2c_f32_bf16 v22, v175, v21
    s_waitcnt lgkmcnt(2)
    v_mfma_f32_32x32x16_bf16 v[232:247], v[176:179], v[144:147], 0
    v_dot2c_f32_bf16 v23, v176, v21
    v_dot2c_f32_bf16 v23, v177, v21
    v_dot2c_f32_bf16 v23, v178, v21
    v_dot2c_f32_bf16 v23, v179, v21
    s_waitcnt lgkmcnt(0)
    v_mfma_f32_32x32x16_bf16 v[232:247], v[180:183], v[148:151], v[232:247]
    v_dot2c_f32_bf16 v23, v180, v21
    v_dot2c_f32_bf16 v23, v181, v21
    v_dot2c_f32_bf16 v23, v182, v21
    v_dot2c_f32_bf16 v23, v183, v21
    v_cvt_pk_bf16_f32 v144, v96, v97
    v_cvt_pk_bf16_f32 v145, v98, v99
    v_cvt_pk_bf16_f32 v148, v100, v101
    v_cvt_pk_bf16_f32 v149, v102, v103
    v_cvt_pk_bf16_f32 v146, v104, v105
    v_cvt_pk_bf16_f32 v147, v106, v107
    v_cvt_pk_bf16_f32 v150, v108, v109
    v_cvt_pk_bf16_f32 v151, v110, v111
    v_permlane16_swap_b32 v144, v146
    v_permlane16_swap_b32 v145, v147
    v_permlane16_swap_b32 v148, v150
    v_permlane16_swap_b32 v149, v151
    v_mfma_f32_32x32x16_bf16 v[152:167], v[24:27], v[144:147], 0
    s_nop 0
    v_mfma_f32_32x32x16_bf16 v[152:167], v[28:31], v[148:151], v[152:167]
    s_nop 11
    v_max3_f32 v248, v152, v153, v154
    v_min3_f32 v250, v152, v153, v154
    v_max3_f32 v248, v248, v155, v156
    v_min3_f32 v250, v250, v155, v156
    v_max3_f32 v248, v248, v157, v158
    v_min3_f32 v250, v250, v157, v158
    v_max3_f32 v248, v248, v159, v160
    v_min3_f32 v250, v250, v159, v160
    v_max3_f32 v248, v248, v161, v162
    v_min3_f32 v250, v250, v161, v162
    v_max3_f32 v248, v248, v163, v164
    v_min3_f32 v250, v250, v163, v164
    v_max3_f32 v248, v248, v165, v166
    v_min3_f32 v250, v250, v165, v166
    v_max_f32 v248, v248, v167
    v_min_f32 v250, v250, v167
    v_mov_b32 v252, v248
    v_mov_b32 v254, v250
    s_nop 0
    v_permlane32_swap_b32 v248, v252
    v_permlane32_swap_b32 v250, v254
    v_max_f32 v248, v248, v252
    v_min_f32 v250, v250, v254
    v_mul_f32 v248, s8, v248
    v_mul_f32 v250, s8, v250
    v_pk_fma_f32 v[168:169], v[152:153], s[8:9], v[248:249] op_sel_hi:[1,1,0] neg_lo:[0,0,1] neg_hi:[0,0,1]
    v_pk_fma_f32 v[184:185], v[152:153], s[8:9], v[250:251] op_sel_hi:[1,1,0] neg_lo:[1,0,0] neg_hi:[1,0,0]
    v_pk_fma_f32 v[170:171], v[154:155], s[8:9], v[248:249] op_sel_hi:[1,1,0] neg_lo:[0,0,1] neg_hi:[0,0,1]
    v_pk_fma_f32 v[186:187], v[154:155], s[8:9], v[250:251] op_sel_hi:[1,1,0] neg_lo:[1,0,0] neg_hi:[1,0,0]
    v_pk_fma_f32 v[172:173], v[156:157], s[8:9], v[248:249] op_sel_hi:[1,1,0] neg_lo:[0,0,1] neg_hi:[0,0,1]
    v_pk_fma_f32 v[188:189], v[156:157], s[8:9], v[250:251] op_sel_hi:[1,1,0] neg_lo:[1,0,0] neg_hi:[1,0,0]
    v_pk_fma_f32 v[174:175], v[158:159], s[8:9], v[248:249] op_sel_hi:[1,1,0] neg_lo:[0,0,1] neg_hi:[0,0,1]
    v_pk_fma_f32 v[190:191], v[158:159], s[8:9], v[250:251] op_sel_hi:[1,1,0] neg_lo:[1,0,0] neg_hi:[1,0,0]
    v_pk_fma_f32 v[176:177], v[160:161], s[8:9], v[248:249] op_sel_hi:[1,1,0] neg_lo:[0,0,1] neg_hi:[0,0,1]
    v_pk_fma_f32 v[192:193], v[160:161], s[8:9], v[250:251] op_sel_hi:[1,1,0] neg_lo:[1,0,0] neg_hi:[1,0,0]
    v_pk_fma_f32 v[178:179], v[162:163], s[8:9], v[248:249] op_sel_hi:[1,1,0] neg_lo:[0,0,1] neg_hi:[0,0,1]
    v_pk_fma_f32 v[194:195], v[162:163], s[8:9], v[250:251] op_sel_hi:[1,1,0] neg_lo:[1,0,0] neg_hi:[1,0,0]
    v_pk_fma_f32 v[180:181], v[164:165], s[8:9], v[248:249] op_sel_hi:[1,1,0] neg_lo:[0,0,1] neg_hi:[0,0,1]
    v_pk_fma_f32 v[196:197], v[164:165], s[8:9], v[250:251] op_sel_hi:[1,1,0] neg_lo:[1,0,0] neg_hi:[1,0,0]
    v_pk_fma_f32 v[182:183], v[166:167], s[8:9], v[248:249] op_sel_hi:[1,1,0] neg_lo:[0,0,1] neg_hi:[0,0,1]
    v_pk_fma_f32 v[198:199], v[166:167], s[8:9], v[250:251] op_sel_hi:[1,1,0] neg_lo:[1,0,0] neg_hi:[1,0,0]
    v_exp_f32 v168, v168
    v_exp_f32 v184, v184
    v_exp_f32 v169, v169
    v_exp_f32 v185, v185
    v_exp_f32 v170, v170
    v_exp_f32 v186, v186
    v_exp_f32 v171, v171
    v_exp_f32 v187, v187
    v_exp_f32 v172, v172
    v_exp_f32 v188, v188
    v_exp_f32 v173, v173
    v_exp_f32 v189, v189
    v_exp_f32 v174, v174
    v_exp_f32 v190, v190
    v_exp_f32 v175, v175
    v_exp_f32 v191, v191
    v_exp_f32 v176, v176
    v_exp_f32 v192, v192
    v_exp_f32 v177, v177
    v_exp_f32 v193, v193
    v_exp_f32 v178, v178
    v_exp_f32 v194, v194
    v_exp_f32 v179, v179
    v_exp_f32 v195, v195
    v_exp_f32 v180, v180
    v_exp_f32 v196, v196
    v_exp_f32 v181, v181
    v_exp_f32 v197, v197
    v_exp_f32 v182, v182
    v_exp_f32 v198, v198
    v_exp_f32 v183, v183
    v_exp_f32 v199, v199
    v_pk_add_f32 v[248:249], v[168:169], v[170:171]
    v_pk_add_f32 v[250:251], v[184:185], v[186:187]
    v_pk_add_f32 v[252:253], v[172:173], v[174:175]
    v_pk_add_f32 v[254:255], v[188:189], v[190:191]
    v_pk_add_f32 v[248:249], v[248:249], v[176:177]
    v_pk_add_f32 v[250:251], v[250:251], v[192:193]
    v_pk_add_f32 v[252:253], v[252:253], v[178:179]
    v_pk_add_f32 v[254:255], v[254:255], v[194:195]
    v_pk_add_f32 v[248:249], v[248:249], v[180:181]
    v_pk_add_f32 v[250:251], v[250:251], v[196:197]
    v_pk_add_f32 v[252:253], v[252:253], v[182:183]
    v_pk_add_f32 v[254:255], v[254:255], v[198:199]
    v_pk_add_f32 v[248:249], v[248:249], v[252:253]
    v_pk_add_f32 v[250:251], v[250:251], v[254:255]
    v_add_f32 v248, v248, v249
    v_add_f32 v250, v250, v251
    v_mov_b32 v252, v248
    v_mov_b32 v254, v250
    s_nop 0
    v_permlane32_swap_b32 v248, v252
    v_permlane32_swap_b32 v250, v254
    v_add_f32 v248, v248, v252
    v_add_f32 v250, v250, v254
    v_rcp_f32 v248, v248
    v_rcp_f32 v250, v250
    v_pk_mul_f32 v[168:169], v[168:169], v[248:249] op_sel_hi:[1,0]
    v_pk_mul_f32 v[184:185], v[184:185], v[250:251] op_sel_hi:[1,0]
    v_pk_mul_f32 v[170:171], v[170:171], v[248:249] op_sel_hi:[1,0]
    v_pk_mul_f32 v[186:187], v[186:187], v[250:251] op_sel_hi:[1,0]
    v_pk_mul_f32 v[172:173], v[172:173], v[248:249] op_sel_hi:[1,0]
    v_pk_mul_f32 v[188:189], v[188:189], v[250:251] op_sel_hi:[1,0]
    v_pk_mul_f32 v[174:175], v[174:175], v[248:249] op_sel_hi:[1,0]
    v_pk_mul_f32 v[190:191], v[190:191], v[250:251] op_sel_hi:[1,0]
    v_pk_mul_f32 v[176:177], v[176:177], v[248:249] op_sel_hi:[1,0]
    v_pk_mul_f32 v[192:193], v[192:193], v[250:251] op_sel_hi:[1,0]
    v_pk_mul_f32 v[178:179], v[178:179], v[248:249] op_sel_hi:[1,0]
    v_pk_mul_f32 v[194:195], v[194:195], v[250:251] op_sel_hi:[1,0]
    v_pk_mul_f32 v[180:181], v[180:181], v[248:249] op_sel_hi:[1,0]
    v_pk_mul_f32 v[196:197], v[196:197], v[250:251] op_sel_hi:[1,0]
    v_pk_mul_f32 v[182:183], v[182:183], v[248:249] op_sel_hi:[1,0]
    v_pk_mul_f32 v[198:199], v[198:199], v[250:251] op_sel_hi:[1,0]
    v_cvt_pk_bf16_f32 v200, v168, v169
    v_cvt_pk_bf16_f32 v208, v184, v185
    v_cvt_pk_bf16_f32 v201, v170, v171
    v_cvt_pk_bf16_f32 v209, v186, v187
    v_cvt_pk_bf16_f32 v202, v172, v173
    v_cvt_pk_bf16_f32 v210, v188, v189
    v_cvt_pk_bf16_f32 v203, v174, v175
    v_cvt_pk_bf16_f32 v211, v190, v191
    v_cvt_pk_bf16_f32 v204, v176, v177
    v_cvt_pk_bf16_f32 v212, v192, v193
    v_cvt_pk_bf16_f32 v205, v178, v179
    v_cvt_pk_bf16_f32 v213, v194, v195
    v_cvt_pk_bf16_f32 v206, v180, v181
    v_cvt_pk_bf16_f32 v214, v196, v197
    v_cvt_pk_bf16_f32 v207, v182, v183
    v_cvt_pk_bf16_f32 v215, v198, v199
    ds_write_b64 v32, v[200:201] offset:4096
    ds_write_b64 v36, v[208:209] offset:4096
    ds_write_b64 v33, v[202:203] offset:4096
    ds_write_b64 v37, v[210:211] offset:4096
    ds_write_b64 v34, v[204:205] offset:4096
    ds_write_b64 v38, v[212:213] offset:4096
    ds_write_b64 v35, v[206:207] offset:4096
    ds_write_b64 v39, v[214:215] offset:4096
    v_cvt_pk_bf16_f32 v144, v128, v129
    v_cvt_pk_bf16_f32 v145, v130, v131
    v_cvt_pk_bf16_f32 v146, v132, v133
    v_cvt_pk_bf16_f32 v147, v134, v135
    v_cvt_pk_bf16_f32 v148, v136, v137
    v_cvt_pk_bf16_f32 v149, v138, v139
    v_cvt_pk_bf16_f32 v150, v140, v141
    v_cvt_pk_bf16_f32 v151, v142, v143
    v_permlane16_swap_b32 v144, v146
    v_permlane16_swap_b32 v145, v147
    v_permlane16_swap_b32 v148, v150
    v_permlane16_swap_b32 v149, v151
    s_waitcnt lgkmcnt(0)
    ds_read_b64_tr_b16 v[168:169], v40 offset:4096
    ds_read_b64_tr_b16 v[170:171], v41 offset:4608
    ds_read_b64_tr_b16 v[172:173], v40 offset:6144
    ds_read_b64_tr_b16 v[174:175], v41 offset:6656
    ds_read_b64_tr_b16 v[176:177], v42 offset:4096
    ds_read_b64_tr_b16 v[178:179], v43 offset:4608
    ds_read_b64_tr_b16 v[180:181], v42 offset:6144
    ds_read_b64_tr_b16 v[182:183], v43 offset:6656
    s_waitcnt lgkmcnt(6)
    v_mfma_f32_32x32x16_bf16 v[216:231], v[168:171], v[144:147], v[216:231]
    v_dot2c_f32_bf16 v22, v168, v21
    v_dot2c_f32_bf16 v22, v169, v21
    v_dot2c_f32_bf16 v22, v170, v21
    v_dot2c_f32_bf16 v22, v171, v21
    s_waitcnt lgkmcnt(4)
    v_mfma_f32_32x32x16_bf16 v[216:231], v[172:175], v[148:151], v[216:231]
    v_dot2c_f32_bf16 v22, v172, v21
    v_dot2c_f32_bf16 v22, v173, v21
    v_dot2c_f32_bf16 v22, v174, v21
    v_dot2c_f32_bf16 v22, v175, v21
    s_waitcnt lgkmcnt(2)
    v_mfma_f32_32x32x16_bf16 v[232:247], v[176:179], v[144:147], v[232:247]
    v_dot2c_f32_bf16 v23, v176, v21
    v_dot2c_f32_bf16 v23, v177, v21
    v_dot2c_f32_bf16 v23, v178, v21
    v_dot2c_f32_bf16 v23, v179, v21
    s_waitcnt lgkmcnt(0)
    v_mfma_f32_32x32x16_bf16 v[232:247], v[180:183], v[148:151], v[232:247]
    v_dot2c_f32_bf16 v23, v180, v21
    v_dot2c_f32_bf16 v23, v181, v21
    v_dot2c_f32_bf16 v23, v182, v21
    v_dot2c_f32_bf16 v23, v183, v21
    v_mov_b32 v248, v22
    s_nop 1
    v_mov_b32 v249, v23
    v_permlane32_swap_b32 v22, v248
    s_nop 0
    v_permlane32_swap_b32 v23, v249
    v_add_f32 v22, v22, v248
    v_add_f32 v23, v23, v249
    v_cmp_eq_u32 vcc, 1, v3
    s_nop 1
    v_cndmask_b32 v22, v22, v23, vcc
    s_lshl_b32 s5, s64, 13
    v_lshl_add_u32 v4, v1, 4, s5
    s_lshl_b32 s5, s64, 8
    s_add_u32 s5, s5, 65536
    v_lshl_add_u32 v5, v1, 2, s5
    ds_write_b32 v5, v22
    ds_write_b128 v4, v[216:219] offset:0
    ds_write_b128 v4, v[220:223] offset:1024
    ds_write_b128 v4, v[224:227] offset:2048
    ds_write_b128 v4, v[228:231] offset:3072
    ds_write_b128 v4, v[232:235] offset:4096
    ds_write_b128 v4, v[236:239] offset:5120
    ds_write_b128 v4, v[240:243] offset:6144
    ds_write_b128 v4, v[244:247] offset:7168
    s_lshl_b32 s5, s77, 13
    s_lshl_b32 s6, s76, 11
    s_add_u32 s5, s5, s6
    v_lshl_add_u32 v4, v1, 4, s5
    s_lshl_b32 s5, s77, 8
    s_add_u32 s5, s5, 65536
    v_lshl_add_u32 v5, v1, 2, s5
    s_lshl_b32 s5, s74, 5
    s_add_u32 s5, s5, s10
    s_lshl_b32 s6, s5, 13
    s_lshl_b32 s7, s76, 11
    s_add_u32 s6, s6, s7
    v_lshlrev_b32 v6, 4, v1
    s_lshl_b32 s7, s5, 8
    s_add_u32 s7, s7, 0x300000
    v_lshlrev_b32 v7, 2, v1
    s_waitcnt lgkmcnt(0)
    s_barrier
    ds_read_b128 v[216:219], v4 offset:0
    ds_read_b128 v[220:223], v4 offset:1024
    ds_read_b128 v[224:227], v4 offset:16384
    ds_read_b128 v[228:231], v4 offset:17408
    ds_read_b128 v[232:235], v4 offset:32768
    ds_read_b128 v[236:239], v4 offset:33792
    ds_read_b128 v[240:243], v4 offset:49152
    ds_read_b128 v[244:247], v4 offset:50176
    ds_read_b32 v200, v5 offset:0
    ds_read_b32 v201, v5 offset:512
    ds_read_b32 v202, v5 offset:1024
    ds_read_b32 v203, v5 offset:1536
    s_waitcnt lgkmcnt(4)
    v_pk_add_f32 v[216:217], v[216:217], v[224:225]
    v_pk_add_f32 v[232:233], v[232:233], v[240:241]
    v_pk_add_f32 v[218:219], v[218:219], v[226:227]
    v_pk_add_f32 v[234:235], v[234:235], v[242:243]
    v_pk_add_f32 v[220:221], v[220:221], v[228:229]
    v_pk_add_f32 v[236:237], v[236:237], v[244:245]
    v_pk_add_f32 v[222:223], v[222:223], v[230:231]
    v_pk_add_f32 v[238:239], v[238:239], v[246:247]
    v_pk_add_f32 v[216:217], v[216:217], v[232:233]
    v_pk_add_f32 v[218:219], v[218:219], v[234:235]
    v_pk_add_f32 v[220:221], v[220:221], v[236:237]
    v_pk_add_f32 v[222:223], v[222:223], v[238:239]
    buffer_store_dwordx4 v[216:219], v6, s[56:59], s6 offen sc1
    buffer_store_dwordx4 v[220:223], v6, s[56:59], s6 offen offset:1024 sc1
    s_waitcnt lgkmcnt(0)
    v_add_f32 v200, v200, v201
    v_add_f32 v202, v202, v203
    v_add_f32 v22, v200, v202
    s_cmp_lg_u32 s76, 0
    s_cbranch_scc1 k1a_noz
    buffer_store_dword v22, v7, s[56:59], s7 offen sc1
k1a_noz:
    v_cvt_pk_bf16_f32 v144, v48, v49
    v_cvt_pk_bf16_f32 v145, v50, v51
    v_cvt_pk_bf16_f32 v148, v52, v53
    v_cvt_pk_bf16_f32 v149, v54, v55
    v_cvt_pk_bf16_f32 v146, v56, v57
    v_cvt_pk_bf16_f32 v147, v58, v59
    v_cvt_pk_bf16_f32 v150, v60, v61
    v_cvt_pk_bf16_f32 v151, v62, v63
    v_permlane16_swap_b32 v144, v146
    v_permlane16_swap_b32 v145, v147
    v_permlane16_swap_b32 v148, v150
    v_permlane16_swap_b32 v149, v151
    v_mfma_f32_32x32x16_bf16 v[152:167], v[24:27], v[144:147], 0
    s_nop 0
    v_mfma_f32_32x32x16_bf16 v[152:167], v[28:31], v[148:151], v[152:167]
    s_nop 11
    v_max3_f32 v248, v152, v153, v154
    v_min3_f32 v250, v152, v153, v154
    v_max3_f32 v248, v248, v155, v156
    v_min3_f32 v250, v250, v155, v156
    v_max3_f32 v248, v248, v157, v158
    v_min3_f32 v250, v250, v157, v158
    v_max3_f32 v248, v248, v159, v160
    v_min3_f32 v250, v250, v159, v160
    v_max3_f32 v248, v248, v161, v162
    v_min3_f32 v250, v250, v161, v162
    v_max3_f32 v248, v248, v163, v164
    v_min3_f32 v250, v250, v163, v164
    v_max3_f32 v248, v248, v165, v166
    v_min3_f32 v250, v250, v165, v166
    v_max_f32 v248, v248, v167
    v_min_f32 v250, v250, v167
    v_mov_b32 v252, v248
    v_mov_b32 v254, v250
    s_nop 0
    v_permlane32_swap_b32 v248, v252
    v_permlane32_swap_b32 v250, v254
    v_max_f32 v248, v248, v252
    v_min_f32 v250, v250, v254
    v_mul_f32 v248, s8, v248
    v_mul_f32 v250, s8, v250
    v_pk_fma_f32 v[168:169], v[152:153], s[8:9], v[248:249] op_sel_hi:[1,1,0] neg_lo:[0,0,1] neg_hi:[0,0,1]
    v_pk_fma_f32 v[184:185], v[152:153], s[8:9], v[250:251] op_sel_hi:[1,1,0] neg_lo:[1,0,0] neg_hi:[1,0,0]
    v_pk_fma_f32 v[170:171], v[154:155], s[8:9], v[248:249] op_sel_hi:[1,1,0] neg_lo:[0,0,1] neg_hi:[0,0,1]
    v_pk_fma_f32 v[186:187], v[154:155], s[8:9], v[250:251] op_sel_hi:[1,1,0] neg_lo:[1,0,0] neg_hi:[1,0,0]
    v_pk_fma_f32 v[172:173], v[156:157], s[8:9], v[248:249] op_sel_hi:[1,1,0] neg_lo:[0,0,1] neg_hi:[0,0,1]
    v_pk_fma_f32 v[188:189], v[156:157], s[8:9], v[250:251] op_sel_hi:[1,1,0] neg_lo:[1,0,0] neg_hi:[1,0,0]
    v_pk_fma_f32 v[174:175], v[158:159], s[8:9], v[248:249] op_sel_hi:[1,1,0] neg_lo:[0,0,1] neg_hi:[0,0,1]
    v_pk_fma_f32 v[190:191], v[158:159], s[8:9], v[250:251] op_sel_hi:[1,1,0] neg_lo:[1,0,0] neg_hi:[1,0,0]
    v_pk_fma_f32 v[176:177], v[160:161], s[8:9], v[248:249] op_sel_hi:[1,1,0] neg_lo:[0,0,1] neg_hi:[0,0,1]
    v_pk_fma_f32 v[192:193], v[160:161], s[8:9], v[250:251] op_sel_hi:[1,1,0] neg_lo:[1,0,0] neg_hi:[1,0,0]
    v_pk_fma_f32 v[178:179], v[162:163], s[8:9], v[248:249] op_sel_hi:[1,1,0] neg_lo:[0,0,1] neg_hi:[0,0,1]
    v_pk_fma_f32 v[194:195], v[162:163], s[8:9], v[250:251] op_sel_hi:[1,1,0] neg_lo:[1,0,0] neg_hi:[1,0,0]
    v_pk_fma_f32 v[180:181], v[164:165], s[8:9], v[248:249] op_sel_hi:[1,1,0] neg_lo:[0,0,1] neg_hi:[0,0,1]
    v_pk_fma_f32 v[196:197], v[164:165], s[8:9], v[250:251] op_sel_hi:[1,1,0] neg_lo:[1,0,0] neg_hi:[1,0,0]
    v_pk_fma_f32 v[182:183], v[166:167], s[8:9], v[248:249] op_sel_hi:[1,1,0] neg_lo:[0,0,1] neg_hi:[0,0,1]
    v_pk_fma_f32 v[198:199], v[166:167], s[8:9], v[250:251] op_sel_hi:[1,1,0] neg_lo:[1,0,0] neg_hi:[1,0,0]
    v_exp_f32 v168, v168
    v_exp_f32 v184, v184
    v_exp_f32 v169, v169
    v_exp_f32 v185, v185
    v_exp_f32 v170, v170
    v_exp_f32 v186, v186
    v_exp_f32 v171, v171
    v_exp_f32 v187, v187
    v_exp_f32 v172, v172
    v_exp_f32 v188, v188
    v_exp_f32 v173, v173
    v_exp_f32 v189, v189
    v_exp_f32 v174, v174
    v_exp_f32 v190, v190
    v_exp_f32 v175, v175
    v_exp_f32 v191, v191
    v_exp_f32 v176, v176
    v_exp_f32 v192, v192
    v_exp_f32 v177, v177
    v_exp_f32 v193, v193
    v_exp_f32 v178, v178
    v_exp_f32 v194, v194
    v_exp_f32 v179, v179
    v_exp_f32 v195, v195
    v_exp_f32 v180, v180
    v_exp_f32 v196, v196
    v_exp_f32 v181, v181
    v_exp_f32 v197, v197
    v_exp_f32 v182, v182
    v_exp_f32 v198, v198
    v_exp_f32 v183, v183
    v_exp_f32 v199, v199
    v_pk_add_f32 v[248:249], v[168:169], v[170:171]
    v_pk_add_f32 v[250:251], v[184:185], v[186:187]
    v_pk_add_f32 v[252:253], v[172:173], v[174:175]
    v_pk_add_f32 v[254:255], v[188:189], v[190:191]
    v_pk_add_f32 v[248:249], v[248:249], v[176:177]
    v_pk_add_f32 v[250:251], v[250:251], v[192:193]
    v_pk_add_f32 v[252:253], v[252:253], v[178:179]
    v_pk_add_f32 v[254:255], v[254:255], v[194:195]
    v_pk_add_f32 v[248:249], v[248:249], v[180:181]
    v_pk_add_f32 v[250:251], v[250:251], v[196:197]
    v_pk_add_f32 v[252:253], v[252:253], v[182:183]
    v_pk_add_f32 v[254:255], v[254:255], v[198:199]
    v_pk_add_f32 v[248:249], v[248:249], v[252:253]
    v_pk_add_f32 v[250:251], v[250:251], v[254:255]
    v_add_f32 v248, v248, v249
    v_add_f32 v250, v250, v251
    v_mov_b32 v252, v248
    v_mov_b32 v254, v250
    s_nop 0
    v_permlane32_swap_b32 v248, v252
    v_permlane32_swap_b32 v250, v254
    v_add_f32 v248, v248, v252
    v_add_f32 v250, v250, v254
    v_rcp_f32 v248, v248
    v_rcp_f32 v250, v250
    v_pk_mul_f32 v[168:169], v[168:169], v[248:249] op_sel_hi:[1,0]
    v_pk_mul_f32 v[184:185], v[184:185], v[250:251] op_sel_hi:[1,0]
    v_pk_mul_f32 v[170:171], v[170:171], v[248:249] op_sel_hi:[1,0]
    v_pk_mul_f32 v[186:187], v[186:187], v[250:251] op_sel_hi:[1,0]
    v_pk_mul_f32 v[172:173], v[172:173], v[248:249] op_sel_hi:[1,0]
    v_pk_mul_f32 v[188:189], v[188:189], v[250:251] op_sel_hi:[1,0]
    v_pk_mul_f32 v[174:175], v[174:175], v[248:249] op_sel_hi:[1,0]
    v_pk_mul_f32 v[190:191], v[190:191], v[250:251] op_sel_hi:[1,0]
    v_pk_mul_f32 v[176:177], v[176:177], v[248:249] op_sel_hi:[1,0]
    v_pk_mul_f32 v[192:193], v[192:193], v[250:251] op_sel_hi:[1,0]
    v_pk_mul_f32 v[178:179], v[178:179], v[248:249] op_sel_hi:[1,0]
    v_pk_mul_f32 v[194:195], v[194:195], v[250:251] op_sel_hi:[1,0]
    v_pk_mul_f32 v[180:181], v[180:181], v[248:249] op_sel_hi:[1,0]
    v_pk_mul_f32 v[196:197], v[196:197], v[250:251] op_sel_hi:[1,0]
    v_pk_mul_f32 v[182:183], v[182:183], v[248:249] op_sel_hi:[1,0]
    v_pk_mul_f32 v[198:199], v[198:199], v[250:251] op_sel_hi:[1,0]
    v_cvt_pk_bf16_f32 v80, v168, v169
    v_cvt_pk_bf16_f32 v88, v184, v185
    v_cvt_pk_bf16_f32 v81, v170, v171
    v_cvt_pk_bf16_f32 v89, v186, v187
    v_cvt_pk_bf16_f32 v82, v172, v173
    v_cvt_pk_bf16_f32 v90, v188, v189
    v_cvt_pk_bf16_f32 v83, v174, v175
    v_cvt_pk_bf16_f32 v91, v190, v191
    v_cvt_pk_bf16_f32 v84, v176, v177
    v_cvt_pk_bf16_f32 v92, v192, v193
    v_cvt_pk_bf16_f32 v85, v178, v179
    v_cvt_pk_bf16_f32 v93, v194, v195
    v_cvt_pk_bf16_f32 v86, v180, v181
    v_cvt_pk_bf16_f32 v94, v196, v197
    v_cvt_pk_bf16_f32 v87, v182, v183
    v_cvt_pk_bf16_f32 v95, v198, v199
    s_waitcnt vmcnt(0)
    s_barrier
    s_cmp_lg_u32 s64, 0
    s_cbranch_scc1 k1a_nosig1
    s_mov_b64 exec, 1
    global_atomic_add v44, v45, s[44:45] sc1
    s_mov_b64 exec, -1
k1a_nosig1:
    v_cvt_pk_bf16_f32 v144, v64, v65
    v_cvt_pk_bf16_f32 v145, v66, v67
    v_cvt_pk_bf16_f32 v148, v68, v69
    v_cvt_pk_bf16_f32 v149, v70, v71
    v_cvt_pk_bf16_f32 v146, v72, v73
    v_cvt_pk_bf16_f32 v147, v74, v75
    v_cvt_pk_bf16_f32 v150, v76, v77
    v_cvt_pk_bf16_f32 v151, v78, v79
    v_permlane16_swap_b32 v144, v146
    v_permlane16_swap_b32 v145, v147
    v_permlane16_swap_b32 v148, v150
    v_permlane16_swap_b32 v149, v151
    v_mfma_f32_32x32x16_bf16 v[152:167], v[24:27], v[144:147], 0
    s_nop 0
    v_mfma_f32_32x32x16_bf16 v[152:167], v[28:31], v[148:151], v[152:167]
    s_nop 11
    v_max3_f32 v248, v152, v153, v154
    v_min3_f32 v250, v152, v153, v154
    v_max3_f32 v248, v248, v155, v156
    v_min3_f32 v250, v250, v155, v156
    v_max3_f32 v248, v248, v157, v158
    v_min3_f32 v250, v250, v157, v158
    v_max3_f32 v248, v248, v159, v160
    v_min3_f32 v250, v250, v159, v160
    v_max3_f32 v248, v248, v161, v162
    v_min3_f32 v250, v250, v161, v162
    v_max3_f32 v248, v248, v163, v164
    v_min3_f32 v250, v250, v163, v164
    v_max3_f32 v248, v248, v165, v166
    v_min3_f32 v250, v250, v165, v166
    v_max_f32 v248, v248, v167
    v_min_f32 v250, v250, v167
    v_mov_b32 v252, v248
    v_mov_b32 v254, v250
    s_nop 0
    v_permlane32_swap_b32 v248, v252
    v_permlane32_swap_b32 v250, v254
    v_max_f32 v248, v248, v252
    v_min_f32 v250, v250, v254
    v_mul_f32 v248, s8, v248
    v_mul_f32 v250, s8, v250
    v_pk_fma_f32 v[168:169], v[152:153], s[8:9], v[248:249] op_sel_hi:[1,1,0] neg_lo:[0,0,1] neg_hi:[0,0,1]
    v_pk_fma_f32 v[184:185], v[152:153], s[8:9], v[250:251] op_sel_hi:[1,1,0] neg_lo:[1,0,0] neg_hi:[1,0,0]
    v_pk_fma_f32 v[170:171], v[154:155], s[8:9], v[248:249] op_sel_hi:[1,1,0] neg_lo:[0,0,1] neg_hi:[0,0,1]
    v_pk_fma_f32 v[186:187], v[154:155], s[8:9], v[250:251] op_sel_hi:[1,1,0] neg_lo:[1,0,0] neg_hi:[1,0,0]
    v_pk_fma_f32 v[172:173], v[156:157], s[8:9], v[248:249] op_sel_hi:[1,1,0] neg_lo:[0,0,1] neg_hi:[0,0,1]
    v_pk_fma_f32 v[188:189], v[156:157], s[8:9], v[250:251] op_sel_hi:[1,1,0] neg_lo:[1,0,0] neg_hi:[1,0,0]
    v_pk_fma_f32 v[174:175], v[158:159], s[8:9], v[248:249] op_sel_hi:[1,1,0] neg_lo:[0,0,1] neg_hi:[0,0,1]
    v_pk_fma_f32 v[190:191], v[158:159], s[8:9], v[250:251] op_sel_hi:[1,1,0] neg_lo:[1,0,0] neg_hi:[1,0,0]
    v_pk_fma_f32 v[176:177], v[160:161], s[8:9], v[248:249] op_sel_hi:[1,1,0] neg_lo:[0,0,1] neg_hi:[0,0,1]
    v_pk_fma_f32 v[192:193], v[160:161], s[8:9], v[250:251] op_sel_hi:[1,1,0] neg_lo:[1,0,0] neg_hi:[1,0,0]
    v_pk_fma_f32 v[178:179], v[162:163], s[8:9], v[248:249] op_sel_hi:[1,1,0] neg_lo:[0,0,1] neg_hi:[0,0,1]
    v_pk_fma_f32 v[194:195], v[162:163], s[8:9], v[250:251] op_sel_hi:[1,1,0] neg_lo:[1,0,0] neg_hi:[1,0,0]
    v_pk_fma_f32 v[180:181], v[164:165], s[8:9], v[248:249] op_sel_hi:[1,1,0] neg_lo:[0,0,1] neg_hi:[0,0,1]
    v_pk_fma_f32 v[196:197], v[164:165], s[8:9], v[250:251] op_sel_hi:[1,1,0] neg_lo:[1,0,0] neg_hi:[1,0,0]
    v_pk_fma_f32 v[182:183], v[166:167], s[8:9], v[248:249] op_sel_hi:[1,1,0] neg_lo:[0,0,1] neg_hi:[0,0,1]
    v_pk_fma_f32 v[198:199], v[166:167], s[8:9], v[250:251] op_sel_hi:[1,1,0] neg_lo:[1,0,0] neg_hi:[1,0,0]
    v_exp_f32 v168, v168
    v_exp_f32 v184, v184
    v_exp_f32 v169, v169
    v_exp_f32 v185, v185
    v_exp_f32 v170, v170
    v_exp_f32 v186, v186
    v_exp_f32 v171, v171
    v_exp_f32 v187, v187
    v_exp_f32 v172, v172
    v_exp_f32 v188, v188
    v_exp_f32 v173, v173
    v_exp_f32 v189, v189
    v_exp_f32 v174, v174
    v_exp_f32 v190, v190
    v_exp_f32 v175, v175
    v_exp_f32 v191, v191
    v_exp_f32 v176, v176
    v_exp_f32 v192, v192
    v_exp_f32 v177, v177
    v_exp_f32 v193, v193
    v_exp_f32 v178, v178
    v_exp_f32 v194, v194
    v_exp_f32 v179, v179
    v_exp_f32 v195, v195
    v_exp_f32 v180, v180
    v_exp_f32 v196, v196
    v_exp_f32 v181, v181
    v_exp_f32 v197, v197
    v_exp_f32 v182, v182
    v_exp_f32 v198, v198
    v_exp_f32 v183, v183
    v_exp_f32 v199, v199
    v_pk_add_f32 v[248:249], v[168:169], v[170:171]
    v_pk_add_f32 v[250:251], v[184:185], v[186:187]
    v_pk_add_f32 v[252:253], v[172:173], v[174:175]
    v_pk_add_f32 v[254:255], v[188:189], v[190:191]
    v_pk_add_f32 v[248:249], v[248:249], v[176:177]
    v_pk_add_f32 v[250:251], v[250:251], v[192:193]
    v_pk_add_f32 v[252:253], v[252:253], v[178:179]
    v_pk_add_f32 v[254:255], v[254:255], v[194:195]
    v_pk_add_f32 v[248:249], v[248:249], v[180:181]
    v_pk_add_f32 v[250:251], v[250:251], v[196:197]
    v_pk_add_f32 v[252:253], v[252:253], v[182:183]
    v_pk_add_f32 v[254:255], v[254:255], v[198:199]
    v_pk_add_f32 v[248:249], v[248:249], v[252:253]
    v_pk_add_f32 v[250:251], v[250:251], v[254:255]
    v_add_f32 v248, v248, v249
    v_add_f32 v250, v250, v251
    v_mov_b32 v252, v248
    v_mov_b32 v254, v250
    s_nop 0
    v_permlane32_swap_b32 v248, v252
    v_permlane32_swap_b32 v250, v254
    v_add_f32 v248, v248, v252
    v_add_f32 v250, v250, v254
    v_rcp_f32 v248, v248
    v_rcp_f32 v250, v250
    v_pk_mul_f32 v[168:169], v[168:169], v[248:249] op_sel_hi:[1,0]
    v_pk_mul_f32 v[184:185], v[184:185], v[250:251] op_sel_hi:[1,0]
    v_pk_mul_f32 v[170:171], v[170:171], v[248:249] op_sel_hi:[1,0]
    v_pk_mul_f32 v[186:187], v[186:187], v[250:251] op_sel_hi:[1,0]
    v_pk_mul_f32 v[172:173], v[172:173], v[248:249] op_sel_hi:[1,0]
    v_pk_mul_f32 v[188:189], v[188:189], v[250:251] op_sel_hi:[1,0]
    v_pk_mul_f32 v[174:175], v[174:175], v[248:249] op_sel_hi:[1,0]
    v_pk_mul_f32 v[190:191], v[190:191], v[250:251] op_sel_hi:[1,0]
    v_pk_mul_f32 v[176:177], v[176:177], v[248:249] op_sel_hi:[1,0]
    v_pk_mul_f32 v[192:193], v[192:193], v[250:251] op_sel_hi:[1,0]
    v_pk_mul_f32 v[178:179], v[178:179], v[248:249] op_sel_hi:[1,0]
    v_pk_mul_f32 v[194:195], v[194:195], v[250:251] op_sel_hi:[1,0]
    v_pk_mul_f32 v[180:181], v[180:181], v[248:249] op_sel_hi:[1,0]
    v_pk_mul_f32 v[196:197], v[196:197], v[250:251] op_sel_hi:[1,0]
    v_pk_mul_f32 v[182:183], v[182:183], v[248:249] op_sel_hi:[1,0]
    v_pk_mul_f32 v[198:199], v[198:199], v[250:251] op_sel_hi:[1,0]
    v_cvt_pk_bf16_f32 v96, v168, v169
    v_cvt_pk_bf16_f32 v104, v184, v185
    v_cvt_pk_bf16_f32 v97, v170, v171
    v_cvt_pk_bf16_f32 v105, v186, v187
    v_cvt_pk_bf16_f32 v98, v172, v173
    v_cvt_pk_bf16_f32 v106, v188, v189
    v_cvt_pk_bf16_f32 v99, v174, v175
    v_cvt_pk_bf16_f32 v107, v190, v191
    v_cvt_pk_bf16_f32 v100, v176, v177
    v_cvt_pk_bf16_f32 v108, v192, v193
    v_cvt_pk_bf16_f32 v101, v178, v179
    v_cvt_pk_bf16_f32 v109, v194, v195
    v_cvt_pk_bf16_f32 v102, v180, v181
    v_cvt_pk_bf16_f32 v110, v196, v197
    v_cvt_pk_bf16_f32 v103, v182, v183
    v_cvt_pk_bf16_f32 v111, v198, v199
    s_cmp_lg_u32 s64, 0
    s_cbranch_scc1 k1a_poll_done
    s_mov_b32 s5, 0
k1a_poll_loop:
    global_load_dword v4, v44, s[44:45] sc1
    s_waitcnt vmcnt(0)
    v_readfirstlane_b32 s6, v4
    s_nop 3
    s_cmp_ge_u32 s6, 8
    s_cbranch_scc1 k1a_poll_ok
    s_sleep 1
    s_add_u32 s5, s5, 1
    s_cmp_lt_u32 s5, 2097152
    s_cbranch_scc1 k1a_poll_loop
k1a_poll_ok:
k1a_poll_done:
    s_barrier
    s_lshl_b32 s6, s10, 13
    s_lshl_b32 s7, s76, 11
    s_add_u32 s6, s6, s7
    buffer_load_dwordx4 v[144:147], v6, s[56:59], s6 offen sc1
    buffer_load_dwordx4 v[148:151], v6, s[56:59], s6 offen offset:1024 sc1
    s_add_u32 s6, s6, 0x40000
    buffer_load_dwordx4 v[152:155], v6, s[56:59], s6 offen sc1
    buffer_load_dwordx4 v[156:159], v6, s[56:59], s6 offen offset:1024 sc1
    s_add_u32 s6, s6, 0x40000
    buffer_load_dwordx4 v[160:163], v6, s[56:59], s6 offen sc1
    buffer_load_dwordx4 v[164:167], v6, s[56:59], s6 offen offset:1024 sc1
    s_add_u32 s6, s6, 0x40000
    buffer_load_dwordx4 v[168:171], v6, s[56:59], s6 offen sc1
    buffer_load_dwordx4 v[172:175], v6, s[56:59], s6 offen offset:1024 sc1
    s_add_u32 s6, s6, 0x40000
    buffer_load_dwordx4 v[176:179], v6, s[56:59], s6 offen sc1
    buffer_load_dwordx4 v[180:183], v6, s[56:59], s6 offen offset:1024 sc1
    s_add_u32 s6, s6, 0x40000
    buffer_load_dwordx4 v[184:187], v6, s[56:59], s6 offen sc1
    buffer_load_dwordx4 v[188:191], v6, s[56:59], s6 offen offset:1024 sc1
    s_add_u32 s6, s6, 0x40000
    buffer_load_dwordx4 v[192:195], v6, s[56:59], s6 offen sc1
    buffer_load_dwordx4 v[196:199], v6, s[56:59], s6 offen offset:1024 sc1
    s_add_u32 s6, s6, 0x40000
    buffer_load_dwordx4 v[200:203], v6, s[56:59], s6 offen sc1
    buffer_load_dwordx4 v[204:207], v6, s[56:59], s6 offen offset:1024 sc1
    s_lshl_b32 s7, s10, 8
    s_add_u32 s7, s7, 0x300000
    buffer_load_dword v208, v7, s[56:59], s7 offen sc1
    s_add_u32 s7, s7, 0x2000
    buffer_load_dword v209, v7, s[56:59], s7 offen sc1
    s_add_u32 s7, s7, 0x2000
    buffer_load_dword v210, v7, s[56:59], s7 offen sc1
    s_add_u32 s7, s7, 0x2000
    buffer_load_dword v211, v7, s[56:59], s7 offen sc1
    s_add_u32 s7, s7, 0x2000
    buffer_load_dword v212, v7, s[56:59], s7 offen sc1
    s_add_u32 s7, s7, 0x2000
    buffer_load_dword v213, v7, s[56:59], s7 offen sc1
    s_add_u32 s7, s7, 0x2000
    buffer_load_dword v214, v7, s[56:59], s7 offen sc1
    s_add_u32 s7, s7, 0x2000
    buffer_load_dword v215, v7, s[56:59], s7 offen sc1
    s_lshl_b32 s5, s77, 12
    v_lshl_add_u32 v4, v1, 4, s5
    s_lshl_b32 s6, s76, 10
    v_add_u32 v5, s6, v4
    s_lshl_b32 s5, s76, 13
    s_lshl_b32 s6, s77, 2
    v_or_b32 v248, s6, v3
    v_and_b32 v249, 7, v2
    v_xor_b32 v248, v248, v249
    v_lshlrev_b32 v248, 4, v248
    v_lshl_add_u32 v248, v2, 7, v248
    v_add_u32 v13, s5, v248
    v_xor_b32 v14, 32, v13
    s_waitcnt vmcnt(8)
    v_pk_add_f32 v[144:145], v[144:145], v[152:153]
    v_pk_add_f32 v[160:161], v[160:161], v[168:169]
    v_pk_add_f32 v[176:177], v[176:177], v[184:185]
    v_pk_add_f32 v[192:193], v[192:193], v[200:201]
    v_pk_add_f32 v[146:147], v[146:147], v[154:155]
    v_pk_add_f32 v[162:163], v[162:163], v[170:171]
    v_pk_add_f32 v[178:179], v[178:179], v[186:187]
    v_pk_add_f32 v[194:195], v[194:195], v[202:203]
    v_pk_add_f32 v[148:149], v[148:149], v[156:157]
    v_pk_add_f32 v[164:165], v[164:165], v[172:173]
    v_pk_add_f32 v[180:181], v[180:181], v[188:189]
    v_pk_add_f32 v[196:197], v[196:197], v[204:205]
    v_pk_add_f32 v[150:151], v[150:151], v[158:159]
    v_pk_add_f32 v[166:167], v[166:167], v[174:175]
    v_pk_add_f32 v[182:183], v[182:183], v[190:191]
    v_pk_add_f32 v[198:199], v[198:199], v[206:207]
    v_pk_add_f32 v[144:145], v[144:145], v[160:161]
    v_pk_add_f32 v[176:177], v[176:177], v[192:193]
    v_pk_add_f32 v[146:147], v[146:147], v[162:163]
    v_pk_add_f32 v[178:179], v[178:179], v[194:195]
    v_pk_add_f32 v[148:149], v[148:149], v[164:165]
    v_pk_add_f32 v[180:181], v[180:181], v[196:197]
    v_pk_add_f32 v[150:151], v[150:151], v[166:167]
    v_pk_add_f32 v[182:183], v[182:183], v[198:199]
    v_pk_add_f32 v[144:145], v[144:145], v[176:177]
    v_pk_add_f32 v[146:147], v[146:147], v[178:179]
    v_pk_add_f32 v[148:149], v[148:149], v[180:181]
    v_pk_add_f32 v[150:151], v[150:151], v[182:183]
    v_cvt_pk_bf16_f32 v152, v144, v145
    v_cvt_pk_bf16_f32 v153, v146, v147
    v_cvt_pk_bf16_f32 v154, v148, v149
    v_cvt_pk_bf16_f32 v155, v150, v151
    ds_write_b128 v5, v[152:155]
    s_waitcnt vmcnt(0)
    v_pk_add_f32 v[208:209], v[208:209], v[210:211]
    v_pk_add_f32 v[212:213], v[212:213], v[214:215]
    v_pk_add_f32 v[208:209], v[208:209], v[212:213]
    v_add_f32 v208, v208, v209
    v_cvt_pk_bf16_f32 v208, v208, v208
    s_lshl_b32 s5, s77, 7
    s_add_u32 s5, s5, 8192
    v_lshl_add_u32 v5, v1, 1, s5
    ds_write_b16 v5, v208
    v_lshl_add_u32 v5, v3, 3, s5
    s_lshl_b32 s5, s10, 6
    s_add_u32 s6, s5, 0x10000
    s_waitcnt lgkmcnt(0)
    s_barrier
    ds_read_b128 v[144:147], v4 offset:0
    ds_read_b64 v[160:161], v5 offset:0
    ds_read_b64 v[162:163], v5 offset:16
    ds_read_b128 v[148:151], v4 offset:1024
    ds_read_b64 v[164:165], v5 offset:32
    ds_read_b64 v[166:167], v5 offset:48
    ds_read_b128 v[152:155], v4 offset:2048
    ds_read_b64 v[168:169], v5 offset:64
    ds_read_b64 v[170:171], v5 offset:80
    ds_read_b128 v[156:159], v4 offset:3072
    ds_read_b64 v[172:173], v5 offset:96
    ds_read_b64 v[174:175], v5 offset:112
    s_waitcnt lgkmcnt(9)
    v_mfma_f32_32x32x16_bf16 v[208:223], v[160:163], v[80:83], 0
    v_mfma_f32_32x32x16_bf16 v[176:191], v[144:147], v[80:83], 0
    v_mfma_f32_32x32x16_bf16 v[224:239], v[160:163], v[96:99], 0
    v_mfma_f32_32x32x16_bf16 v[192:207], v[144:147], v[96:99], 0
    s_waitcnt lgkmcnt(6)
    v_mfma_f32_32x32x16_bf16 v[208:223], v[164:167], v[84:87], v[208:223]
    v_mfma_f32_32x32x16_bf16 v[176:191], v[148:151], v[84:87], v[176:191]
    v_mfma_f32_32x32x16_bf16 v[224:239], v[164:167], v[100:103], v[224:239]
    v_mfma_f32_32x32x16_bf16 v[192:207], v[148:151], v[100:103], v[192:207]
    s_waitcnt lgkmcnt(3)
    v_mfma_f32_32x32x16_bf16 v[208:223], v[168:171], v[88:91], v[208:223]
    v_mfma_f32_32x32x16_bf16 v[176:191], v[152:155], v[88:91], v[176:191]
    v_mfma_f32_32x32x16_bf16 v[224:239], v[168:171], v[104:107], v[224:239]
    v_mfma_f32_32x32x16_bf16 v[192:207], v[152:155], v[104:107], v[192:207]
    s_waitcnt lgkmcnt(0)
    v_mfma_f32_32x32x16_bf16 v[208:223], v[172:175], v[92:95], v[208:223]
    v_mfma_f32_32x32x16_bf16 v[176:191], v[156:159], v[92:95], v[176:191]
    v_mfma_f32_32x32x16_bf16 v[224:239], v[172:175], v[108:111], v[224:239]
    v_mfma_f32_32x32x16_bf16 v[192:207], v[156:159], v[108:111], v[192:207]
    s_nop 8
    v_add_f32 v208, 0x358637bd, v208
    v_rcp_f32 v208, v208
    s_nop 0
    v_pk_mul_f32 v[176:177], v[176:177], v[208:209] op_sel_hi:[1,0]
    v_pk_mul_f32 v[178:179], v[178:179], v[208:209] op_sel_hi:[1,0]
    v_pk_mul_f32 v[180:181], v[180:181], v[208:209] op_sel_hi:[1,0]
    v_pk_mul_f32 v[182:183], v[182:183], v[208:209] op_sel_hi:[1,0]
    v_pk_mul_f32 v[184:185], v[184:185], v[208:209] op_sel_hi:[1,0]
    v_pk_mul_f32 v[186:187], v[186:187], v[208:209] op_sel_hi:[1,0]
    v_pk_mul_f32 v[188:189], v[188:189], v[208:209] op_sel_hi:[1,0]
    v_pk_mul_f32 v[190:191], v[190:191], v[208:209] op_sel_hi:[1,0]
    v_cvt_pk_bf16_f32 v212, v176, v177
    v_cvt_pk_bf16_f32 v213, v178, v179
    v_cvt_pk_bf16_f32 v214, v180, v181
    v_cvt_pk_bf16_f32 v215, v182, v183
    v_cvt_pk_bf16_f32 v216, v184, v185
    v_cvt_pk_bf16_f32 v217, v186, v187
    v_cvt_pk_bf16_f32 v218, v188, v189
    v_cvt_pk_bf16_f32 v219, v190, v191
    v_permlane32_swap_b32 v212, v214
    v_permlane32_swap_b32 v213, v215
    ds_write_b128 v13, v[212:215] offset:16384
    v_permlane32_swap_b32 v216, v218
    v_permlane32_swap_b32 v217, v219
    ds_write_b128 v14, v[216:219] offset:16384
    v_add_f32 v224, 0x358637bd, v224
    v_rcp_f32 v224, v224
    s_nop 0
    v_pk_mul_f32 v[192:193], v[192:193], v[224:225] op_sel_hi:[1,0]
    v_pk_mul_f32 v[194:195], v[194:195], v[224:225] op_sel_hi:[1,0]
    v_pk_mul_f32 v[196:197], v[196:197], v[224:225] op_sel_hi:[1,0]
    v_pk_mul_f32 v[198:199], v[198:199], v[224:225] op_sel_hi:[1,0]
    v_pk_mul_f32 v[200:201], v[200:201], v[224:225] op_sel_hi:[1,0]
    v_pk_mul_f32 v[202:203], v[202:203], v[224:225] op_sel_hi:[1,0]
    v_pk_mul_f32 v[204:205], v[204:205], v[224:225] op_sel_hi:[1,0]
    v_pk_mul_f32 v[206:207], v[206:207], v[224:225] op_sel_hi:[1,0]
    v_cvt_pk_bf16_f32 v228, v192, v193
    v_cvt_pk_bf16_f32 v229, v194, v195
    v_cvt_pk_bf16_f32 v230, v196, v197
    v_cvt_pk_bf16_f32 v231, v198, v199
    v_cvt_pk_bf16_f32 v232, v200, v201
    v_cvt_pk_bf16_f32 v233, v202, v203
    v_cvt_pk_bf16_f32 v234, v204, v205
    v_cvt_pk_bf16_f32 v235, v206, v207
    v_permlane32_swap_b32 v228, v230
    v_permlane32_swap_b32 v229, v231
    ds_write_b128 v13, v[228:231] offset:20480
    v_permlane32_swap_b32 v232, v234
    v_permlane32_swap_b32 v233, v235
    ds_write_b128 v14, v[232:235] offset:20480
    s_waitcnt lgkmcnt(0)
    s_barrier
    ds_read_b128 v[144:147], v47 offset:16384
    ds_read_b128 v[148:151], v47 offset:17408
    ds_read_b128 v[152:155], v47 offset:18432
    ds_read_b128 v[156:159], v47 offset:19456
    s_mov_b32 s5, 0x0
    s_waitcnt lgkmcnt(3)
    buffer_store_dwordx4 v[144:147], v46, s[60:63], s5 offen sc1
    s_mov_b32 s5, 0x4000
    s_waitcnt lgkmcnt(2)
    buffer_store_dwordx4 v[148:151], v46, s[60:63], s5 offen sc1
    s_mov_b32 s5, 0x8000
    s_waitcnt lgkmcnt(1)
    buffer_store_dwordx4 v[152:155], v46, s[60:63], s5 offen sc1
    s_mov_b32 s5, 0xc000
    s_waitcnt lgkmcnt(0)
    buffer_store_dwordx4 v[156:159], v46, s[60:63], s5 offen sc1
    s_lshl_b32 s5, s74, 2
    s_add_u32 s5, s5, 160
    v_mov_b32 v34, s5
    v_mov_b32 v35, 1
    s_waitcnt vmcnt(0) lgkmcnt(0)
    s_barrier
    s_cmp_lt_u32 s64, 4
    s_cbranch_scc1 hoa_go
    s_endpgm
hoa_go:
    s_cmp_lg_u32 s64, 0
    s_cbranch_scc1 hoa_nosig
    s_mov_b64 exec, 1
    global_atomic_add v34, v35, s[44:45] sc1
    s_mov_b64 exec, -1
hoa_nosig:
    s_lshl_b32 s74, s74, 1
    s_and_b32 s5, s75, 1
    s_add_u32 s74, s74, s5
    s_lshr_b32 s75, s75, 1
    s_and_b32 s5, s2, 7
    s_lshl_b32 s11, s5, 1
    s_lshl_b32 s72, s64, 12
    s_add_u32 s73, s72, 16384
    s_lshl_b32 s70, s11, 7
    s_mov_b32 s71, s70
    s_mov_b32 s10, 0
    s_lshl_b32 s69, s76, 13
    v_bfe_u32 v4, v1, 1, 3
    v_and_b32 v5, 15, v1
    v_lshlrev_b32 v5, 7, v5
    v_add_u32 v5, s69, v5
    v_lshrrev_b32 v8, 4, v1
    v_xor_b32 v8, v8, v4
    v_lshl_add_u32 v8, v8, 4, v5
    v_lshrrev_b32 v9, 4, v1
    v_or_b32 v9, 4, v9
    v_xor_b32 v9, v9, v4
    v_lshl_add_u32 v9, v9, 4, v5
    s_lshl_b32 s5, s74, 7
    s_lshl_b32 s6, s76, 6
    s_add_u32 s5, s5, s6
    s_lshl_b32 s6, s75, 7
    s_lshl_b32 s7, s77, 6
    s_add_u32 s6, s6, s7
    v_lshrrev_b32 v4, 4, v1
    v_add_u32 v4, s5, v4
    v_and_b32 v5, 15, v1
    v_lshl_add_u32 v5, v5, 2, s6
    v_lshlrev_b32 v24, 13, v4
    v_lshl_add_u32 v24, v5, 2, v24
    v_lshlrev_b32 v25, 11, v4
    v_lshl_add_u32 v25, v5, 1, v25
    v_lshlrev_b32 v6, 1, v5
    s_lshl_b32 s5, s64, 14
    v_lshrrev_b32 v26, 4, v1
    v_lshlrev_b32 v26, 10, v26
    v_and_b32 v27, 15, v1
    v_lshl_add_u32 v26, v27, 2, v26
    v_add_u32 v26, s5, v26
    v_lshl_add_u32 v27, v1, 4, s5
    s_mov_b32 s56, s42
    s_and_b32 s57, s43, 0xffff
    s_mov_b32 s58, 0x1000000
    s_mov_b32 s59, 0x00020000
    s_mov_b32 s48, s46
    s_and_b32 s49, s47, 0xffff
    s_mov_b32 s50, 0x400000
    s_mov_b32 s51, 0x00020000
    s_mov_b32 s52, s22
    s_and_b32 s53, s23, 0xffff
    s_mov_b32 s54, 0x200000
    s_mov_b32 s55, 0x00020000
    s_lshl_b32 s71, s11, 17
    s_lshl_b32 s5, s74, 7
    s_lshl_b32 s78, s64, 5
    s_add_u32 s78, s78, s5
    v_lshrrev_b32 v4, 3, v1
    v_add_u32 v4, s78, v4
    v_lshlrev_b32 v4, 11, v4
    v_lshrrev_b32 v5, 4, v1
    v_and_b32 v6, 7, v1
    v_xor_b32 v5, v5, v6
    v_xor_b32 v6, 0, v5
    v_lshl_add_u32 v16, v6, 4, v4
    v_xor_b32 v6, 4, v5
    v_lshl_add_u32 v17, v6, 4, v4
    v_add_u32 v17, 0x3c00, v17
    v_xor_b32 v6, 0, v5
    v_lshl_add_u32 v18, v6, 4, v4
    v_add_u32 v18, 0x7800, v18
    v_xor_b32 v6, 4, v5
    v_lshl_add_u32 v19, v6, 4, v4
    v_add_u32 v19, 0xb400, v19
    s_lshl_b32 s5, s77, 5
    v_lshrrev_b32 v4, 3, v1
    v_add_u32 v4, s5, v4
    v_lshlrev_b32 v4, 11, v4
    s_lshl_b32 s5, s75, 8
    s_lshl_b32 s6, s76, 7
    s_add_u32 s5, s5, s6
    v_add_u32 v4, s5, v4
    v_bfe_u32 v5, v1, 4, 1
    v_lshlrev_b32 v5, 1, v5
    v_and_b32 v6, 7, v1
    v_xor_b32 v5, v5, v6
    v_lshl_add_u32 v20, v5, 4, v4
    v_xor_b32 v6, 4, v5
    v_lshl_add_u32 v21, v6, 4, v4
    v_add_u32 v21, 0x3c00, v21
    v_lshl_add_u32 v22, v5, 4, v4
    v_add_u32 v22, 0x7800, v22
    v_xor_b32 v6, 4, v5
    v_lshl_add_u32 v23, v6, 4, v4
    v_add_u32 v23, 0xb400, v23
    s_lshl_b32 s69, s77, 13
    v_lshrrev_b32 v4, 4, v1
    v_lshlrev_b32 v12, 10, v4
    v_bfe_u32 v4, v1, 2, 2
    v_lshl_add_u32 v12, v4, 7, v12
    v_bfe_u32 v4, v1, 3, 2
    v_lshl_add_u32 v12, v4, 5, v12
    v_and_b32 v4, 3, v1
    v_lshl_add_u32 v12, v4, 3, v12
    v_add_u32 v12, s69, v12
    v_add_u32 v12, 0x4000, v12
    v_xor_b32 v13, 32, v12
    v_xor_b32 v14, 64, v12
    v_xor_b32 v15, 96, v12
    s_mov_b32 m0, s73
    s_add_u32 s73, s73, 0x8000
    buffer_load_dwordx4 v20, s[52:55], s71 offen offset:0 lds
    buffer_load_dwordx4 v21, s[52:55], s71 offen offset:1024 lds
    buffer_load_dwordx4 v22, s[52:55], s71 offen offset:2048 lds
    buffer_load_dwordx4 v23, s[52:55], s71 offen offset:3072 lds
    s_add_u32 s71, s71, 0x20000
    s_and_b32 s71, s71, 0x1fffff
    s_mov_b32 m0, s73
    s_add_u32 s73, s73, 0x8000
    buffer_load_dwordx4 v20, s[52:55], s71 offen offset:0 lds
    buffer_load_dwordx4 v21, s[52:55], s71 offen offset:1024 lds
    buffer_load_dwordx4 v22, s[52:55], s71 offen offset:2048 lds
    buffer_load_dwordx4 v23, s[52:55], s71 offen offset:3072 lds
    s_add_u32 s71, s71, 0x20000
    s_and_b32 s71, s71, 0x1fffff
    s_mov_b32 m0, s73
    s_add_u32 s73, s73, 0x8000
    buffer_load_dwordx4 v20, s[52:55], s71 offen offset:0 lds
    buffer_load_dwordx4 v21, s[52:55], s71 offen offset:1024 lds
    buffer_load_dwordx4 v22, s[52:55], s71 offen offset:2048 lds
    buffer_load_dwordx4 v23, s[52:55], s71 offen offset:3072 lds
    s_add_u32 s71, s71, 0x20000
    s_and_b32 s71, s71, 0x1fffff
    s_mov_b32 m0, s73
    s_add_u32 s73, s73, 0xfffe8000
    buffer_load_dwordx4 v20, s[52:55], s71 offen offset:0 lds
    buffer_load_dwordx4 v21, s[52:55], s71 offen offset:1024 lds
    buffer_load_dwordx4 v22, s[52:55], s71 offen offset:2048 lds
    buffer_load_dwordx4 v23, s[52:55], s71 offen offset:3072 lds
    s_add_u32 s71, s71, 0x20000
    s_and_b32 s71, s71, 0x1fffff
    s_cmp_lg_u32 s64, 0
    s_cbranch_scc1 hoa_poll_done
    s_mov_b32 s5, 0
hoa_poll_loop:
    global_load_dword v4, v34, s[44:45] sc1
    s_waitcnt vmcnt(0)
    v_readfirstlane_b32 s6, v4
    s_nop 3
    s_cmp_ge_u32 s6, 16
    s_cbranch_scc1 hoa_poll_ok
    s_sleep 1
    s_add_u32 s5, s5, 1
    s_cmp_lt_u32 s5, 2097152
    s_cbranch_scc1 hoa_poll_loop
hoa_poll_ok:
hoa_poll_done:
    s_barrier
    s_mov_b32 m0, s72
    s_add_u32 s72, s72, 0x8000
    buffer_load_dwordx4 v16, s[48:51], s70 offen offset:0 sc1 lds
    buffer_load_dwordx4 v17, s[48:51], s70 offen offset:1024 sc1 lds
    buffer_load_dwordx4 v18, s[48:51], s70 offen offset:2048 sc1 lds
    buffer_load_dwordx4 v19, s[48:51], s70 offen offset:3072 sc1 lds
    s_add_u32 s70, s70, 128
    s_and_b32 s70, s70, 0x7ff
    s_mov_b32 m0, s72
    s_add_u32 s72, s72, 0x8000
    buffer_load_dwordx4 v16, s[48:51], s70 offen offset:0 sc1 lds
    buffer_load_dwordx4 v17, s[48:51], s70 offen offset:1024 sc1 lds
    buffer_load_dwordx4 v18, s[48:51], s70 offen offset:2048 sc1 lds
    buffer_load_dwordx4 v19, s[48:51], s70 offen offset:3072 sc1 lds
    s_add_u32 s70, s70, 128
    s_and_b32 s70, s70, 0x7ff
    s_mov_b32 m0, s72
    s_add_u32 s72, s72, 0x8000
    buffer_load_dwordx4 v16, s[48:51], s70 offen offset:0 sc1 lds
    buffer_load_dwordx4 v17, s[48:51], s70 offen offset:1024 sc1 lds
    buffer_load_dwordx4 v18, s[48:51], s70 offen offset:2048 sc1 lds
    buffer_load_dwordx4 v19, s[48:51], s70 offen offset:3072 sc1 lds
    s_add_u32 s70, s70, 128
    s_and_b32 s70, s70, 0x7ff
    s_mov_b32 m0, s72
    s_add_u32 s72, s72, 0xfffe8000
    buffer_load_dwordx4 v16, s[48:51], s70 offen offset:0 sc1 lds
    buffer_load_dwordx4 v17, s[48:51], s70 offen offset:1024 sc1 lds
    buffer_load_dwordx4 v18, s[48:51], s70 offen offset:2048 sc1 lds
    buffer_load_dwordx4 v19, s[48:51], s70 offen offset:3072 sc1 lds
    s_add_u32 s70, s70, 128
    s_and_b32 s70, s70, 0x7ff
    s_mov_b32 s67, 0x8000
    s_mov_b32 s68, 0x8000
    s_mov_b32 s79, 0x8000
    s_mov_b32 s9, 0xfffe8000
    s_waitcnt vmcnt(12)
    s_barrier
    ds_read_b128 v[128:131], v8 offset:0
    ds_read_b64_tr_b16 v[144:145], v12 offset:0
    ds_read_b64_tr_b16 v[146:147], v12 offset:512
    ds_read_b64_tr_b16 v[148:149], v13 offset:0
    ds_read_b64_tr_b16 v[150:151], v13 offset:512
    ds_read_b64_tr_b16 v[152:153], v14 offset:0
    ds_read_b64_tr_b16 v[154:155], v14 offset:512
    ds_read_b64_tr_b16 v[156:157], v15 offset:0
    ds_read_b64_tr_b16 v[158:159], v15 offset:512
    ds_read_b128 v[132:135], v8 offset:2048
    ds_read_b128 v[136:139], v8 offset:4096
    ds_read_b128 v[140:143], v8 offset:6144
    v_add_u32 v8, s67, v8
    s_waitcnt lgkmcnt(0)
    v_mfma_f32_16x16x32_bf16 v[64:67], v[128:131], v[144:147], 0
    ds_read_b128 v[160:163], v9 offset:0
    ds_read_b64_tr_b16 v[176:177], v12 offset:4096
    v_mfma_f32_16x16x32_bf16 v[68:71], v[128:131], v[148:151], 0
    ds_read_b64_tr_b16 v[178:179], v12 offset:4608
    v_mfma_f32_16x16x32_bf16 v[72:75], v[128:131], v[152:155], 0
    ds_read_b64_tr_b16 v[180:181], v13 offset:4096
    v_mfma_f32_16x16x32_bf16 v[76:79], v[128:131], v[156:159], 0
    ds_read_b64_tr_b16 v[182:183], v13 offset:4608
    v_mfma_f32_16x16x32_bf16 v[80:83], v[132:135], v[144:147], 0
    ds_read_b64_tr_b16 v[184:185], v14 offset:4096
    v_mfma_f32_16x16x32_bf16 v[84:87], v[132:135], v[148:151], 0
    ds_read_b64_tr_b16 v[186:187], v14 offset:4608
    v_mfma_f32_16x16x32_bf16 v[88:91], v[132:135], v[152:155], 0
    ds_read_b64_tr_b16 v[188:189], v15 offset:4096
    v_mfma_f32_16x16x32_bf16 v[92:95], v[132:135], v[156:159], 0
    ds_read_b64_tr_b16 v[190:191], v15 offset:4608
    v_mfma_f32_16x16x32_bf16 v[96:99], v[136:139], v[144:147], 0
    ds_read_b128 v[164:167], v9 offset:2048
    v_mfma_f32_16x16x32_bf16 v[100:103], v[136:139], v[148:151], 0
    ds_read_b128 v[168:171], v9 offset:4096
    v_mfma_f32_16x16x32_bf16 v[104:107], v[136:139], v[152:155], 0
    ds_read_b128 v[172:175], v9 offset:6144
    v_mfma_f32_16x16x32_bf16 v[108:111], v[136:139], v[156:159], 0
    v_add_u32 v9, s67, v9
    v_mfma_f32_16x16x32_bf16 v[112:115], v[140:143], v[144:147], 0
    v_add_u32 v12, s67, v12
    v_mfma_f32_16x16x32_bf16 v[116:119], v[140:143], v[148:151], 0
    v_add_u32 v13, s67, v13
    v_mfma_f32_16x16x32_bf16 v[120:123], v[140:143], v[152:155], 0
    v_add_u32 v14, s67, v14
    v_mfma_f32_16x16x32_bf16 v[124:127], v[140:143], v[156:159], 0
    v_add_u32 v15, s67, v15
    s_waitcnt vmcnt(8) lgkmcnt(0)
    s_barrier
    v_mfma_f32_16x16x32_bf16 v[64:67], v[160:163], v[176:179], v[64:67]
    ds_read_b128 v[128:131], v8 offset:0
    ds_read_b64_tr_b16 v[144:145], v12 offset:0
    v_mfma_f32_16x16x32_bf16 v[68:71], v[160:163], v[180:183], v[68:71]
    ds_read_b64_tr_b16 v[146:147], v12 offset:512
    v_mfma_f32_16x16x32_bf16 v[72:75], v[160:163], v[184:187], v[72:75]
    ds_read_b64_tr_b16 v[148:149], v13 offset:0
    ds_read_b64_tr_b16 v[150:151], v13 offset:512
    v_mfma_f32_16x16x32_bf16 v[76:79], v[160:163], v[188:191], v[76:79]
    ds_read_b64_tr_b16 v[152:153], v14 offset:0
    v_mfma_f32_16x16x32_bf16 v[80:83], v[164:167], v[176:179], v[80:83]
    ds_read_b64_tr_b16 v[154:155], v14 offset:512
    v_mfma_f32_16x16x32_bf16 v[84:87], v[164:167], v[180:183], v[84:87]
    ds_read_b64_tr_b16 v[156:157], v15 offset:0
    ds_read_b64_tr_b16 v[158:159], v15 offset:512
    v_mfma_f32_16x16x32_bf16 v[88:91], v[164:167], v[184:187], v[88:91]
    ds_read_b128 v[132:135], v8 offset:2048
    v_mfma_f32_16x16x32_bf16 v[92:95], v[164:167], v[188:191], v[92:95]
    ds_read_b128 v[136:139], v8 offset:4096
    v_mfma_f32_16x16x32_bf16 v[96:99], v[168:171], v[176:179], v[96:99]
    ds_read_b128 v[140:143], v8 offset:6144
    v_add_u32 v8, s68, v8
    v_mfma_f32_16x16x32_bf16 v[100:103], v[168:171], v[180:183], v[100:103]
    s_mov_b32 m0, s72
    s_add_u32 s72, s72, s67
    buffer_load_dwordx4 v16, s[48:51], s70 offen offset:0 sc1 lds
    v_mfma_f32_16x16x32_bf16 v[104:107], v[168:171], v[184:187], v[104:107]
    buffer_load_dwordx4 v17, s[48:51], s70 offen offset:1024 sc1 lds
    buffer_load_dwordx4 v18, s[48:51], s70 offen offset:2048 sc1 lds
    v_mfma_f32_16x16x32_bf16 v[108:111], v[168:171], v[188:191], v[108:111]
    buffer_load_dwordx4 v19, s[48:51], s70 offen offset:3072 sc1 lds
    s_add_u32 s70, s70, 128
    s_and_b32 s70, s70, 0x7ff
    v_mfma_f32_16x16x32_bf16 v[112:115], v[172:175], v[176:179], v[112:115]
    s_mov_b32 s69, s67
    v_mfma_f32_16x16x32_bf16 v[116:119], v[172:175], v[180:183], v[116:119]
    s_mov_b32 s67, s68
    s_mov_b32 s68, s79
    v_mfma_f32_16x16x32_bf16 v[120:123], v[172:175], v[184:187], v[120:123]
    s_mov_b32 s79, s9
    v_mfma_f32_16x16x32_bf16 v[124:127], v[172:175], v[188:191], v[124:127]
    s_mov_b32 s9, s69
    s_waitcnt lgkmcnt(0)
    v_mfma_f32_16x16x32_bf16 v[64:67], v[128:131], v[144:147], v[64:67]
    ds_read_b128 v[160:163], v9 offset:0
    ds_read_b64_tr_b16 v[176:177], v12 offset:4096
    v_mfma_f32_16x16x32_bf16 v[68:71], v[128:131], v[148:151], v[68:71]
    ds_read_b64_tr_b16 v[178:179], v12 offset:4608
    v_mfma_f32_16x16x32_bf16 v[72:75], v[128:131], v[152:155], v[72:75]
    ds_read_b64_tr_b16 v[180:181], v13 offset:4096
    v_mfma_f32_16x16x32_bf16 v[76:79], v[128:131], v[156:159], v[76:79]
    ds_read_b64_tr_b16 v[182:183], v13 offset:4608
    ds_read_b64_tr_b16 v[184:185], v14 offset:4096
    v_mfma_f32_16x16x32_bf16 v[80:83], v[132:135], v[144:147], v[80:83]
    ds_read_b64_tr_b16 v[186:187], v14 offset:4608
    v_mfma_f32_16x16x32_bf16 v[84:87], v[132:135], v[148:151], v[84:87]
    ds_read_b64_tr_b16 v[188:189], v15 offset:4096
    v_mfma_f32_16x16x32_bf16 v[88:91], v[132:135], v[152:155], v[88:91]
    ds_read_b64_tr_b16 v[190:191], v15 offset:4608
    ds_read_b128 v[164:167], v9 offset:2048
    v_mfma_f32_16x16x32_bf16 v[92:95], v[132:135], v[156:159], v[92:95]
    ds_read_b128 v[168:171], v9 offset:4096
    v_mfma_f32_16x16x32_bf16 v[96:99], v[136:139], v[144:147], v[96:99]
    ds_read_b128 v[172:175], v9 offset:6144
    v_mfma_f32_16x16x32_bf16 v[100:103], v[136:139], v[148:151], v[100:103]
    v_add_u32 v9, s67, v9
    v_add_u32 v12, s67, v12
    v_mfma_f32_16x16x32_bf16 v[104:107], v[136:139], v[152:155], v[104:107]
    v_add_u32 v13, s67, v13
    v_mfma_f32_16x16x32_bf16 v[108:111], v[136:139], v[156:159], v[108:111]
    v_add_u32 v14, s67, v14
    v_mfma_f32_16x16x32_bf16 v[112:115], v[140:143], v[144:147], v[112:115]
    v_add_u32 v15, s67, v15
    s_mov_b32 m0, s73
    s_add_u32 s73, s73, s9
    buffer_load_dwordx4 v20, s[52:55], s71 offen offset:0 lds
    v_mfma_f32_16x16x32_bf16 v[116:119], v[140:143], v[148:151], v[116:119]
    buffer_load_dwordx4 v21, s[52:55], s71 offen offset:1024 lds
    v_mfma_f32_16x16x32_bf16 v[120:123], v[140:143], v[152:155], v[120:123]
    buffer_load_dwordx4 v22, s[52:55], s71 offen offset:2048 lds
    v_mfma_f32_16x16x32_bf16 v[124:127], v[140:143], v[156:159], v[124:127]
    buffer_load_dwordx4 v23, s[52:55], s71 offen offset:3072 lds
    s_add_u32 s71, s71, 0x20000
    s_and_b32 s71, s71, 0x1fffff
    s_waitcnt vmcnt(12) lgkmcnt(0)
    s_barrier
    v_mfma_f32_16x16x32_bf16 v[64:67], v[160:163], v[176:179], v[64:67]
    ds_read_b128 v[128:131], v8 offset:0
    ds_read_b64_tr_b16 v[144:145], v12 offset:0
    v_mfma_f32_16x16x32_bf16 v[68:71], v[160:163], v[180:183], v[68:71]
    ds_read_b64_tr_b16 v[146:147], v12 offset:512
    v_mfma_f32_16x16x32_bf16 v[72:75], v[160:163], v[184:187], v[72:75]
    ds_read_b64_tr_b16 v[148:149], v13 offset:0
    ds_read_b64_tr_b16 v[150:151], v13 offset:512
    v_mfma_f32_16x16x32_bf16 v[76:79], v[160:163], v[188:191], v[76:79]
    ds_read_b64_tr_b16 v[152:153], v14 offset:0
    v_mfma_f32_16x16x32_bf16 v[80:83], v[164:167], v[176:179], v[80:83]
    ds_read_b64_tr_b16 v[154:155], v14 offset:512
    v_mfma_f32_16x16x32_bf16 v[84:87], v[164:167], v[180:183], v[84:87]
    ds_read_b64_tr_b16 v[156:157], v15 offset:0
    ds_read_b64_tr_b16 v[158:159], v15 offset:512
    v_mfma_f32_16x16x32_bf16 v[88:91], v[164:167], v[184:187], v[88:91]
    ds_read_b128 v[132:135], v8 offset:2048
    v_mfma_f32_16x16x32_bf16 v[92:95], v[164:167], v[188:191], v[92:95]
    ds_read_b128 v[136:139], v8 offset:4096
    v_mfma_f32_16x16x32_bf16 v[96:99], v[168:171], v[176:179], v[96:99]
    ds_read_b128 v[140:143], v8 offset:6144
    v_add_u32 v8, s68, v8
    v_mfma_f32_16x16x32_bf16 v[100:103], v[168:171], v[180:183], v[100:103]
    s_mov_b32 m0, s72
    s_add_u32 s72, s72, s67
    buffer_load_dwordx4 v16, s[48:51], s70 offen offset:0 sc1 lds
    v_mfma_f32_16x16x32_bf16 v[104:107], v[168:171], v[184:187], v[104:107]
    buffer_load_dwordx4 v17, s[48:51], s70 offen offset:1024 sc1 lds
    buffer_load_dwordx4 v18, s[48:51], s70 offen offset:2048 sc1 lds
    v_mfma_f32_16x16x32_bf16 v[108:111], v[168:171], v[188:191], v[108:111]
    buffer_load_dwordx4 v19, s[48:51], s70 offen offset:3072 sc1 lds
    s_add_u32 s70, s70, 128
    s_and_b32 s70, s70, 0x7ff
    v_mfma_f32_16x16x32_bf16 v[112:115], v[172:175], v[176:179], v[112:115]
    s_mov_b32 s69, s67
    v_mfma_f32_16x16x32_bf16 v[116:119], v[172:175], v[180:183], v[116:119]
    s_mov_b32 s67, s68
    s_mov_b32 s68, s79
    v_mfma_f32_16x16x32_bf16 v[120:123], v[172:175], v[184:187], v[120:123]
    s_mov_b32 s79, s9
    v_mfma_f32_16x16x32_bf16 v[124:127], v[172:175], v[188:191], v[124:127]
    s_mov_b32 s9, s69
    s_mov_b32 s65, 10
p2a_L0:
    s_waitcnt lgkmcnt(0)
    v_mfma_f32_16x16x32_bf16 v[64:67], v[128:131], v[144:147], v[64:67]
    ds_read_b128 v[160:163], v9 offset:0
    ds_read_b64_tr_b16 v[176:177], v12 offset:4096
    v_mfma_f32_16x16x32_bf16 v[68:71], v[128:131], v[148:151], v[68:71]
    ds_read_b64_tr_b16 v[178:179], v12 offset:4608
    v_mfma_f32_16x16x32_bf16 v[72:75], v[128:131], v[152:155], v[72:75]
    ds_read_b64_tr_b16 v[180:181], v13 offset:4096
    v_mfma_f32_16x16x32_bf16 v[76:79], v[128:131], v[156:159], v[76:79]
    ds_read_b64_tr_b16 v[182:183], v13 offset:4608
    ds_read_b64_tr_b16 v[184:185], v14 offset:4096
    v_mfma_f32_16x16x32_bf16 v[80:83], v[132:135], v[144:147], v[80:83]
    ds_read_b64_tr_b16 v[186:187], v14 offset:4608
    v_mfma_f32_16x16x32_bf16 v[84:87], v[132:135], v[148:151], v[84:87]
    ds_read_b64_tr_b16 v[188:189], v15 offset:4096
    v_mfma_f32_16x16x32_bf16 v[88:91], v[132:135], v[152:155], v[88:91]
    ds_read_b64_tr_b16 v[190:191], v15 offset:4608
    ds_read_b128 v[164:167], v9 offset:2048
    v_mfma_f32_16x16x32_bf16 v[92:95], v[132:135], v[156:159], v[92:95]
    ds_read_b128 v[168:171], v9 offset:4096
    v_mfma_f32_16x16x32_bf16 v[96:99], v[136:139], v[144:147], v[96:99]
    ds_read_b128 v[172:175], v9 offset:6144
    v_mfma_f32_16x16x32_bf16 v[100:103], v[136:139], v[148:151], v[100:103]
    v_add_u32 v9, s67, v9
    v_add_u32 v12, s67, v12
    v_mfma_f32_16x16x32_bf16 v[104:107], v[136:139], v[152:155], v[104:107]
    v_add_u32 v13, s67, v13
    v_mfma_f32_16x16x32_bf16 v[108:111], v[136:139], v[156:159], v[108:111]
    v_add_u32 v14, s67, v14
    v_mfma_f32_16x16x32_bf16 v[112:115], v[140:143], v[144:147], v[112:115]
    v_add_u32 v15, s67, v15
    s_mov_b32 m0, s73
    s_add_u32 s73, s73, s9
    buffer_load_dwordx4 v20, s[52:55], s71 offen offset:0 lds
    v_mfma_f32_16x16x32_bf16 v[116:119], v[140:143], v[148:151], v[116:119]
    buffer_load_dwordx4 v21, s[52:55], s71 offen offset:1024 lds
    v_mfma_f32_16x16x32_bf16 v[120:123], v[140:143], v[152:155], v[120:123]
    buffer_load_dwordx4 v22, s[52:55], s71 offen offset:2048 lds
    v_mfma_f32_16x16x32_bf16 v[124:127], v[140:143], v[156:159], v[124:127]
    buffer_load_dwordx4 v23, s[52:55], s71 offen offset:3072 lds
    s_add_u32 s71, s71, 0x20000
    s_and_b32 s71, s71, 0x1fffff
    s_waitcnt vmcnt(16) lgkmcnt(0)
    s_barrier
    v_mfma_f32_16x16x32_bf16 v[64:67], v[160:163], v[176:179], v[64:67]
    ds_read_b128 v[128:131], v8 offset:0
    ds_read_b64_tr_b16 v[144:145], v12 offset:0
    v_mfma_f32_16x16x32_bf16 v[68:71], v[160:163], v[180:183], v[68:71]
    ds_read_b64_tr_b16 v[146:147], v12 offset:512
    v_mfma_f32_16x16x32_bf16 v[72:75], v[160:163], v[184:187], v[72:75]
    ds_read_b64_tr_b16 v[148:149], v13 offset:0
    ds_read_b64_tr_b16 v[150:151], v13 offset:512
    v_mfma_f32_16x16x32_bf16 v[76:79], v[160:163], v[188:191], v[76:79]
    ds_read_b64_tr_b16 v[152:153], v14 offset:0
    v_mfma_f32_16x16x32_bf16 v[80:83], v[164:167], v[176:179], v[80:83]
    ds_read_b64_tr_b16 v[154:155], v14 offset:512
    v_mfma_f32_16x16x32_bf16 v[84:87], v[164:167], v[180:183], v[84:87]
    ds_read_b64_tr_b16 v[156:157], v15 offset:0
    ds_read_b64_tr_b16 v[158:159], v15 offset:512
    v_mfma_f32_16x16x32_bf16 v[88:91], v[164:167], v[184:187], v[88:91]
    ds_read_b128 v[132:135], v8 offset:2048
    v_mfma_f32_16x16x32_bf16 v[92:95], v[164:167], v[188:191], v[92:95]
    ds_read_b128 v[136:139], v8 offset:4096
    v_mfma_f32_16x16x32_bf16 v[96:99], v[168:171], v[176:179], v[96:99]
    ds_read_b128 v[140:143], v8 offset:6144
    v_add_u32 v8, s68, v8
    v_mfma_f32_16x16x32_bf16 v[100:103], v[168:171], v[180:183], v[100:103]
    s_mov_b32 m0, s72
    s_add_u32 s72, s72, s67
    buffer_load_dwordx4 v16, s[48:51], s70 offen offset:0 sc1 lds
    v_mfma_f32_16x16x32_bf16 v[104:107], v[168:171], v[184:187], v[104:107]
    buffer_load_dwordx4 v17, s[48:51], s70 offen offset:1024 sc1 lds
    buffer_load_dwordx4 v18, s[48:51], s70 offen offset:2048 sc1 lds
    v_mfma_f32_16x16x32_bf16 v[108:111], v[168:171], v[188:191], v[108:111]
    buffer_load_dwordx4 v19, s[48:51], s70 offen offset:3072 sc1 lds
    s_add_u32 s70, s70, 128
    s_and_b32 s70, s70, 0x7ff
    v_mfma_f32_16x16x32_bf16 v[112:115], v[172:175], v[176:179], v[112:115]
    s_mov_b32 s69, s67
    v_mfma_f32_16x16x32_bf16 v[116:119], v[172:175], v[180:183], v[116:119]
    s_mov_b32 s67, s68
    s_mov_b32 s68, s79
    v_mfma_f32_16x16x32_bf16 v[120:123], v[172:175], v[184:187], v[120:123]
    s_mov_b32 s79, s9
    v_mfma_f32_16x16x32_bf16 v[124:127], v[172:175], v[188:191], v[124:127]
    s_mov_b32 s9, s69
    s_sub_u32 s65, s65, 1
    s_cmp_lg_u32 s65, 0
    s_cbranch_scc1 p2a_L0
    s_waitcnt lgkmcnt(0)
    v_mfma_f32_16x16x32_bf16 v[64:67], v[128:131], v[144:147], v[64:67]
    ds_read_b128 v[160:163], v9 offset:0
    ds_read_b64_tr_b16 v[176:177], v12 offset:4096
    v_mfma_f32_16x16x32_bf16 v[68:71], v[128:131], v[148:151], v[68:71]
    ds_read_b64_tr_b16 v[178:179], v12 offset:4608
    v_mfma_f32_16x16x32_bf16 v[72:75], v[128:131], v[152:155], v[72:75]
    ds_read_b64_tr_b16 v[180:181], v13 offset:4096
    v_mfma_f32_16x16x32_bf16 v[76:79], v[128:131], v[156:159], v[76:79]
    ds_read_b64_tr_b16 v[182:183], v13 offset:4608
    ds_read_b64_tr_b16 v[184:185], v14 offset:4096
    v_mfma_f32_16x16x32_bf16 v[80:83], v[132:135], v[144:147], v[80:83]
    ds_read_b64_tr_b16 v[186:187], v14 offset:4608
    v_mfma_f32_16x16x32_bf16 v[84:87], v[132:135], v[148:151], v[84:87]
    ds_read_b64_tr_b16 v[188:189], v15 offset:4096
    v_mfma_f32_16x16x32_bf16 v[88:91], v[132:135], v[152:155], v[88:91]
    ds_read_b64_tr_b16 v[190:191], v15 offset:4608
    ds_read_b128 v[164:167], v9 offset:2048
    v_mfma_f32_16x16x32_bf16 v[92:95], v[132:135], v[156:159], v[92:95]
    ds_read_b128 v[168:171], v9 offset:4096
    v_mfma_f32_16x16x32_bf16 v[96:99], v[136:139], v[144:147], v[96:99]
    ds_read_b128 v[172:175], v9 offset:6144
    v_mfma_f32_16x16x32_bf16 v[100:103], v[136:139], v[148:151], v[100:103]
    v_add_u32 v9, s67, v9
    v_add_u32 v12, s67, v12
    v_mfma_f32_16x16x32_bf16 v[104:107], v[136:139], v[152:155], v[104:107]
    v_add_u32 v13, s67, v13
    v_mfma_f32_16x16x32_bf16 v[108:111], v[136:139], v[156:159], v[108:111]
    v_add_u32 v14, s67, v14
    v_mfma_f32_16x16x32_bf16 v[112:115], v[140:143], v[144:147], v[112:115]
    v_add_u32 v15, s67, v15
    s_mov_b32 m0, s73
    s_add_u32 s73, s73, s9
    buffer_load_dwordx4 v20, s[52:55], s71 offen offset:0 lds
    v_mfma_f32_16x16x32_bf16 v[116:119], v[140:143], v[148:151], v[116:119]
    buffer_load_dwordx4 v21, s[52:55], s71 offen offset:1024 lds
    v_mfma_f32_16x16x32_bf16 v[120:123], v[140:143], v[152:155], v[120:123]
    buffer_load_dwordx4 v22, s[52:55], s71 offen offset:2048 lds
    v_mfma_f32_16x16x32_bf16 v[124:127], v[140:143], v[156:159], v[124:127]
    buffer_load_dwordx4 v23, s[52:55], s71 offen offset:3072 lds
    s_add_u32 s71, s71, 0x20000
    s_and_b32 s71, s71, 0x1fffff
    s_waitcnt vmcnt(16) lgkmcnt(0)
    s_barrier
    v_mfma_f32_16x16x32_bf16 v[64:67], v[160:163], v[176:179], v[64:67]
    ds_read_b128 v[128:131], v8 offset:0
    ds_read_b64_tr_b16 v[144:145], v12 offset:0
    v_mfma_f32_16x16x32_bf16 v[68:71], v[160:163], v[180:183], v[68:71]
    ds_read_b64_tr_b16 v[146:147], v12 offset:512
    v_mfma_f32_16x16x32_bf16 v[72:75], v[160:163], v[184:187], v[72:75]
    ds_read_b64_tr_b16 v[148:149], v13 offset:0
    v_mfma_f32_16x16x32_bf16 v[76:79], v[160:163], v[188:191], v[76:79]
    ds_read_b64_tr_b16 v[150:151], v13 offset:512
    v_mfma_f32_16x16x32_bf16 v[80:83], v[164:167], v[176:179], v[80:83]
    ds_read_b64_tr_b16 v[152:153], v14 offset:0
    v_mfma_f32_16x16x32_bf16 v[84:87], v[164:167], v[180:183], v[84:87]
    ds_read_b64_tr_b16 v[154:155], v14 offset:512
    v_mfma_f32_16x16x32_bf16 v[88:91], v[164:167], v[184:187], v[88:91]
    ds_read_b64_tr_b16 v[156:157], v15 offset:0
    v_mfma_f32_16x16x32_bf16 v[92:95], v[164:167], v[188:191], v[92:95]
    ds_read_b64_tr_b16 v[158:159], v15 offset:512
    v_mfma_f32_16x16x32_bf16 v[96:99], v[168:171], v[176:179], v[96:99]
    ds_read_b128 v[132:135], v8 offset:2048
    ds_read_b128 v[136:139], v8 offset:4096
    v_mfma_f32_16x16x32_bf16 v[100:103], v[168:171], v[180:183], v[100:103]
    ds_read_b128 v[140:143], v8 offset:6144
    v_mfma_f32_16x16x32_bf16 v[104:107], v[168:171], v[184:187], v[104:107]
    v_add_u32 v8, s68, v8
    v_mfma_f32_16x16x32_bf16 v[108:111], v[168:171], v[188:191], v[108:111]
    s_mov_b32 s69, s67
    v_mfma_f32_16x16x32_bf16 v[112:115], v[172:175], v[176:179], v[112:115]
    s_mov_b32 s67, s68
    v_mfma_f32_16x16x32_bf16 v[116:119], v[172:175], v[180:183], v[116:119]
    s_mov_b32 s68, s79
    v_mfma_f32_16x16x32_bf16 v[120:123], v[172:175], v[184:187], v[120:123]
    s_mov_b32 s79, s9
    v_mfma_f32_16x16x32_bf16 v[124:127], v[172:175], v[188:191], v[124:127]
    s_mov_b32 s9, s69
    s_waitcnt lgkmcnt(0)
    v_mfma_f32_16x16x32_bf16 v[64:67], v[128:131], v[144:147], v[64:67]
    ds_read_b128 v[160:163], v9 offset:0
    ds_read_b64_tr_b16 v[176:177], v12 offset:4096
    v_mfma_f32_16x16x32_bf16 v[68:71], v[128:131], v[148:151], v[68:71]
    ds_read_b64_tr_b16 v[178:179], v12 offset:4608
    v_mfma_f32_16x16x32_bf16 v[72:75], v[128:131], v[152:155], v[72:75]
    ds_read_b64_tr_b16 v[180:181], v13 offset:4096
    v_mfma_f32_16x16x32_bf16 v[76:79], v[128:131], v[156:159], v[76:79]
    ds_read_b64_tr_b16 v[182:183], v13 offset:4608
    v_mfma_f32_16x16x32_bf16 v[80:83], v[132:135], v[144:147], v[80:83]
    ds_read_b64_tr_b16 v[184:185], v14 offset:4096
    v_mfma_f32_16x16x32_bf16 v[84:87], v[132:135], v[148:151], v[84:87]
    ds_read_b64_tr_b16 v[186:187], v14 offset:4608
    v_mfma_f32_16x16x32_bf16 v[88:91], v[132:135], v[152:155], v[88:91]
    ds_read_b64_tr_b16 v[188:189], v15 offset:4096
    v_mfma_f32_16x16x32_bf16 v[92:95], v[132:135], v[156:159], v[92:95]
    ds_read_b64_tr_b16 v[190:191], v15 offset:4608
    v_mfma_f32_16x16x32_bf16 v[96:99], v[136:139], v[144:147], v[96:99]
    ds_read_b128 v[164:167], v9 offset:2048
    v_mfma_f32_16x16x32_bf16 v[100:103], v[136:139], v[148:151], v[100:103]
    ds_read_b128 v[168:171], v9 offset:4096
    v_mfma_f32_16x16x32_bf16 v[104:107], v[136:139], v[152:155], v[104:107]
    ds_read_b128 v[172:175], v9 offset:6144
    v_mfma_f32_16x16x32_bf16 v[108:111], v[136:139], v[156:159], v[108:111]
    v_add_u32 v9, s67, v9
    v_mfma_f32_16x16x32_bf16 v[112:115], v[140:143], v[144:147], v[112:115]
    v_add_u32 v12, s67, v12
    v_mfma_f32_16x16x32_bf16 v[116:119], v[140:143], v[148:151], v[116:119]
    v_add_u32 v13, s67, v13
    v_mfma_f32_16x16x32_bf16 v[120:123], v[140:143], v[152:155], v[120:123]
    v_add_u32 v14, s67, v14
    v_mfma_f32_16x16x32_bf16 v[124:127], v[140:143], v[156:159], v[124:127]
    v_add_u32 v15, s67, v15
    s_waitcnt vmcnt(8) lgkmcnt(0)
    s_barrier
    v_mfma_f32_16x16x32_bf16 v[64:67], v[160:163], v[176:179], v[64:67]
    ds_read_b128 v[128:131], v8 offset:0
    ds_read_b64_tr_b16 v[144:145], v12 offset:0
    v_mfma_f32_16x16x32_bf16 v[68:71], v[160:163], v[180:183], v[68:71]
    ds_read_b64_tr_b16 v[146:147], v12 offset:512
    v_mfma_f32_16x16x32_bf16 v[72:75], v[160:163], v[184:187], v[72:75]
    ds_read_b64_tr_b16 v[148:149], v13 offset:0
    v_mfma_f32_16x16x32_bf16 v[76:79], v[160:163], v[188:191], v[76:79]
    ds_read_b64_tr_b16 v[150:151], v13 offset:512
    v_mfma_f32_16x16x32_bf16 v[80:83], v[164:167], v[176:179], v[80:83]
    ds_read_b64_tr_b16 v[152:153], v14 offset:0
    v_mfma_f32_16x16x32_bf16 v[84:87], v[164:167], v[180:183], v[84:87]
    ds_read_b64_tr_b16 v[154:155], v14 offset:512
    v_mfma_f32_16x16x32_bf16 v[88:91], v[164:167], v[184:187], v[88:91]
    ds_read_b64_tr_b16 v[156:157], v15 offset:0
    v_mfma_f32_16x16x32_bf16 v[92:95], v[164:167], v[188:191], v[92:95]
    ds_read_b64_tr_b16 v[158:159], v15 offset:512
    v_mfma_f32_16x16x32_bf16 v[96:99], v[168:171], v[176:179], v[96:99]
    ds_read_b128 v[132:135], v8 offset:2048
    ds_read_b128 v[136:139], v8 offset:4096
    v_mfma_f32_16x16x32_bf16 v[100:103], v[168:171], v[180:183], v[100:103]
    ds_read_b128 v[140:143], v8 offset:6144
    v_mfma_f32_16x16x32_bf16 v[104:107], v[168:171], v[184:187], v[104:107]
    v_add_u32 v8, s68, v8
    v_mfma_f32_16x16x32_bf16 v[108:111], v[168:171], v[188:191], v[108:111]
    s_mov_b32 s69, s67
    v_mfma_f32_16x16x32_bf16 v[112:115], v[172:175], v[176:179], v[112:115]
    s_mov_b32 s67, s68
    v_mfma_f32_16x16x32_bf16 v[116:119], v[172:175], v[180:183], v[116:119]
    s_mov_b32 s68, s79
    v_mfma_f32_16x16x32_bf16 v[120:123], v[172:175], v[184:187], v[120:123]
    s_mov_b32 s79, s9
    v_mfma_f32_16x16x32_bf16 v[124:127], v[172:175], v[188:191], v[124:127]
    s_mov_b32 s9, s69
    s_waitcnt lgkmcnt(0)
    v_mfma_f32_16x16x32_bf16 v[64:67], v[128:131], v[144:147], v[64:67]
    ds_read_b128 v[160:163], v9 offset:0
    ds_read_b64_tr_b16 v[176:177], v12 offset:4096
    v_mfma_f32_16x16x32_bf16 v[68:71], v[128:131], v[148:151], v[68:71]
    ds_read_b64_tr_b16 v[178:179], v12 offset:4608
    v_mfma_f32_16x16x32_bf16 v[72:75], v[128:131], v[152:155], v[72:75]
    ds_read_b64_tr_b16 v[180:181], v13 offset:4096
    v_mfma_f32_16x16x32_bf16 v[76:79], v[128:131], v[156:159], v[76:79]
    ds_read_b64_tr_b16 v[182:183], v13 offset:4608
    v_mfma_f32_16x16x32_bf16 v[80:83], v[132:135], v[144:147], v[80:83]
    ds_read_b64_tr_b16 v[184:185], v14 offset:4096
    v_mfma_f32_16x16x32_bf16 v[84:87], v[132:135], v[148:151], v[84:87]
    ds_read_b64_tr_b16 v[186:187], v14 offset:4608
    v_mfma_f32_16x16x32_bf16 v[88:91], v[132:135], v[152:155], v[88:91]
    ds_read_b64_tr_b16 v[188:189], v15 offset:4096
    v_mfma_f32_16x16x32_bf16 v[92:95], v[132:135], v[156:159], v[92:95]
    ds_read_b64_tr_b16 v[190:191], v15 offset:4608
    v_mfma_f32_16x16x32_bf16 v[96:99], v[136:139], v[144:147], v[96:99]
    ds_read_b128 v[164:167], v9 offset:2048
    v_mfma_f32_16x16x32_bf16 v[100:103], v[136:139], v[148:151], v[100:103]
    ds_read_b128 v[168:171], v9 offset:4096
    v_mfma_f32_16x16x32_bf16 v[104:107], v[136:139], v[152:155], v[104:107]
    ds_read_b128 v[172:175], v9 offset:6144
    v_mfma_f32_16x16x32_bf16 v[108:111], v[136:139], v[156:159], v[108:111]
    v_add_u32 v9, s67, v9
    v_mfma_f32_16x16x32_bf16 v[112:115], v[140:143], v[144:147], v[112:115]
    v_add_u32 v12, s67, v12
    v_mfma_f32_16x16x32_bf16 v[116:119], v[140:143], v[148:151], v[116:119]
    v_add_u32 v13, s67, v13
    v_mfma_f32_16x16x32_bf16 v[120:123], v[140:143], v[152:155], v[120:123]
    v_add_u32 v14, s67, v14
    v_mfma_f32_16x16x32_bf16 v[124:127], v[140:143], v[156:159], v[124:127]
    v_add_u32 v15, s67, v15
    s_waitcnt vmcnt(0) lgkmcnt(0)
    s_barrier
    v_mfma_f32_16x16x32_bf16 v[64:67], v[160:163], v[176:179], v[64:67]
    ds_read_b128 v[128:131], v8 offset:0
    ds_read_b64_tr_b16 v[144:145], v12 offset:0
    v_mfma_f32_16x16x32_bf16 v[68:71], v[160:163], v[180:183], v[68:71]
    ds_read_b64_tr_b16 v[146:147], v12 offset:512
    v_mfma_f32_16x16x32_bf16 v[72:75], v[160:163], v[184:187], v[72:75]
    ds_read_b64_tr_b16 v[148:149], v13 offset:0
    v_mfma_f32_16x16x32_bf16 v[76:79], v[160:163], v[188:191], v[76:79]
    ds_read_b64_tr_b16 v[150:151], v13 offset:512
    v_mfma_f32_16x16x32_bf16 v[80:83], v[164:167], v[176:179], v[80:83]
    ds_read_b64_tr_b16 v[152:153], v14 offset:0
    v_mfma_f32_16x16x32_bf16 v[84:87], v[164:167], v[180:183], v[84:87]
    ds_read_b64_tr_b16 v[154:155], v14 offset:512
    v_mfma_f32_16x16x32_bf16 v[88:91], v[164:167], v[184:187], v[88:91]
    ds_read_b64_tr_b16 v[156:157], v15 offset:0
    v_mfma_f32_16x16x32_bf16 v[92:95], v[164:167], v[188:191], v[92:95]
    ds_read_b64_tr_b16 v[158:159], v15 offset:512
    v_mfma_f32_16x16x32_bf16 v[96:99], v[168:171], v[176:179], v[96:99]
    ds_read_b128 v[132:135], v8 offset:2048
    ds_read_b128 v[136:139], v8 offset:4096
    v_mfma_f32_16x16x32_bf16 v[100:103], v[168:171], v[180:183], v[100:103]
    ds_read_b128 v[140:143], v8 offset:6144
    v_mfma_f32_16x16x32_bf16 v[104:107], v[168:171], v[184:187], v[104:107]
    v_add_u32 v8, s68, v8
    v_mfma_f32_16x16x32_bf16 v[108:111], v[168:171], v[188:191], v[108:111]
    s_mov_b32 s69, s67
    v_mfma_f32_16x16x32_bf16 v[112:115], v[172:175], v[176:179], v[112:115]
    s_mov_b32 s67, s68
    v_mfma_f32_16x16x32_bf16 v[116:119], v[172:175], v[180:183], v[116:119]
    s_mov_b32 s68, s79
    v_mfma_f32_16x16x32_bf16 v[120:123], v[172:175], v[184:187], v[120:123]
    s_mov_b32 s79, s9
    v_mfma_f32_16x16x32_bf16 v[124:127], v[172:175], v[188:191], v[124:127]
    s_mov_b32 s9, s69
    s_waitcnt lgkmcnt(0)
    v_mfma_f32_16x16x32_bf16 v[64:67], v[128:131], v[144:147], v[64:67]
    ds_read_b128 v[160:163], v9 offset:0
    ds_read_b64_tr_b16 v[176:177], v12 offset:4096
    v_mfma_f32_16x16x32_bf16 v[68:71], v[128:131], v[148:151], v[68:71]
    ds_read_b64_tr_b16 v[178:179], v12 offset:4608
    v_mfma_f32_16x16x32_bf16 v[72:75], v[128:131], v[152:155], v[72:75]
    ds_read_b64_tr_b16 v[180:181], v13 offset:4096
    v_mfma_f32_16x16x32_bf16 v[76:79], v[128:131], v[156:159], v[76:79]
    ds_read_b64_tr_b16 v[182:183], v13 offset:4608
    v_mfma_f32_16x16x32_bf16 v[80:83], v[132:135], v[144:147], v[80:83]
    ds_read_b64_tr_b16 v[184:185], v14 offset:4096
    v_mfma_f32_16x16x32_bf16 v[84:87], v[132:135], v[148:151], v[84:87]
    ds_read_b64_tr_b16 v[186:187], v14 offset:4608
    v_mfma_f32_16x16x32_bf16 v[88:91], v[132:135], v[152:155], v[88:91]
    ds_read_b64_tr_b16 v[188:189], v15 offset:4096
    v_mfma_f32_16x16x32_bf16 v[92:95], v[132:135], v[156:159], v[92:95]
    ds_read_b64_tr_b16 v[190:191], v15 offset:4608
    v_mfma_f32_16x16x32_bf16 v[96:99], v[136:139], v[144:147], v[96:99]
    ds_read_b128 v[164:167], v9 offset:2048
    v_mfma_f32_16x16x32_bf16 v[100:103], v[136:139], v[148:151], v[100:103]
    ds_read_b128 v[168:171], v9 offset:4096
    v_mfma_f32_16x16x32_bf16 v[104:107], v[136:139], v[152:155], v[104:107]
    ds_read_b128 v[172:175], v9 offset:6144
    v_mfma_f32_16x16x32_bf16 v[108:111], v[136:139], v[156:159], v[108:111]
    v_add_u32 v9, s67, v9
    v_mfma_f32_16x16x32_bf16 v[112:115], v[140:143], v[144:147], v[112:115]
    v_add_u32 v12, s67, v12
    v_mfma_f32_16x16x32_bf16 v[116:119], v[140:143], v[148:151], v[116:119]
    v_add_u32 v13, s67, v13
    v_mfma_f32_16x16x32_bf16 v[120:123], v[140:143], v[152:155], v[120:123]
    v_add_u32 v14, s67, v14
    v_mfma_f32_16x16x32_bf16 v[124:127], v[140:143], v[156:159], v[124:127]
    v_add_u32 v15, s67, v15
    s_waitcnt lgkmcnt(0)
    v_mfma_f32_16x16x32_bf16 v[64:67], v[160:163], v[176:179], v[64:67]
    v_mfma_f32_16x16x32_bf16 v[68:71], v[160:163], v[180:183], v[68:71]
    v_mfma_f32_16x16x32_bf16 v[72:75], v[160:163], v[184:187], v[72:75]
    v_mfma_f32_16x16x32_bf16 v[76:79], v[160:163], v[188:191], v[76:79]
    v_mfma_f32_16x16x32_bf16 v[80:83], v[164:167], v[176:179], v[80:83]
    v_mfma_f32_16x16x32_bf16 v[84:87], v[164:167], v[180:183], v[84:87]
    v_mfma_f32_16x16x32_bf16 v[88:91], v[164:167], v[184:187], v[88:91]
    v_mfma_f32_16x16x32_bf16 v[92:95], v[164:167], v[188:191], v[92:95]
    v_mfma_f32_16x16x32_bf16 v[96:99], v[168:171], v[176:179], v[96:99]
    v_mfma_f32_16x16x32_bf16 v[100:103], v[168:171], v[180:183], v[100:103]
    v_mfma_f32_16x16x32_bf16 v[104:107], v[168:171], v[184:187], v[104:107]
    v_mfma_f32_16x16x32_bf16 v[108:111], v[168:171], v[188:191], v[108:111]
    v_mfma_f32_16x16x32_bf16 v[112:115], v[172:175], v[176:179], v[112:115]
    v_mfma_f32_16x16x32_bf16 v[116:119], v[172:175], v[180:183], v[116:119]
    v_mfma_f32_16x16x32_bf16 v[120:123], v[172:175], v[184:187], v[120:123]
    v_mfma_f32_16x16x32_bf16 v[124:127], v[172:175], v[188:191], v[124:127]
    ds_write_b32 v26, v64 offset:0
    ds_write_b32 v26, v65 offset:256
    ds_write_b32 v26, v66 offset:512
    ds_write_b32 v26, v67 offset:768
    ds_write_b32 v26, v68 offset:64
    ds_write_b32 v26, v69 offset:320
    ds_write_b32 v26, v70 offset:576
    ds_write_b32 v26, v71 offset:832
    ds_write_b32 v26, v72 offset:128
    ds_write_b32 v26, v73 offset:384
    ds_write_b32 v26, v74 offset:640
    ds_write_b32 v26, v75 offset:896
    ds_write_b32 v26, v76 offset:192
    ds_write_b32 v26, v77 offset:448
    ds_write_b32 v26, v78 offset:704
    ds_write_b32 v26, v79 offset:960
    ds_write_b32 v26, v80 offset:4096
    ds_write_b32 v26, v81 offset:4352
    ds_write_b32 v26, v82 offset:4608
    ds_write_b32 v26, v83 offset:4864
    ds_write_b32 v26, v84 offset:4160
    ds_write_b32 v26, v85 offset:4416
    ds_write_b32 v26, v86 offset:4672
    ds_write_b32 v26, v87 offset:4928
    ds_write_b32 v26, v88 offset:4224
    ds_write_b32 v26, v89 offset:4480
    ds_write_b32 v26, v90 offset:4736
    ds_write_b32 v26, v91 offset:4992
    ds_write_b32 v26, v92 offset:4288
    ds_write_b32 v26, v93 offset:4544
    ds_write_b32 v26, v94 offset:4800
    ds_write_b32 v26, v95 offset:5056
    ds_write_b32 v26, v96 offset:8192
    ds_write_b32 v26, v97 offset:8448
    ds_write_b32 v26, v98 offset:8704
    ds_write_b32 v26, v99 offset:8960
    ds_write_b32 v26, v100 offset:8256
    ds_write_b32 v26, v101 offset:8512
    ds_write_b32 v26, v102 offset:8768
    ds_write_b32 v26, v103 offset:9024
    ds_write_b32 v26, v104 offset:8320
    ds_write_b32 v26, v105 offset:8576
    ds_write_b32 v26, v106 offset:8832
    ds_write_b32 v26, v107 offset:9088
    ds_write_b32 v26, v108 offset:8384
    ds_write_b32 v26, v109 offset:8640
    ds_write_b32 v26, v110 offset:8896
    ds_write_b32 v26, v111 offset:9152
    ds_write_b32 v26, v112 offset:12288
    ds_write_b32 v26, v113 offset:12544
    ds_write_b32 v26, v114 offset:12800
    ds_write_b32 v26, v115 offset:13056
    ds_write_b32 v26, v116 offset:12352
    ds_write_b32 v26, v117 offset:12608
    ds_write_b32 v26, v118 offset:12864
    ds_write_b32 v26, v119 offset:13120
    ds_write_b32 v26, v120 offset:12416
    ds_write_b32 v26, v121 offset:12672
    ds_write_b32 v26, v122 offset:12928
    ds_write_b32 v26, v123 offset:13184
    ds_write_b32 v26, v124 offset:12480
    ds_write_b32 v26, v125 offset:12736
    ds_write_b32 v26, v126 offset:12992
    ds_write_b32 v26, v127 offset:13248
    s_waitcnt lgkmcnt(0)
    ds_read_b128 v[128:131], v27 offset:0
    ds_read_b128 v[132:135], v27 offset:1024
    ds_read_b128 v[136:139], v27 offset:2048
    ds_read_b128 v[140:143], v27 offset:3072
    ds_read_b128 v[144:147], v27 offset:4096
    ds_read_b128 v[148:151], v27 offset:5120
    ds_read_b128 v[152:155], v27 offset:6144
    ds_read_b128 v[156:159], v27 offset:7168
    ds_read_b128 v[160:163], v27 offset:8192
    ds_read_b128 v[164:167], v27 offset:9216
    ds_read_b128 v[168:171], v27 offset:10240
    ds_read_b128 v[172:175], v27 offset:11264
    ds_read_b128 v[176:179], v27 offset:12288
    ds_read_b128 v[180:183], v27 offset:13312
    ds_read_b128 v[184:187], v27 offset:14336
    ds_read_b128 v[188:191], v27 offset:15360
    s_mov_b32 s78, 0x0
    s_waitcnt lgkmcnt(15)
    v_cvt_pk_bf16_f32 v64, v128, v129
    v_cvt_pk_bf16_f32 v65, v130, v131
    v_lshlrev_b32 v128, 16, v64
    v_and_b32 v129, 0xffff0000, v64
    v_lshlrev_b32 v130, 16, v65
    v_and_b32 v131, 0xffff0000, v65
    buffer_store_dwordx4 v[128:131], v24, s[56:59], s78 offen
    s_mov_b32 s78, 0x8000
    s_waitcnt lgkmcnt(14)
    v_cvt_pk_bf16_f32 v66, v132, v133
    v_cvt_pk_bf16_f32 v67, v134, v135
    v_lshlrev_b32 v132, 16, v66
    v_and_b32 v133, 0xffff0000, v66
    v_lshlrev_b32 v134, 16, v67
    v_and_b32 v135, 0xffff0000, v67
    buffer_store_dwordx4 v[132:135], v24, s[56:59], s78 offen
    s_mov_b32 s78, 0x10000
    s_waitcnt lgkmcnt(13)
    v_cvt_pk_bf16_f32 v68, v136, v137
    v_cvt_pk_bf16_f32 v69, v138, v139
    v_lshlrev_b32 v136, 16, v68
    v_and_b32 v137, 0xffff0000, v68
    v_lshlrev_b32 v138, 16, v69
    v_and_b32 v139, 0xffff0000, v69
    buffer_store_dwordx4 v[136:139], v24, s[56:59], s78 offen
    s_mov_b32 s78, 0x18000
    s_waitcnt lgkmcnt(12)
    v_cvt_pk_bf16_f32 v70, v140, v141
    v_cvt_pk_bf16_f32 v71, v142, v143
    v_lshlrev_b32 v140, 16, v70
    v_and_b32 v141, 0xffff0000, v70
    v_lshlrev_b32 v142, 16, v71
    v_and_b32 v143, 0xffff0000, v71
    buffer_store_dwordx4 v[140:143], v24, s[56:59], s78 offen
    s_mov_b32 s78, 0x20000
    s_waitcnt lgkmcnt(11)
    v_cvt_pk_bf16_f32 v64, v144, v145
    v_cvt_pk_bf16_f32 v65, v146, v147
    v_lshlrev_b32 v144, 16, v64
    v_and_b32 v145, 0xffff0000, v64
    v_lshlrev_b32 v146, 16, v65
    v_and_b32 v147, 0xffff0000, v65
    buffer_store_dwordx4 v[144:147], v24, s[56:59], s78 offen
    s_mov_b32 s78, 0x28000
    s_waitcnt lgkmcnt(10)
    v_cvt_pk_bf16_f32 v66, v148, v149
    v_cvt_pk_bf16_f32 v67, v150, v151
    v_lshlrev_b32 v148, 16, v66
    v_and_b32 v149, 0xffff0000, v66
    v_lshlrev_b32 v150, 16, v67
    v_and_b32 v151, 0xffff0000, v67
    buffer_store_dwordx4 v[148:151], v24, s[56:59], s78 offen
    s_mov_b32 s78, 0x30000
    s_waitcnt lgkmcnt(9)
    v_cvt_pk_bf16_f32 v68, v152, v153
    v_cvt_pk_bf16_f32 v69, v154, v155
    v_lshlrev_b32 v152, 16, v68
    v_and_b32 v153, 0xffff0000, v68
    v_lshlrev_b32 v154, 16, v69
    v_and_b32 v155, 0xffff0000, v69
    buffer_store_dwordx4 v[152:155], v24, s[56:59], s78 offen
    s_mov_b32 s78, 0x38000
    s_waitcnt lgkmcnt(8)
    v_cvt_pk_bf16_f32 v70, v156, v157
    v_cvt_pk_bf16_f32 v71, v158, v159
    v_lshlrev_b32 v156, 16, v70
    v_and_b32 v157, 0xffff0000, v70
    v_lshlrev_b32 v158, 16, v71
    v_and_b32 v159, 0xffff0000, v71
    buffer_store_dwordx4 v[156:159], v24, s[56:59], s78 offen
    s_mov_b32 s78, 0x40000
    s_waitcnt lgkmcnt(7)
    v_cvt_pk_bf16_f32 v64, v160, v161
    v_cvt_pk_bf16_f32 v65, v162, v163
    v_lshlrev_b32 v160, 16, v64
    v_and_b32 v161, 0xffff0000, v64
    v_lshlrev_b32 v162, 16, v65
    v_and_b32 v163, 0xffff0000, v65
    buffer_store_dwordx4 v[160:163], v24, s[56:59], s78 offen
    s_mov_b32 s78, 0x48000
    s_waitcnt lgkmcnt(6)
    v_cvt_pk_bf16_f32 v66, v164, v165
    v_cvt_pk_bf16_f32 v67, v166, v167
    v_lshlrev_b32 v164, 16, v66
    v_and_b32 v165, 0xffff0000, v66
    v_lshlrev_b32 v166, 16, v67
    v_and_b32 v167, 0xffff0000, v67
    buffer_store_dwordx4 v[164:167], v24, s[56:59], s78 offen
    s_mov_b32 s78, 0x50000
    s_waitcnt lgkmcnt(5)
    v_cvt_pk_bf16_f32 v68, v168, v169
    v_cvt_pk_bf16_f32 v69, v170, v171
    v_lshlrev_b32 v168, 16, v68
    v_and_b32 v169, 0xffff0000, v68
    v_lshlrev_b32 v170, 16, v69
    v_and_b32 v171, 0xffff0000, v69
    buffer_store_dwordx4 v[168:171], v24, s[56:59], s78 offen
    s_mov_b32 s78, 0x58000
    s_waitcnt lgkmcnt(4)
    v_cvt_pk_bf16_f32 v70, v172, v173
    v_cvt_pk_bf16_f32 v71, v174, v175
    v_lshlrev_b32 v172, 16, v70
    v_and_b32 v173, 0xffff0000, v70
    v_lshlrev_b32 v174, 16, v71
    v_and_b32 v175, 0xffff0000, v71
    buffer_store_dwordx4 v[172:175], v24, s[56:59], s78 offen
    s_mov_b32 s78, 0x60000
    s_waitcnt lgkmcnt(3)
    v_cvt_pk_bf16_f32 v64, v176, v177
    v_cvt_pk_bf16_f32 v65, v178, v179
    v_lshlrev_b32 v176, 16, v64
    v_and_b32 v177, 0xffff0000, v64
    v_lshlrev_b32 v178, 16, v65
    v_and_b32 v179, 0xffff0000, v65
    buffer_store_dwordx4 v[176:179], v24, s[56:59], s78 offen
    s_mov_b32 s78, 0x68000
    s_waitcnt lgkmcnt(2)
    v_cvt_pk_bf16_f32 v66, v180, v181
    v_cvt_pk_bf16_f32 v67, v182, v183
    v_lshlrev_b32 v180, 16, v66
    v_and_b32 v181, 0xffff0000, v66
    v_lshlrev_b32 v182, 16, v67
    v_and_b32 v183, 0xffff0000, v67
    buffer_store_dwordx4 v[180:183], v24, s[56:59], s78 offen
    s_mov_b32 s78, 0x70000
    s_waitcnt lgkmcnt(1)
    v_cvt_pk_bf16_f32 v68, v184, v185
    v_cvt_pk_bf16_f32 v69, v186, v187
    v_lshlrev_b32 v184, 16, v68
    v_and_b32 v185, 0xffff0000, v68
    v_lshlrev_b32 v186, 16, v69
    v_and_b32 v187, 0xffff0000, v69
    buffer_store_dwordx4 v[184:187], v24, s[56:59], s78 offen
    s_mov_b32 s78, 0x78000
    s_waitcnt lgkmcnt(0)
    v_cvt_pk_bf16_f32 v70, v188, v189
    v_cvt_pk_bf16_f32 v71, v190, v191
    v_lshlrev_b32 v188, 16, v70
    v_and_b32 v189, 0xffff0000, v70
    v_lshlrev_b32 v190, 16, v71
    v_and_b32 v191, 0xffff0000, v71
    buffer_store_dwordx4 v[188:191], v24, s[56:59], s78 offen
    s_endpgm
k1_B:
    s_lshl_b32 s5, s75, 6
    s_lshl_b32 s6, s77, 5
    s_add_u32 s5, s5, s6
    v_add_u32 v32, s5, v2
    v_lshlrev_b32 v4, 1, v32
    global_load_ushort v38, v4, s[26:27]
    global_load_ushort v39, v4, s[28:29]
    global_load_ushort v40, v4, s[38:39]
    s_mov_b32 s48, s24
    s_and_b32 s49, s25, 0xffff
    s_mov_b32 s50, 0x400000
    s_mov_b32 s51, 0x00020000
    s_mov_b32 s52, s30
    s_and_b32 s53, s31, 0xffff
    s_mov_b32 s54, 0x200000
    s_mov_b32 s55, 0x00020000
    s_mov_b32 s56, s32
    s_and_b32 s57, s33, 0xffff
    s_mov_b32 s58, 0x200000
    s_mov_b32 s59, 0x00020000
    s_and_b32 s4, s64, 3
    s_cmp_ge_u32 s4, 2
    s_cselect_b32 s52, s56, s52
    s_cselect_b32 s53, s57, s53
    s_lshl_b32 s5, s74, 8
    s_lshl_b32 s6, s4, 6
    s_add_u32 s6, s5, s6
    v_lshrrev_b32 v4, 3, v1
    v_add_u32 v4, s6, v4
    v_lshlrev_b32 v4, 11, v4
    v_lshrrev_b32 v5, 4, v1
    v_and_b32 v6, 7, v1
    v_xor_b32 v5, v5, v6
    v_xor_b32 v6, 0, v5
    v_lshl_add_u32 v13, v6, 4, v4
    v_xor_b32 v6, 4, v5
    v_lshl_add_u32 v14, v6, 4, v4
    v_add_u32 v14, 0xfc00, v14
    v_xor_b32 v6, 0, v5
    v_lshl_add_u32 v15, v6, 4, v4
    v_add_u32 v15, 0x3800, v15
    v_xor_b32 v6, 4, v5
    v_lshl_add_u32 v16, v6, 4, v4
    v_add_u32 v16, 0x13400, v16
    v_xor_b32 v6, 0, v5
    v_lshl_add_u32 v17, v6, 4, v4
    v_add_u32 v17, 0x8000, v17
    v_xor_b32 v6, 4, v5
    v_lshl_add_u32 v18, v6, 4, v4
    v_add_u32 v18, 0x17c00, v18
    v_xor_b32 v6, 0, v5
    v_lshl_add_u32 v19, v6, 4, v4
    v_add_u32 v19, 0xb800, v19
    v_xor_b32 v6, 4, v5
    v_lshl_add_u32 v20, v6, 4, v4
    v_add_u32 v20, 0x1b400, v20
    s_lshl_b32 s70, s7, 7
    s_lshl_b32 s5, s75, 6
    s_and_b32 s6, s4, 1
    s_lshl_b32 s6, s6, 5
    s_add_u32 s5, s5, s6
    v_lshrrev_b32 v4, 3, v1
    v_add_u32 v4, s5, v4
    v_lshlrev_b32 v4, 11, v4
    v_xor_b32 v6, 0, v5
    v_lshl_add_u32 v176, v6, 4, v4
    v_xor_b32 v6, 4, v5
    v_lshl_add_u32 v177, v6, 4, v4
    v_add_u32 v177, 0x3c00, v177
    v_xor_b32 v6, 0, v5
    v_lshl_add_u32 v178, v6, 4, v4
    v_add_u32 v178, 0x7800, v178
    v_xor_b32 v6, 4, v5
    v_lshl_add_u32 v179, v6, 4, v4
    v_add_u32 v179, 0xb400, v179
    s_lshl_b32 s66, s4, 12
    s_add_u32 s66, s66, 98304
    s_add_u32 s5, s7, 0
    s_and_b32 s5, s5, 15
    s_mul_i32 s71, s5, 0x80
    s_mov_b32 s11, 0x80
    s_mov_b32 s15, 0x800
    s_lshl_b32 s69, s77, 12
    v_bfe_u32 v4, v1, 1, 3
    v_and_b32 v5, 15, v1
    v_lshlrev_b32 v5, 7, v5
    v_add_u32 v5, s69, v5
    v_add_u32 v5, 0x18000, v5
    v_lshrrev_b32 v12, 4, v1
    v_xor_b32 v12, v12, v4
    v_lshl_add_u32 v12, v12, 4, v5
    v_lshrrev_b32 v21, 4, v1
    v_or_b32 v21, 4, v21
    v_xor_b32 v21, v21, v4
    v_lshl_add_u32 v21, v21, 4, v5
    s_cmp_ge_u32 s64, 4
    s_cbranch_scc1 k1b_r1
    s_mov_b32 m0, s72
    s_add_u32 s72, s72, 0x8000
    buffer_load_dwordx4 v13, s[48:51], s70 offen offset:0 lds
    buffer_load_dwordx4 v14, s[48:51], s70 offen offset:1024 lds
    buffer_load_dwordx4 v15, s[48:51], s70 offen offset:2048 lds
    buffer_load_dwordx4 v16, s[48:51], s70 offen offset:3072 lds
    s_mov_b32 m0, s73
    s_add_u32 s73, s73, 0x8000
    buffer_load_dwordx4 v17, s[48:51], s70 offen offset:0 lds
    buffer_load_dwordx4 v18, s[48:51], s70 offen offset:1024 lds
    buffer_load_dwordx4 v19, s[48:51], s70 offen offset:2048 lds
    buffer_load_dwordx4 v20, s[48:51], s70 offen offset:3072 lds
    s_add_u32 s70, s70, 128
    s_and_b32 s70, s70, 0x7ff
    s_mov_b32 m0, s66
    s_add_u32 s66, s66, 0x4000
    buffer_load_dwordx4 v176, s[52:55], s71 offen offset:0 lds
    buffer_load_dwordx4 v177, s[52:55], s71 offen offset:1024 lds
    buffer_load_dwordx4 v178, s[52:55], s71 offen offset:2048 lds
    buffer_load_dwordx4 v179, s[52:55], s71 offen offset:3072 lds
    s_add_u32 s71, s71, s11
    s_cmp_eq_u32 s71, s15
    s_cselect_b32 s71, 0, s71
    s_mov_b32 m0, s72
    s_add_u32 s72, s72, 0x8000
    buffer_load_dwordx4 v13, s[48:51], s70 offen offset:0 lds
    buffer_load_dwordx4 v14, s[48:51], s70 offen offset:1024 lds
    buffer_load_dwordx4 v15, s[48:51], s70 offen offset:2048 lds
    buffer_load_dwordx4 v16, s[48:51], s70 offen offset:3072 lds
    s_mov_b32 m0, s73
    s_add_u32 s73, s73, 0x8000
    buffer_load_dwordx4 v17, s[48:51], s70 offen offset:0 lds
    buffer_load_dwordx4 v18, s[48:51], s70 offen offset:1024 lds
    buffer_load_dwordx4 v19, s[48:51], s70 offen offset:2048 lds
    buffer_load_dwordx4 v20, s[48:51], s70 offen offset:3072 lds
    s_add_u32 s70, s70, 128
    s_and_b32 s70, s70, 0x7ff
    s_mov_b32 m0, s66
    s_add_u32 s66, s66, 0x4000
    buffer_load_dwordx4 v176, s[52:55], s71 offen offset:0 lds
    buffer_load_dwordx4 v177, s[52:55], s71 offen offset:1024 lds
    buffer_load_dwordx4 v178, s[52:55], s71 offen offset:2048 lds
    buffer_load_dwordx4 v179, s[52:55], s71 offen offset:3072 lds
    s_add_u32 s71, s71, s11
    s_cmp_eq_u32 s71, s15
    s_cselect_b32 s71, 0, s71
    s_mov_b32 m0, s72
    s_add_u32 s72, s72, 0xffff0000
    buffer_load_dwordx4 v13, s[48:51], s70 offen offset:0 lds
    buffer_load_dwordx4 v14, s[48:51], s70 offen offset:1024 lds
    buffer_load_dwordx4 v15, s[48:51], s70 offen offset:2048 lds
    buffer_load_dwordx4 v16, s[48:51], s70 offen offset:3072 lds
    s_mov_b32 m0, s73
    s_add_u32 s73, s73, 0xffff0000
    buffer_load_dwordx4 v17, s[48:51], s70 offen offset:0 lds
    buffer_load_dwordx4 v18, s[48:51], s70 offen offset:1024 lds
    buffer_load_dwordx4 v19, s[48:51], s70 offen offset:2048 lds
    buffer_load_dwordx4 v20, s[48:51], s70 offen offset:3072 lds
    s_add_u32 s70, s70, 128
    s_and_b32 s70, s70, 0x7ff
    s_mov_b32 m0, s66
    s_add_u32 s66, s66, 0xffff8000
    buffer_load_dwordx4 v176, s[52:55], s71 offen offset:0 lds
    buffer_load_dwordx4 v177, s[52:55], s71 offen offset:1024 lds
    buffer_load_dwordx4 v178, s[52:55], s71 offen offset:2048 lds
    buffer_load_dwordx4 v179, s[52:55], s71 offen offset:3072 lds
    s_add_u32 s71, s71, s11
    s_cmp_eq_u32 s71, s15
    s_cselect_b32 s71, 0, s71
    s_mov_b32 s67, 0x8000
    s_mov_b32 s68, 0x8000
    s_mov_b32 s79, 0xffff0000
    s_mov_b32 s12, 0x4000
    s_mov_b32 s13, 0x4000
    s_mov_b32 s14, 0xffff8000
    s_waitcnt vmcnt(36)
    v_lshlrev_b32 v38, 16, v38
    v_lshlrev_b32 v39, 16, v39
    v_lshlrev_b32 v40, 16, v40
    v_mul_f32 v40, s8, v40
    v_exp_f32 v40, v40
    s_nop 0
    v_cvt_pk_bf16_f32 v40, v40, v40
    v_lshlrev_b32 v40, 16, v40
    v_mul_f32 v41, v40, v38
    v_mul_f32 v42, v40, v39
    v_mul_f32 v41, s8, v41
    v_exp_f32 v41, v41
    v_mul_f32 v42, 0.15915494, v42
    v_rndne_f32 v43, v42
    v_sub_f32 v42, v42, v43
    v_cos_f32 v24, v42
    v_sin_f32 v25, v42
    v_mul_f32 v24, v24, v41
    v_mul_f32 v25, v25, v41
    v_add_f32 v43, -1.0, v24
    v_mul_f32 v44, v38, v38
    v_fma_f32 v44, v39, v39, v44
    v_rcp_f32 v44, v44
    v_mul_f32 v26, v43, v38
    v_fma_f32 v26, v25, v39, v26
    v_mul_f32 v27, v43, v39
    v_fma_f32 v27, v25, v38, -v27
    v_add_f32 v44, v44, v44
    v_mul_f32 v26, v26, v44
    v_mul_f32 v27, v27, v44
    v_mov_b32 v28, v24
    v_mov_b32 v29, v25
    v_mul_f32 v45, v29, v29
    v_mul_f32 v46, v28, v29
    v_fma_f32 v45, v28, v28, -v45
    v_fma_f32 v29, v29, v28, v46
    v_mov_b32 v28, v45
    v_mul_f32 v45, v29, v29
    v_mul_f32 v46, v28, v29
    v_fma_f32 v45, v28, v28, -v45
    v_fma_f32 v29, v29, v28, v46
    v_mov_b32 v28, v45
    v_mul_f32 v45, v29, v29
    v_mul_f32 v46, v28, v29
    v_fma_f32 v45, v28, v28, -v45
    v_fma_f32 v29, v29, v28, v46
    v_mov_b32 v28, v45
    v_mul_f32 v45, v29, v29
    v_mul_f32 v46, v28, v29
    v_fma_f32 v45, v28, v28, -v45
    v_fma_f32 v29, v29, v28, v46
    v_mov_b32 v28, v45
    v_mul_f32 v45, v29, v29
    v_mul_f32 v46, v28, v29
    v_fma_f32 v45, v28, v28, -v45
    v_fma_f32 v29, v29, v28, v46
    v_mov_b32 v28, v45
    v_mov_b32 v30, v28
    v_mov_b32 v31, v29
    v_mul_f32 v45, v31, v31
    v_mul_f32 v46, v30, v31
    v_fma_f32 v45, v30, v30, -v45
    v_fma_f32 v31, v31, v30, v46
    v_mov_b32 v30, v45
    v_mul_f32 v45, v31, v31
    v_mul_f32 v46, v30, v31
    v_fma_f32 v45, v30, v30, -v45
    v_fma_f32 v31, v31, v30, v46
    v_mov_b32 v30, v45
    v_mul_f32 v45, v31, v31
    v_mul_f32 v46, v30, v31
    v_fma_f32 v45, v30, v30, -v45
    v_fma_f32 v31, v31, v30, v46
    v_mov_b32 v30, v45
    s_lshl_b32 s5, s75, 2
    s_add_u32 s5, s5, 64
    v_mov_b32 v33, s5
    s_lshl_b32 s5, 1, s74
    v_mov_b32 v34, s5
    v_and_b32 v4, 1, v1
    v_mov_b32 v35, 0x05040100
    v_mov_b32 v5, 0x03020706
    v_cmp_eq_u32 vcc, 1, v4
    s_nop 1
    v_cndmask_b32 v35, v35, v5, vcc
    s_lshl_b32 s5, s76, 14
    s_lshl_b32 s6, s77, 6
    s_add_u32 s5, s5, s6
    v_lshl_add_u32 v47, v3, 13, s5
    v_lshl_add_u32 v47, v4, 7, v47
    v_and_b32 v5, 30, v2
    v_lshl_add_u32 v47, v5, 1, v47
    s_lshl_b32 s5, s74, 8
    s_lshl_b32 s6, s64, 5
    s_add_u32 s5, s5, s6
    v_lshrrev_b32 v5, 4, v1
    v_add_u32 v5, s5, v5
    v_lshlrev_b32 v36, 12, v5
    v_bfe_u32 v5, v1, 3, 1
    v_lshl_add_u32 v36, v5, 11, v36
    v_and_b32 v5, 7, v1
    v_lshl_add_u32 v36, v5, 4, v36
    s_lshl_b32 s5, s75, 7
    v_add_u32 v36, s5, v36
    s_lshl_b32 s5, s76, 1
    v_add_u32 v37, s5, v3
    s_waitcnt vmcnt(24)
    s_barrier
    ds_read_b128 v[112:115], v8 offset:0
    ds_read_b128 v[128:131], v12 offset:0
    ds_read_b128 v[132:135], v12 offset:2048
    ds_read_b128 v[136:139], v12 offset:8192
    ds_read_b128 v[140:143], v12 offset:10240
    ds_read_b128 v[116:119], v8 offset:2048
    ds_read_b128 v[120:123], v8 offset:4096
    ds_read_b128 v[124:127], v8 offset:6144
    v_add_u32 v8, s67, v8
    v_add_u32 v12, s12, v12
    s_waitcnt lgkmcnt(0)
    v_mfma_f32_16x16x32_bf16 v[48:51], v[112:115], v[128:131], 0
    ds_read_b128 v[144:147], v9 offset:0
    v_mfma_f32_16x16x32_bf16 v[52:55], v[112:115], v[132:135], 0
    ds_read_b128 v[160:163], v21 offset:0
    v_mfma_f32_16x16x32_bf16 v[56:59], v[112:115], v[136:139], 0
    v_mfma_f32_16x16x32_bf16 v[60:63], v[112:115], v[140:143], 0
    ds_read_b128 v[164:167], v21 offset:2048
    v_mfma_f32_16x16x32_bf16 v[64:67], v[116:119], v[128:131], 0
    ds_read_b128 v[168:171], v21 offset:8192
    v_mfma_f32_16x16x32_bf16 v[68:71], v[116:119], v[132:135], 0
    v_mfma_f32_16x16x32_bf16 v[72:75], v[116:119], v[136:139], 0
    ds_read_b128 v[172:175], v21 offset:10240
    v_mfma_f32_16x16x32_bf16 v[76:79], v[116:119], v[140:143], 0
    v_mfma_f32_16x16x32_bf16 v[80:83], v[120:123], v[128:131], 0
    ds_read_b128 v[148:151], v9 offset:2048
    v_mfma_f32_16x16x32_bf16 v[84:87], v[120:123], v[132:135], 0
    ds_read_b128 v[152:155], v9 offset:4096
    v_mfma_f32_16x16x32_bf16 v[88:91], v[120:123], v[136:139], 0
    v_mfma_f32_16x16x32_bf16 v[92:95], v[120:123], v[140:143], 0
    ds_read_b128 v[156:159], v9 offset:6144
    v_mfma_f32_16x16x32_bf16 v[96:99], v[124:127], v[128:131], 0
    v_add_u32 v9, s67, v9
    v_mfma_f32_16x16x32_bf16 v[100:103], v[124:127], v[132:135], 0
    v_mfma_f32_16x16x32_bf16 v[104:107], v[124:127], v[136:139], 0
    v_add_u32 v21, s12, v21
    v_mfma_f32_16x16x32_bf16 v[108:111], v[124:127], v[140:143], 0
    s_waitcnt vmcnt(12) lgkmcnt(0)
    s_barrier
    v_mfma_f32_16x16x32_bf16 v[48:51], v[144:147], v[160:163], v[48:51]
    ds_read_b128 v[112:115], v8 offset:0
    ds_read_b128 v[128:131], v12 offset:0
    v_mfma_f32_16x16x32_bf16 v[52:55], v[144:147], v[164:167], v[52:55]
    ds_read_b128 v[132:135], v12 offset:2048
    v_mfma_f32_16x16x32_bf16 v[56:59], v[144:147], v[168:171], v[56:59]
    ds_read_b128 v[136:139], v12 offset:8192
    ds_read_b128 v[140:143], v12 offset:10240
    v_mfma_f32_16x16x32_bf16 v[60:63], v[144:147], v[172:175], v[60:63]
    ds_read_b128 v[116:119], v8 offset:2048
    v_mfma_f32_16x16x32_bf16 v[64:67], v[148:151], v[160:163], v[64:67]
    ds_read_b128 v[120:123], v8 offset:4096
    ds_read_b128 v[124:127], v8 offset:6144
    v_mfma_f32_16x16x32_bf16 v[68:71], v[148:151], v[164:167], v[68:71]
    v_add_u32 v8, s68, v8
    v_mfma_f32_16x16x32_bf16 v[72:75], v[148:151], v[168:171], v[72:75]
    v_add_u32 v12, s13, v12
    s_mov_b32 m0, s72
    s_add_u32 s72, s72, s67
    buffer_load_dwordx4 v13, s[48:51], s70 offen offset:0 lds
    v_mfma_f32_16x16x32_bf16 v[76:79], v[148:151], v[172:175], v[76:79]
    buffer_load_dwordx4 v14, s[48:51], s70 offen offset:1024 lds
    v_mfma_f32_16x16x32_bf16 v[80:83], v[152:155], v[160:163], v[80:83]
    buffer_load_dwordx4 v15, s[48:51], s70 offen offset:2048 lds
    buffer_load_dwordx4 v16, s[48:51], s70 offen offset:3072 lds
    v_mfma_f32_16x16x32_bf16 v[84:87], v[152:155], v[164:167], v[84:87]
    s_mov_b32 m0, s73
    s_add_u32 s73, s73, s67
    buffer_load_dwordx4 v17, s[48:51], s70 offen offset:0 lds
    v_mfma_f32_16x16x32_bf16 v[88:91], v[152:155], v[168:171], v[88:91]
    buffer_load_dwordx4 v18, s[48:51], s70 offen offset:1024 lds
    s_mov_b32 s69, s67
    v_mfma_f32_16x16x32_bf16 v[92:95], v[152:155], v[172:175], v[92:95]
    s_mov_b32 s67, s68
    v_mfma_f32_16x16x32_bf16 v[96:99], v[156:159], v[160:163], v[96:99]
    s_mov_b32 s68, s79
    s_mov_b32 s79, s69
    v_mfma_f32_16x16x32_bf16 v[100:103], v[156:159], v[164:167], v[100:103]
    s_mov_b32 s69, s12
    v_mfma_f32_16x16x32_bf16 v[104:107], v[156:159], v[168:171], v[104:107]
    s_mov_b32 s12, s13
    s_mov_b32 s13, s14
    v_mfma_f32_16x16x32_bf16 v[108:111], v[156:159], v[172:175], v[108:111]
    s_mov_b32 s14, s69
    s_mov_b32 s65, 12
k1bd_L0:
    s_waitcnt lgkmcnt(0)
    v_mfma_f32_16x16x32_bf16 v[48:51], v[112:115], v[128:131], v[48:51]
    ds_read_b128 v[144:147], v9 offset:0
    v_mfma_f32_16x16x32_bf16 v[52:55], v[112:115], v[132:135], v[52:55]
    ds_read_b128 v[160:163], v21 offset:0
    v_mfma_f32_16x16x32_bf16 v[56:59], v[112:115], v[136:139], v[56:59]
    ds_read_b128 v[164:167], v21 offset:2048
    v_mfma_f32_16x16x32_bf16 v[60:63], v[112:115], v[140:143], v[60:63]
    ds_read_b128 v[168:171], v21 offset:8192
    v_mfma_f32_16x16x32_bf16 v[64:67], v[116:119], v[128:131], v[64:67]
    ds_read_b128 v[172:175], v21 offset:10240
    v_mfma_f32_16x16x32_bf16 v[68:71], v[116:119], v[132:135], v[68:71]
    ds_read_b128 v[148:151], v9 offset:2048
    v_mfma_f32_16x16x32_bf16 v[72:75], v[116:119], v[136:139], v[72:75]
    ds_read_b128 v[152:155], v9 offset:4096
    v_mfma_f32_16x16x32_bf16 v[76:79], v[116:119], v[140:143], v[76:79]
    ds_read_b128 v[156:159], v9 offset:6144
    v_mfma_f32_16x16x32_bf16 v[80:83], v[120:123], v[128:131], v[80:83]
    v_add_u32 v9, s67, v9
    v_mfma_f32_16x16x32_bf16 v[84:87], v[120:123], v[132:135], v[84:87]
    v_add_u32 v21, s12, v21
    v_mfma_f32_16x16x32_bf16 v[88:91], v[120:123], v[136:139], v[88:91]
    buffer_load_dwordx4 v19, s[48:51], s70 offen offset:2048 lds
    v_mfma_f32_16x16x32_bf16 v[92:95], v[120:123], v[140:143], v[92:95]
    buffer_load_dwordx4 v20, s[48:51], s70 offen offset:3072 lds
    s_add_u32 s70, s70, 128
    s_and_b32 s70, s70, 0x7ff
    v_mfma_f32_16x16x32_bf16 v[96:99], v[124:127], v[128:131], v[96:99]
    s_mov_b32 m0, s66
    s_add_u32 s66, s66, s14
    buffer_load_dwordx4 v176, s[52:55], s71 offen offset:0 lds
    v_mfma_f32_16x16x32_bf16 v[100:103], v[124:127], v[132:135], v[100:103]
    buffer_load_dwordx4 v177, s[52:55], s71 offen offset:1024 lds
    v_mfma_f32_16x16x32_bf16 v[104:107], v[124:127], v[136:139], v[104:107]
    buffer_load_dwordx4 v178, s[52:55], s71 offen offset:2048 lds
    v_mfma_f32_16x16x32_bf16 v[108:111], v[124:127], v[140:143], v[108:111]
    buffer_load_dwordx4 v179, s[52:55], s71 offen offset:3072 lds
    s_add_u32 s71, s71, s11
    s_cmp_eq_u32 s71, s15
    s_cselect_b32 s71, 0, s71
    s_waitcnt vmcnt(12) lgkmcnt(0)
    s_barrier
    v_mfma_f32_16x16x32_bf16 v[48:51], v[144:147], v[160:163], v[48:51]
    ds_read_b128 v[112:115], v8 offset:0
    ds_read_b128 v[128:131], v12 offset:0
    v_mfma_f32_16x16x32_bf16 v[52:55], v[144:147], v[164:167], v[52:55]
    ds_read_b128 v[132:135], v12 offset:2048
    v_mfma_f32_16x16x32_bf16 v[56:59], v[144:147], v[168:171], v[56:59]
    ds_read_b128 v[136:139], v12 offset:8192
    ds_read_b128 v[140:143], v12 offset:10240
    v_mfma_f32_16x16x32_bf16 v[60:63], v[144:147], v[172:175], v[60:63]
    ds_read_b128 v[116:119], v8 offset:2048
    v_mfma_f32_16x16x32_bf16 v[64:67], v[148:151], v[160:163], v[64:67]
    ds_read_b128 v[120:123], v8 offset:4096
    ds_read_b128 v[124:127], v8 offset:6144
    v_mfma_f32_16x16x32_bf16 v[68:71], v[148:151], v[164:167], v[68:71]
    v_add_u32 v8, s68, v8
    v_mfma_f32_16x16x32_bf16 v[72:75], v[148:151], v[168:171], v[72:75]
    v_add_u32 v12, s13, v12
    s_mov_b32 m0, s72
    s_add_u32 s72, s72, s67
    buffer_load_dwordx4 v13, s[48:51], s70 offen offset:0 lds
    v_mfma_f32_16x16x32_bf16 v[76:79], v[148:151], v[172:175], v[76:79]
    buffer_load_dwordx4 v14, s[48:51], s70 offen offset:1024 lds
    v_mfma_f32_16x16x32_bf16 v[80:83], v[152:155], v[160:163], v[80:83]
    buffer_load_dwordx4 v15, s[48:51], s70 offen offset:2048 lds
    buffer_load_dwordx4 v16, s[48:51], s70 offen offset:3072 lds
    v_mfma_f32_16x16x32_bf16 v[84:87], v[152:155], v[164:167], v[84:87]
    s_mov_b32 m0, s73
    s_add_u32 s73, s73, s67
    buffer_load_dwordx4 v17, s[48:51], s70 offen offset:0 lds
    v_mfma_f32_16x16x32_bf16 v[88:91], v[152:155], v[168:171], v[88:91]
    buffer_load_dwordx4 v18, s[48:51], s70 offen offset:1024 lds
    s_mov_b32 s69, s67
    v_mfma_f32_16x16x32_bf16 v[92:95], v[152:155], v[172:175], v[92:95]
    s_mov_b32 s67, s68
    v_mfma_f32_16x16x32_bf16 v[96:99], v[156:159], v[160:163], v[96:99]
    s_mov_b32 s68, s79
    s_mov_b32 s79, s69
    v_mfma_f32_16x16x32_bf16 v[100:103], v[156:159], v[164:167], v[100:103]
    s_mov_b32 s69, s12
    v_mfma_f32_16x16x32_bf16 v[104:107], v[156:159], v[168:171], v[104:107]
    s_mov_b32 s12, s13
    s_mov_b32 s13, s14
    v_mfma_f32_16x16x32_bf16 v[108:111], v[156:159], v[172:175], v[108:111]
    s_mov_b32 s14, s69
    s_sub_u32 s65, s65, 1
    s_cmp_lg_u32 s65, 0
    s_cbranch_scc1 k1bd_L0
    s_waitcnt lgkmcnt(0)
    v_mfma_f32_16x16x32_bf16 v[48:51], v[112:115], v[128:131], v[48:51]
    ds_read_b128 v[144:147], v9 offset:0
    v_mfma_f32_16x16x32_bf16 v[52:55], v[112:115], v[132:135], v[52:55]
    ds_read_b128 v[160:163], v21 offset:0
    v_mfma_f32_16x16x32_bf16 v[56:59], v[112:115], v[136:139], v[56:59]
    ds_read_b128 v[164:167], v21 offset:2048
    v_mfma_f32_16x16x32_bf16 v[60:63], v[112:115], v[140:143], v[60:63]
    ds_read_b128 v[168:171], v21 offset:8192
    v_mfma_f32_16x16x32_bf16 v[64:67], v[116:119], v[128:131], v[64:67]
    ds_read_b128 v[172:175], v21 offset:10240
    v_mfma_f32_16x16x32_bf16 v[68:71], v[116:119], v[132:135], v[68:71]
    ds_read_b128 v[148:151], v9 offset:2048
    v_mfma_f32_16x16x32_bf16 v[72:75], v[116:119], v[136:139], v[72:75]
    ds_read_b128 v[152:155], v9 offset:4096
    v_mfma_f32_16x16x32_bf16 v[76:79], v[116:119], v[140:143], v[76:79]
    ds_read_b128 v[156:159], v9 offset:6144
    v_mfma_f32_16x16x32_bf16 v[80:83], v[120:123], v[128:131], v[80:83]
    v_add_u32 v9, s67, v9
    v_mfma_f32_16x16x32_bf16 v[84:87], v[120:123], v[132:135], v[84:87]
    v_add_u32 v21, s12, v21
    v_mfma_f32_16x16x32_bf16 v[88:91], v[120:123], v[136:139], v[88:91]
    buffer_load_dwordx4 v19, s[48:51], s70 offen offset:2048 lds
    v_mfma_f32_16x16x32_bf16 v[92:95], v[120:123], v[140:143], v[92:95]
    buffer_load_dwordx4 v20, s[48:51], s70 offen offset:3072 lds
    s_add_u32 s70, s70, 128
    s_and_b32 s70, s70, 0x7ff
    v_mfma_f32_16x16x32_bf16 v[96:99], v[124:127], v[128:131], v[96:99]
    s_mov_b32 m0, s66
    s_add_u32 s66, s66, s14
    buffer_load_dwordx4 v176, s[52:55], s71 offen offset:0 lds
    v_mfma_f32_16x16x32_bf16 v[100:103], v[124:127], v[132:135], v[100:103]
    buffer_load_dwordx4 v177, s[52:55], s71 offen offset:1024 lds
    v_mfma_f32_16x16x32_bf16 v[104:107], v[124:127], v[136:139], v[104:107]
    buffer_load_dwordx4 v178, s[52:55], s71 offen offset:2048 lds
    v_mfma_f32_16x16x32_bf16 v[108:111], v[124:127], v[140:143], v[108:111]
    buffer_load_dwordx4 v179, s[52:55], s71 offen offset:3072 lds
    s_add_u32 s71, s71, s11
    s_cmp_eq_u32 s71, s15
    s_cselect_b32 s71, 0, s71
    s_waitcnt vmcnt(12) lgkmcnt(0)
    s_barrier
    v_mfma_f32_16x16x32_bf16 v[48:51], v[144:147], v[160:163], v[48:51]
    ds_read_b128 v[112:115], v8 offset:0
    ds_read_b128 v[128:131], v12 offset:0
    v_mfma_f32_16x16x32_bf16 v[52:55], v[144:147], v[164:167], v[52:55]
    ds_read_b128 v[132:135], v12 offset:2048
    v_mfma_f32_16x16x32_bf16 v[56:59], v[144:147], v[168:171], v[56:59]
    ds_read_b128 v[136:139], v12 offset:8192
    v_mfma_f32_16x16x32_bf16 v[60:63], v[144:147], v[172:175], v[60:63]
    ds_read_b128 v[140:143], v12 offset:10240
    v_mfma_f32_16x16x32_bf16 v[64:67], v[148:151], v[160:163], v[64:67]
    ds_read_b128 v[116:119], v8 offset:2048
    v_mfma_f32_16x16x32_bf16 v[68:71], v[148:151], v[164:167], v[68:71]
    ds_read_b128 v[120:123], v8 offset:4096
    v_mfma_f32_16x16x32_bf16 v[72:75], v[148:151], v[168:171], v[72:75]
    ds_read_b128 v[124:127], v8 offset:6144
    v_mfma_f32_16x16x32_bf16 v[76:79], v[148:151], v[172:175], v[76:79]
    v_add_u32 v8, s68, v8
    v_mfma_f32_16x16x32_bf16 v[80:83], v[152:155], v[160:163], v[80:83]
    v_add_u32 v12, s13, v12
    s_mov_b32 s69, s67
    v_mfma_f32_16x16x32_bf16 v[84:87], v[152:155], v[164:167], v[84:87]
    s_mov_b32 s67, s68
    v_mfma_f32_16x16x32_bf16 v[88:91], v[152:155], v[168:171], v[88:91]
    s_mov_b32 s68, s79
    v_mfma_f32_16x16x32_bf16 v[92:95], v[152:155], v[172:175], v[92:95]
    s_mov_b32 s79, s69
    v_mfma_f32_16x16x32_bf16 v[96:99], v[156:159], v[160:163], v[96:99]
    s_mov_b32 s69, s12
    v_mfma_f32_16x16x32_bf16 v[100:103], v[156:159], v[164:167], v[100:103]
    s_mov_b32 s12, s13
    v_mfma_f32_16x16x32_bf16 v[104:107], v[156:159], v[168:171], v[104:107]
    s_mov_b32 s13, s14
    v_mfma_f32_16x16x32_bf16 v[108:111], v[156:159], v[172:175], v[108:111]
    s_mov_b32 s14, s69
    s_waitcnt lgkmcnt(0)
    v_mfma_f32_16x16x32_bf16 v[48:51], v[112:115], v[128:131], v[48:51]
    ds_read_b128 v[144:147], v9 offset:0
    v_mfma_f32_16x16x32_bf16 v[52:55], v[112:115], v[132:135], v[52:55]
    ds_read_b128 v[160:163], v21 offset:0
    v_mfma_f32_16x16x32_bf16 v[56:59], v[112:115], v[136:139], v[56:59]
    v_mfma_f32_16x16x32_bf16 v[60:63], v[112:115], v[140:143], v[60:63]
    ds_read_b128 v[164:167], v21 offset:2048
    v_mfma_f32_16x16x32_bf16 v[64:67], v[116:119], v[128:131], v[64:67]
    ds_read_b128 v[168:171], v21 offset:8192
    v_mfma_f32_16x16x32_bf16 v[68:71], v[116:119], v[132:135], v[68:71]
    v_mfma_f32_16x16x32_bf16 v[72:75], v[116:119], v[136:139], v[72:75]
    ds_read_b128 v[172:175], v21 offset:10240
    v_mfma_f32_16x16x32_bf16 v[76:79], v[116:119], v[140:143], v[76:79]
    v_mfma_f32_16x16x32_bf16 v[80:83], v[120:123], v[128:131], v[80:83]
    ds_read_b128 v[148:151], v9 offset:2048
    v_mfma_f32_16x16x32_bf16 v[84:87], v[120:123], v[132:135], v[84:87]
    ds_read_b128 v[152:155], v9 offset:4096
    v_mfma_f32_16x16x32_bf16 v[88:91], v[120:123], v[136:139], v[88:91]
    v_mfma_f32_16x16x32_bf16 v[92:95], v[120:123], v[140:143], v[92:95]
    ds_read_b128 v[156:159], v9 offset:6144
    v_mfma_f32_16x16x32_bf16 v[96:99], v[124:127], v[128:131], v[96:99]
    v_add_u32 v9, s67, v9
    v_mfma_f32_16x16x32_bf16 v[100:103], v[124:127], v[132:135], v[100:103]
    v_mfma_f32_16x16x32_bf16 v[104:107], v[124:127], v[136:139], v[104:107]
    v_add_u32 v21, s12, v21
    v_mfma_f32_16x16x32_bf16 v[108:111], v[124:127], v[140:143], v[108:111]
    s_waitcnt vmcnt(0) lgkmcnt(0)
    s_barrier
    v_mfma_f32_16x16x32_bf16 v[48:51], v[144:147], v[160:163], v[48:51]
    ds_read_b128 v[112:115], v8 offset:0
    ds_read_b128 v[128:131], v12 offset:0
    v_mfma_f32_16x16x32_bf16 v[52:55], v[144:147], v[164:167], v[52:55]
    ds_read_b128 v[132:135], v12 offset:2048
    v_mfma_f32_16x16x32_bf16 v[56:59], v[144:147], v[168:171], v[56:59]
    ds_read_b128 v[136:139], v12 offset:8192
    v_mfma_f32_16x16x32_bf16 v[60:63], v[144:147], v[172:175], v[60:63]
    ds_read_b128 v[140:143], v12 offset:10240
    v_mfma_f32_16x16x32_bf16 v[64:67], v[148:151], v[160:163], v[64:67]
    ds_read_b128 v[116:119], v8 offset:2048
    v_mfma_f32_16x16x32_bf16 v[68:71], v[148:151], v[164:167], v[68:71]
    ds_read_b128 v[120:123], v8 offset:4096
    v_mfma_f32_16x16x32_bf16 v[72:75], v[148:151], v[168:171], v[72:75]
    ds_read_b128 v[124:127], v8 offset:6144
    v_mfma_f32_16x16x32_bf16 v[76:79], v[148:151], v[172:175], v[76:79]
    v_add_u32 v8, s68, v8
    v_mfma_f32_16x16x32_bf16 v[80:83], v[152:155], v[160:163], v[80:83]
    v_add_u32 v12, s13, v12
    s_mov_b32 s69, s67
    v_mfma_f32_16x16x32_bf16 v[84:87], v[152:155], v[164:167], v[84:87]
    s_mov_b32 s67, s68
    v_mfma_f32_16x16x32_bf16 v[88:91], v[152:155], v[168:171], v[88:91]
    s_mov_b32 s68, s79
    v_mfma_f32_16x16x32_bf16 v[92:95], v[152:155], v[172:175], v[92:95]
    s_mov_b32 s79, s69
    v_mfma_f32_16x16x32_bf16 v[96:99], v[156:159], v[160:163], v[96:99]
    s_mov_b32 s69, s12
    v_mfma_f32_16x16x32_bf16 v[100:103], v[156:159], v[164:167], v[100:103]
    s_mov_b32 s12, s13
    v_mfma_f32_16x16x32_bf16 v[104:107], v[156:159], v[168:171], v[104:107]
    s_mov_b32 s13, s14
    v_mfma_f32_16x16x32_bf16 v[108:111], v[156:159], v[172:175], v[108:111]
    s_mov_b32 s14, s69
    s_waitcnt lgkmcnt(0)
    v_mfma_f32_16x16x32_bf16 v[48:51], v[112:115], v[128:131], v[48:51]
    ds_read_b128 v[144:147], v9 offset:0
    v_mfma_f32_16x16x32_bf16 v[52:55], v[112:115], v[132:135], v[52:55]
    ds_read_b128 v[160:163], v21 offset:0
    v_mfma_f32_16x16x32_bf16 v[56:59], v[112:115], v[136:139], v[56:59]
    v_mfma_f32_16x16x32_bf16 v[60:63], v[112:115], v[140:143], v[60:63]
    ds_read_b128 v[164:167], v21 offset:2048
    v_mfma_f32_16x16x32_bf16 v[64:67], v[116:119], v[128:131], v[64:67]
    ds_read_b128 v[168:171], v21 offset:8192
    v_mfma_f32_16x16x32_bf16 v[68:71], v[116:119], v[132:135], v[68:71]
    v_mfma_f32_16x16x32_bf16 v[72:75], v[116:119], v[136:139], v[72:75]
    ds_read_b128 v[172:175], v21 offset:10240
    v_mfma_f32_16x16x32_bf16 v[76:79], v[116:119], v[140:143], v[76:79]
    v_mfma_f32_16x16x32_bf16 v[80:83], v[120:123], v[128:131], v[80:83]
    ds_read_b128 v[148:151], v9 offset:2048
    v_mfma_f32_16x16x32_bf16 v[84:87], v[120:123], v[132:135], v[84:87]
    ds_read_b128 v[152:155], v9 offset:4096
    v_mfma_f32_16x16x32_bf16 v[88:91], v[120:123], v[136:139], v[88:91]
    v_mfma_f32_16x16x32_bf16 v[92:95], v[120:123], v[140:143], v[92:95]
    ds_read_b128 v[156:159], v9 offset:6144
    v_mfma_f32_16x16x32_bf16 v[96:99], v[124:127], v[128:131], v[96:99]
    v_add_u32 v9, s67, v9
    v_mfma_f32_16x16x32_bf16 v[100:103], v[124:127], v[132:135], v[100:103]
    v_mfma_f32_16x16x32_bf16 v[104:107], v[124:127], v[136:139], v[104:107]
    v_add_u32 v21, s12, v21
    v_mfma_f32_16x16x32_bf16 v[108:111], v[124:127], v[140:143], v[108:111]
    s_waitcnt lgkmcnt(0)
    v_mfma_f32_16x16x32_bf16 v[48:51], v[144:147], v[160:163], v[48:51]
    v_mfma_f32_16x16x32_bf16 v[52:55], v[144:147], v[164:167], v[52:55]
    v_mfma_f32_16x16x32_bf16 v[56:59], v[144:147], v[168:171], v[56:59]
    v_mfma_f32_16x16x32_bf16 v[60:63], v[144:147], v[172:175], v[60:63]
    v_mfma_f32_16x16x32_bf16 v[64:67], v[148:151], v[160:163], v[64:67]
    v_mfma_f32_16x16x32_bf16 v[68:71], v[148:151], v[164:167], v[68:71]
    v_mfma_f32_16x16x32_bf16 v[72:75], v[148:151], v[168:171], v[72:75]
    v_mfma_f32_16x16x32_bf16 v[76:79], v[148:151], v[172:175], v[76:79]
    v_mfma_f32_16x16x32_bf16 v[80:83], v[152:155], v[160:163], v[80:83]
    v_mfma_f32_16x16x32_bf16 v[84:87], v[152:155], v[164:167], v[84:87]
    v_mfma_f32_16x16x32_bf16 v[88:91], v[152:155], v[168:171], v[88:91]
    v_mfma_f32_16x16x32_bf16 v[92:95], v[152:155], v[172:175], v[92:95]
    v_mfma_f32_16x16x32_bf16 v[96:99], v[156:159], v[160:163], v[96:99]
    v_mfma_f32_16x16x32_bf16 v[100:103], v[156:159], v[164:167], v[100:103]
    v_mfma_f32_16x16x32_bf16 v[104:107], v[156:159], v[168:171], v[104:107]
    v_mfma_f32_16x16x32_bf16 v[108:111], v[156:159], v[172:175], v[108:111]
    s_branch k1b_join
k1b_r1:
    s_mov_b32 s67, 0x8000
    s_mov_b32 s68, 0x8000
    s_mov_b32 s79, 0xffff0000
    s_mov_b32 s12, 0x4000
    s_mov_b32 s13, 0x4000
    s_mov_b32 s14, 0xffff8000
    s_waitcnt vmcnt(0)
    v_lshlrev_b32 v38, 16, v38
    v_lshlrev_b32 v39, 16, v39
    v_lshlrev_b32 v40, 16, v40
    v_mul_f32 v40, s8, v40
    v_exp_f32 v40, v40
    s_nop 0
    v_cvt_pk_bf16_f32 v40, v40, v40
    v_lshlrev_b32 v40, 16, v40
    v_mul_f32 v41, v40, v38
    v_mul_f32 v42, v40, v39
    v_mul_f32 v41, s8, v41
    v_exp_f32 v41, v41
    v_mul_f32 v42, 0.15915494, v42
    v_rndne_f32 v43, v42
    v_sub_f32 v42, v42, v43
    v_cos_f32 v24, v42
    v_sin_f32 v25, v42
    v_mul_f32 v24, v24, v41
    v_mul_f32 v25, v25, v41
    v_add_f32 v43, -1.0, v24
    v_mul_f32 v44, v38, v38
    v_fma_f32 v44, v39, v39, v44
    v_rcp_f32 v44, v44
    v_mul_f32 v26, v43, v38
    v_fma_f32 v26, v25, v39, v26
    v_mul_f32 v27, v43, v39
    v_fma_f32 v27, v25, v38, -v27
    v_add_f32 v44, v44, v44
    v_mul_f32 v26, v26, v44
    v_mul_f32 v27, v27, v44
    v_mov_b32 v28, v24
    v_mov_b32 v29, v25
    v_mul_f32 v45, v29, v29
    v_mul_f32 v46, v28, v29
    v_fma_f32 v45, v28, v28, -v45
    v_fma_f32 v29, v29, v28, v46
    v_mov_b32 v28, v45
    v_mul_f32 v45, v29, v29
    v_mul_f32 v46, v28, v29
    v_fma_f32 v45, v28, v28, -v45
    v_fma_f32 v29, v29, v28, v46
    v_mov_b32 v28, v45
    v_mul_f32 v45, v29, v29
    v_mul_f32 v46, v28, v29
    v_fma_f32 v45, v28, v28, -v45
    v_fma_f32 v29, v29, v28, v46
    v_mov_b32 v28, v45
    v_mul_f32 v45, v29, v29
    v_mul_f32 v46, v28, v29
    v_fma_f32 v45, v28, v28, -v45
    v_fma_f32 v29, v29, v28, v46
    v_mov_b32 v28, v45
    v_mul_f32 v45, v29, v29
    v_mul_f32 v46, v28, v29
    v_fma_f32 v45, v28, v28, -v45
    v_fma_f32 v29, v29, v28, v46
    v_mov_b32 v28, v45
    v_mov_b32 v30, v28
    v_mov_b32 v31, v29
    v_mul_f32 v45, v31, v31
    v_mul_f32 v46, v30, v31
    v_fma_f32 v45, v30, v30, -v45
    v_fma_f32 v31, v31, v30, v46
    v_mov_b32 v30, v45
    v_mul_f32 v45, v31, v31
    v_mul_f32 v46, v30, v31
    v_fma_f32 v45, v30, v30, -v45
    v_fma_f32 v31, v31, v30, v46
    v_mov_b32 v30, v45
    v_mul_f32 v45, v31, v31
    v_mul_f32 v46, v30, v31
    v_fma_f32 v45, v30, v30, -v45
    v_fma_f32 v31, v31, v30, v46
    v_mov_b32 v30, v45
    s_lshl_b32 s5, s75, 2
    s_add_u32 s5, s5, 64
    v_mov_b32 v33, s5
    s_lshl_b32 s5, 1, s74
    v_mov_b32 v34, s5
    v_and_b32 v4, 1, v1
    v_mov_b32 v35, 0x05040100
    v_mov_b32 v5, 0x03020706
    v_cmp_eq_u32 vcc, 1, v4
    s_nop 1
    v_cndmask_b32 v35, v35, v5, vcc
    s_lshl_b32 s5, s76, 14
    s_lshl_b32 s6, s77, 6
    s_add_u32 s5, s5, s6
    v_lshl_add_u32 v47, v3, 13, s5
    v_lshl_add_u32 v47, v4, 7, v47
    v_and_b32 v5, 30, v2
    v_lshl_add_u32 v47, v5, 1, v47
    s_lshl_b32 s5, s74, 8
    s_lshl_b32 s6, s64, 5
    s_add_u32 s5, s5, s6
    v_lshrrev_b32 v5, 4, v1
    v_add_u32 v5, s5, v5
    v_lshlrev_b32 v36, 12, v5
    v_bfe_u32 v5, v1, 3, 1
    v_lshl_add_u32 v36, v5, 11, v36
    v_and_b32 v5, 7, v1
    v_lshl_add_u32 v36, v5, 4, v36
    s_lshl_b32 s5, s75, 7
    v_add_u32 v36, s5, v36
    s_lshl_b32 s5, s76, 1
    v_add_u32 v37, s5, v3
    s_barrier
    ds_read_b128 v[112:115], v8 offset:0
    ds_read_b128 v[128:131], v12 offset:0
    ds_read_b128 v[132:135], v12 offset:2048
    ds_read_b128 v[136:139], v12 offset:8192
    ds_read_b128 v[140:143], v12 offset:10240
    ds_read_b128 v[116:119], v8 offset:2048
    ds_read_b128 v[120:123], v8 offset:4096
    ds_read_b128 v[124:127], v8 offset:6144
    v_add_u32 v8, s67, v8
    v_add_u32 v12, s12, v12
    s_waitcnt lgkmcnt(0)
    v_mfma_f32_16x16x32_bf16 v[48:51], v[112:115], v[128:131], 0
    ds_read_b128 v[144:147], v9 offset:0
    v_mfma_f32_16x16x32_bf16 v[52:55], v[112:115], v[132:135], 0
    ds_read_b128 v[160:163], v21 offset:0
    v_mfma_f32_16x16x32_bf16 v[56:59], v[112:115], v[136:139], 0
    v_mfma_f32_16x16x32_bf16 v[60:63], v[112:115], v[140:143], 0
    ds_read_b128 v[164:167], v21 offset:2048
    v_mfma_f32_16x16x32_bf16 v[64:67], v[116:119], v[128:131], 0
    ds_read_b128 v[168:171], v21 offset:8192
    v_mfma_f32_16x16x32_bf16 v[68:71], v[116:119], v[132:135], 0
    v_mfma_f32_16x16x32_bf16 v[72:75], v[116:119], v[136:139], 0
    ds_read_b128 v[172:175], v21 offset:10240
    v_mfma_f32_16x16x32_bf16 v[76:79], v[116:119], v[140:143], 0
    v_mfma_f32_16x16x32_bf16 v[80:83], v[120:123], v[128:131], 0
    ds_read_b128 v[148:151], v9 offset:2048
    v_mfma_f32_16x16x32_bf16 v[84:87], v[120:123], v[132:135], 0
    ds_read_b128 v[152:155], v9 offset:4096
    v_mfma_f32_16x16x32_bf16 v[88:91], v[120:123], v[136:139], 0
    v_mfma_f32_16x16x32_bf16 v[92:95], v[120:123], v[140:143], 0
    ds_read_b128 v[156:159], v9 offset:6144
    v_mfma_f32_16x16x32_bf16 v[96:99], v[124:127], v[128:131], 0
    v_add_u32 v9, s67, v9
    v_mfma_f32_16x16x32_bf16 v[100:103], v[124:127], v[132:135], 0
    v_mfma_f32_16x16x32_bf16 v[104:107], v[124:127], v[136:139], 0
    v_add_u32 v21, s12, v21
    v_mfma_f32_16x16x32_bf16 v[108:111], v[124:127], v[140:143], 0
    s_waitcnt lgkmcnt(0)
    s_barrier
    v_mfma_f32_16x16x32_bf16 v[48:51], v[144:147], v[160:163], v[48:51]
    ds_read_b128 v[112:115], v8 offset:0
    ds_read_b128 v[128:131], v12 offset:0
    v_mfma_f32_16x16x32_bf16 v[52:55], v[144:147], v[164:167], v[52:55]
    ds_read_b128 v[132:135], v12 offset:2048
    v_mfma_f32_16x16x32_bf16 v[56:59], v[144:147], v[168:171], v[56:59]
    ds_read_b128 v[136:139], v12 offset:8192
    v_mfma_f32_16x16x32_bf16 v[60:63], v[144:147], v[172:175], v[60:63]
    ds_read_b128 v[140:143], v12 offset:10240
    v_mfma_f32_16x16x32_bf16 v[64:67], v[148:151], v[160:163], v[64:67]
    ds_read_b128 v[116:119], v8 offset:2048
    v_mfma_f32_16x16x32_bf16 v[68:71], v[148:151], v[164:167], v[68:71]
    ds_read_b128 v[120:123], v8 offset:4096
    v_mfma_f32_16x16x32_bf16 v[72:75], v[148:151], v[168:171], v[72:75]
    ds_read_b128 v[124:127], v8 offset:6144
    v_mfma_f32_16x16x32_bf16 v[76:79], v[148:151], v[172:175], v[76:79]
    v_add_u32 v8, s68, v8
    v_mfma_f32_16x16x32_bf16 v[80:83], v[152:155], v[160:163], v[80:83]
    v_add_u32 v12, s13, v12
    s_mov_b32 s69, s67
    v_mfma_f32_16x16x32_bf16 v[84:87], v[152:155], v[164:167], v[84:87]
    s_mov_b32 s67, s68
    v_mfma_f32_16x16x32_bf16 v[88:91], v[152:155], v[168:171], v[88:91]
    s_mov_b32 s68, s79
    v_mfma_f32_16x16x32_bf16 v[92:95], v[152:155], v[172:175], v[92:95]
    s_mov_b32 s79, s69
    v_mfma_f32_16x16x32_bf16 v[96:99], v[156:159], v[160:163], v[96:99]
    s_mov_b32 s69, s12
    v_mfma_f32_16x16x32_bf16 v[100:103], v[156:159], v[164:167], v[100:103]
    s_mov_b32 s12, s13
    v_mfma_f32_16x16x32_bf16 v[104:107], v[156:159], v[168:171], v[104:107]
    s_mov_b32 s13, s14
    v_mfma_f32_16x16x32_bf16 v[108:111], v[156:159], v[172:175], v[108:111]
    s_mov_b32 s14, s69
    s_mov_b32 s65, 14
k1bn_L0:
    s_waitcnt lgkmcnt(0)
    v_mfma_f32_16x16x32_bf16 v[48:51], v[112:115], v[128:131], v[48:51]
    ds_read_b128 v[144:147], v9 offset:0
    v_mfma_f32_16x16x32_bf16 v[52:55], v[112:115], v[132:135], v[52:55]
    ds_read_b128 v[160:163], v21 offset:0
    v_mfma_f32_16x16x32_bf16 v[56:59], v[112:115], v[136:139], v[56:59]
    v_mfma_f32_16x16x32_bf16 v[60:63], v[112:115], v[140:143], v[60:63]
    ds_read_b128 v[164:167], v21 offset:2048
    v_mfma_f32_16x16x32_bf16 v[64:67], v[116:119], v[128:131], v[64:67]
    ds_read_b128 v[168:171], v21 offset:8192
    v_mfma_f32_16x16x32_bf16 v[68:71], v[116:119], v[132:135], v[68:71]
    v_mfma_f32_16x16x32_bf16 v[72:75], v[116:119], v[136:139], v[72:75]
    ds_read_b128 v[172:175], v21 offset:10240
    v_mfma_f32_16x16x32_bf16 v[76:79], v[116:119], v[140:143], v[76:79]
    v_mfma_f32_16x16x32_bf16 v[80:83], v[120:123], v[128:131], v[80:83]
    ds_read_b128 v[148:151], v9 offset:2048
    v_mfma_f32_16x16x32_bf16 v[84:87], v[120:123], v[132:135], v[84:87]
    ds_read_b128 v[152:155], v9 offset:4096
    v_mfma_f32_16x16x32_bf16 v[88:91], v[120:123], v[136:139], v[88:91]
    v_mfma_f32_16x16x32_bf16 v[92:95], v[120:123], v[140:143], v[92:95]
    ds_read_b128 v[156:159], v9 offset:6144
    v_mfma_f32_16x16x32_bf16 v[96:99], v[124:127], v[128:131], v[96:99]
    v_add_u32 v9, s67, v9
    v_mfma_f32_16x16x32_bf16 v[100:103], v[124:127], v[132:135], v[100:103]
    v_mfma_f32_16x16x32_bf16 v[104:107], v[124:127], v[136:139], v[104:107]
    v_add_u32 v21, s12, v21
    v_mfma_f32_16x16x32_bf16 v[108:111], v[124:127], v[140:143], v[108:111]
    s_waitcnt lgkmcnt(0)
    s_barrier
    v_mfma_f32_16x16x32_bf16 v[48:51], v[144:147], v[160:163], v[48:51]
    ds_read_b128 v[112:115], v8 offset:0
    ds_read_b128 v[128:131], v12 offset:0
    v_mfma_f32_16x16x32_bf16 v[52:55], v[144:147], v[164:167], v[52:55]
    ds_read_b128 v[132:135], v12 offset:2048
    v_mfma_f32_16x16x32_bf16 v[56:59], v[144:147], v[168:171], v[56:59]
    ds_read_b128 v[136:139], v12 offset:8192
    v_mfma_f32_16x16x32_bf16 v[60:63], v[144:147], v[172:175], v[60:63]
    ds_read_b128 v[140:143], v12 offset:10240
    v_mfma_f32_16x16x32_bf16 v[64:67], v[148:151], v[160:163], v[64:67]
    ds_read_b128 v[116:119], v8 offset:2048
    v_mfma_f32_16x16x32_bf16 v[68:71], v[148:151], v[164:167], v[68:71]
    ds_read_b128 v[120:123], v8 offset:4096
    v_mfma_f32_16x16x32_bf16 v[72:75], v[148:151], v[168:171], v[72:75]
    ds_read_b128 v[124:127], v8 offset:6144
    v_mfma_f32_16x16x32_bf16 v[76:79], v[148:151], v[172:175], v[76:79]
    v_add_u32 v8, s68, v8
    v_mfma_f32_16x16x32_bf16 v[80:83], v[152:155], v[160:163], v[80:83]
    v_add_u32 v12, s13, v12
    s_mov_b32 s69, s67
    v_mfma_f32_16x16x32_bf16 v[84:87], v[152:155], v[164:167], v[84:87]
    s_mov_b32 s67, s68
    v_mfma_f32_16x16x32_bf16 v[88:91], v[152:155], v[168:171], v[88:91]
    s_mov_b32 s68, s79
    v_mfma_f32_16x16x32_bf16 v[92:95], v[152:155], v[172:175], v[92:95]
    s_mov_b32 s79, s69
    v_mfma_f32_16x16x32_bf16 v[96:99], v[156:159], v[160:163], v[96:99]
    s_mov_b32 s69, s12
    v_mfma_f32_16x16x32_bf16 v[100:103], v[156:159], v[164:167], v[100:103]
    s_mov_b32 s12, s13
    v_mfma_f32_16x16x32_bf16 v[104:107], v[156:159], v[168:171], v[104:107]
    s_mov_b32 s13, s14
    v_mfma_f32_16x16x32_bf16 v[108:111], v[156:159], v[172:175], v[108:111]
    s_mov_b32 s14, s69
    s_sub_u32 s65, s65, 1
    s_cmp_lg_u32 s65, 0
    s_cbranch_scc1 k1bn_L0
    s_waitcnt lgkmcnt(0)
    v_mfma_f32_16x16x32_bf16 v[48:51], v[112:115], v[128:131], v[48:51]
    ds_read_b128 v[144:147], v9 offset:0
    v_mfma_f32_16x16x32_bf16 v[52:55], v[112:115], v[132:135], v[52:55]
    ds_read_b128 v[160:163], v21 offset:0
    v_mfma_f32_16x16x32_bf16 v[56:59], v[112:115], v[136:139], v[56:59]
    v_mfma_f32_16x16x32_bf16 v[60:63], v[112:115], v[140:143], v[60:63]
    ds_read_b128 v[164:167], v21 offset:2048
    v_mfma_f32_16x16x32_bf16 v[64:67], v[116:119], v[128:131], v[64:67]
    ds_read_b128 v[168:171], v21 offset:8192
    v_mfma_f32_16x16x32_bf16 v[68:71], v[116:119], v[132:135], v[68:71]
    v_mfma_f32_16x16x32_bf16 v[72:75], v[116:119], v[136:139], v[72:75]
    ds_read_b128 v[172:175], v21 offset:10240
    v_mfma_f32_16x16x32_bf16 v[76:79], v[116:119], v[140:143], v[76:79]
    v_mfma_f32_16x16x32_bf16 v[80:83], v[120:123], v[128:131], v[80:83]
    ds_read_b128 v[148:151], v9 offset:2048
    v_mfma_f32_16x16x32_bf16 v[84:87], v[120:123], v[132:135], v[84:87]
    ds_read_b128 v[152:155], v9 offset:4096
    v_mfma_f32_16x16x32_bf16 v[88:91], v[120:123], v[136:139], v[88:91]
    v_mfma_f32_16x16x32_bf16 v[92:95], v[120:123], v[140:143], v[92:95]
    ds_read_b128 v[156:159], v9 offset:6144
    v_mfma_f32_16x16x32_bf16 v[96:99], v[124:127], v[128:131], v[96:99]
    v_add_u32 v9, s67, v9
    v_mfma_f32_16x16x32_bf16 v[100:103], v[124:127], v[132:135], v[100:103]
    v_mfma_f32_16x16x32_bf16 v[104:107], v[124:127], v[136:139], v[104:107]
    v_add_u32 v21, s12, v21
    v_mfma_f32_16x16x32_bf16 v[108:111], v[124:127], v[140:143], v[108:111]
    s_waitcnt lgkmcnt(0)
    v_mfma_f32_16x16x32_bf16 v[48:51], v[144:147], v[160:163], v[48:51]
    v_mfma_f32_16x16x32_bf16 v[52:55], v[144:147], v[164:167], v[52:55]
    v_mfma_f32_16x16x32_bf16 v[56:59], v[144:147], v[168:171], v[56:59]
    v_mfma_f32_16x16x32_bf16 v[60:63], v[144:147], v[172:175], v[60:63]
    v_mfma_f32_16x16x32_bf16 v[64:67], v[148:151], v[160:163], v[64:67]
    v_mfma_f32_16x16x32_bf16 v[68:71], v[148:151], v[164:167], v[68:71]
    v_mfma_f32_16x16x32_bf16 v[72:75], v[148:151], v[168:171], v[72:75]
    v_mfma_f32_16x16x32_bf16 v[76:79], v[148:151], v[172:175], v[76:79]
    v_mfma_f32_16x16x32_bf16 v[80:83], v[152:155], v[160:163], v[80:83]
    v_mfma_f32_16x16x32_bf16 v[84:87], v[152:155], v[164:167], v[84:87]
    v_mfma_f32_16x16x32_bf16 v[88:91], v[152:155], v[168:171], v[88:91]
    v_mfma_f32_16x16x32_bf16 v[92:95], v[152:155], v[172:175], v[92:95]
    v_mfma_f32_16x16x32_bf16 v[96:99], v[156:159], v[160:163], v[96:99]
    v_mfma_f32_16x16x32_bf16 v[100:103], v[156:159], v[164:167], v[100:103]
    v_mfma_f32_16x16x32_bf16 v[104:107], v[156:159], v[168:171], v[104:107]
    v_mfma_f32_16x16x32_bf16 v[108:111], v[156:159], v[172:175], v[108:111]
k1b_join:
    s_lshl_b32 s5, s74, 4
    s_add_u32 s5, s5, s75
    s_lshl_b32 s5, s5, 3
    s_add_u32 s5, s5, s64
    s_mov_b32 s96, s34
    s_and_b32 s97, s35, 0xffff
    s_mov_b32 s98, 0x200000
    s_mov_b32 s99, 0x00020000
    s_mul_i32 s6, s5, 2048
    v_min_u32 v4, 15, v1
    v_lshlrev_b32 v4, 7, v4
    buffer_load_dword v255, v4, s[96:99], s6 offen
    s_mov_b32 s96, s36
    s_and_b32 s97, s37, 0xffff
    s_mov_b32 s98, 0x200000
    s_mov_b32 s99, 0x00020000
    s_mul_i32 s6, s5, 2048
    v_min_u32 v4, 15, v1
    v_lshlrev_b32 v4, 7, v4
    buffer_load_dword v255, v4, s[96:99], s6 offen
    s_mov_b32 s96, s22
    s_and_b32 s97, s23, 0xffff
    s_mov_b32 s98, 0x200000
    s_mov_b32 s99, 0x00020000
    s_mul_i32 s6, s5, 2048
    v_min_u32 v4, 15, v1
    v_lshlrev_b32 v4, 7, v4
    buffer_load_dword v255, v4, s[96:99], s6 offen
pft_skip:
    v_permlane16_swap_b32 v48, v52
    v_permlane16_swap_b32 v49, v53
    v_permlane16_swap_b32 v50, v54
    v_permlane16_swap_b32 v51, v55
    v_permlane16_swap_b32 v56, v60
    v_permlane16_swap_b32 v57, v61
    v_permlane16_swap_b32 v58, v62
    v_permlane16_swap_b32 v59, v63
    v_permlane16_swap_b32 v64, v68
    v_permlane16_swap_b32 v65, v69
    v_permlane16_swap_b32 v66, v70
    v_permlane16_swap_b32 v67, v71
    v_permlane16_swap_b32 v72, v76
    v_permlane16_swap_b32 v73, v77
    v_permlane16_swap_b32 v74, v78
    v_permlane16_swap_b32 v75, v79
    v_permlane16_swap_b32 v80, v84
    v_permlane16_swap_b32 v81, v85
    v_permlane16_swap_b32 v82, v86
    v_permlane16_swap_b32 v83, v87
    v_permlane16_swap_b32 v88, v92
    v_permlane16_swap_b32 v89, v93
    v_permlane16_swap_b32 v90, v94
    v_permlane16_swap_b32 v91, v95
    v_permlane16_swap_b32 v96, v100
    v_permlane16_swap_b32 v97, v101
    v_permlane16_swap_b32 v98, v102
    v_permlane16_swap_b32 v99, v103
    v_permlane16_swap_b32 v104, v108
    v_permlane16_swap_b32 v105, v109
    v_permlane16_swap_b32 v106, v110
    v_permlane16_swap_b32 v107, v111
    v_mov_b32 v208, v26
    v_mov_b32 v209, v27
    v_xor_b32 v210, 0x80000000, v27
    v_mov_b32 v211, v26
    v_mov_b32 v212, v24
    v_mov_b32 v213, v24
    v_xor_b32 v214, 0x80000000, v25
    v_mov_b32 v215, v25
    v_pk_mul_f32 v[114:115], v[48:49], v[208:209] op_sel:[0,0] op_sel_hi:[0,1]
    v_pk_fma_f32 v[144:145], v[56:57], v[210:211], v[114:115] op_sel:[0,0,0] op_sel_hi:[0,1,1]
    v_pk_mul_f32 v[116:117], v[48:49], v[208:209] op_sel:[1,0] op_sel_hi:[1,1]
    v_pk_fma_f32 v[146:147], v[56:57], v[210:211], v[116:117] op_sel:[1,0,0] op_sel_hi:[1,1,1]
    v_mov_b32 v112, v144
    v_mov_b32 v113, v145
    v_pk_fma_f32 v[118:119], v[112:113], v[214:215], v[146:147] op_sel:[1,0,0] op_sel_hi:[0,1,1]
    v_pk_fma_f32 v[112:113], v[112:113], v[212:213], v[118:119]
    v_pk_mul_f32 v[114:115], v[50:51], v[208:209] op_sel:[0,0] op_sel_hi:[0,1]
    v_pk_fma_f32 v[148:149], v[58:59], v[210:211], v[114:115] op_sel:[0,0,0] op_sel_hi:[0,1,1]
    v_pk_fma_f32 v[118:119], v[112:113], v[214:215], v[148:149] op_sel:[1,0,0] op_sel_hi:[0,1,1]
    v_pk_fma_f32 v[112:113], v[112:113], v[212:213], v[118:119]
    v_pk_mul_f32 v[116:117], v[50:51], v[208:209] op_sel:[1,0] op_sel_hi:[1,1]
    v_pk_fma_f32 v[150:151], v[58:59], v[210:211], v[116:117] op_sel:[1,0,0] op_sel_hi:[1,1,1]
    v_pk_fma_f32 v[118:119], v[112:113], v[214:215], v[150:151] op_sel:[1,0,0] op_sel_hi:[0,1,1]
    v_pk_fma_f32 v[112:113], v[112:113], v[212:213], v[118:119]
    v_pk_mul_f32 v[114:115], v[52:53], v[208:209] op_sel:[0,0] op_sel_hi:[0,1]
    v_pk_fma_f32 v[152:153], v[60:61], v[210:211], v[114:115] op_sel:[0,0,0] op_sel_hi:[0,1,1]
    v_pk_fma_f32 v[118:119], v[112:113], v[214:215], v[152:153] op_sel:[1,0,0] op_sel_hi:[0,1,1]
    v_pk_fma_f32 v[112:113], v[112:113], v[212:213], v[118:119]
    v_pk_mul_f32 v[116:117], v[52:53], v[208:209] op_sel:[1,0] op_sel_hi:[1,1]
    v_pk_fma_f32 v[154:155], v[60:61], v[210:211], v[116:117] op_sel:[1,0,0] op_sel_hi:[1,1,1]
    v_pk_fma_f32 v[118:119], v[112:113], v[214:215], v[154:155] op_sel:[1,0,0] op_sel_hi:[0,1,1]
    v_pk_fma_f32 v[112:113], v[112:113], v[212:213], v[118:119]
    v_pk_mul_f32 v[114:115], v[54:55], v[208:209] op_sel:[0,0] op_sel_hi:[0,1]
    v_pk_fma_f32 v[156:157], v[62:63], v[210:211], v[114:115] op_sel:[0,0,0] op_sel_hi:[0,1,1]
    v_pk_fma_f32 v[118:119], v[112:113], v[214:215], v[156:157] op_sel:[1,0,0] op_sel_hi:[0,1,1]
    v_pk_fma_f32 v[112:113], v[112:113], v[212:213], v[118:119]
    v_pk_mul_f32 v[116:117], v[54:55], v[208:209] op_sel:[1,0] op_sel_hi:[1,1]
    v_pk_fma_f32 v[158:159], v[62:63], v[210:211], v[116:117] op_sel:[1,0,0] op_sel_hi:[1,1,1]
    v_pk_fma_f32 v[118:119], v[112:113], v[214:215], v[158:159] op_sel:[1,0,0] op_sel_hi:[0,1,1]
    v_pk_fma_f32 v[112:113], v[112:113], v[212:213], v[118:119]
    v_pk_mul_f32 v[114:115], v[64:65], v[208:209] op_sel:[0,0] op_sel_hi:[0,1]
    v_pk_fma_f32 v[160:161], v[72:73], v[210:211], v[114:115] op_sel:[0,0,0] op_sel_hi:[0,1,1]
    v_pk_fma_f32 v[118:119], v[112:113], v[214:215], v[160:161] op_sel:[1,0,0] op_sel_hi:[0,1,1]
    v_pk_fma_f32 v[112:113], v[112:113], v[212:213], v[118:119]
    v_pk_mul_f32 v[116:117], v[64:65], v[208:209] op_sel:[1,0] op_sel_hi:[1,1]
    v_pk_fma_f32 v[162:163], v[72:73], v[210:211], v[116:117] op_sel:[1,0,0] op_sel_hi:[1,1,1]
    v_pk_fma_f32 v[118:119], v[112:113], v[214:215], v[162:163] op_sel:[1,0,0] op_sel_hi:[0,1,1]
    v_pk_fma_f32 v[112:113], v[112:113], v[212:213], v[118:119]
    v_pk_mul_f32 v[114:115], v[66:67], v[208:209] op_sel:[0,0] op_sel_hi:[0,1]
    v_pk_fma_f32 v[164:165], v[74:75], v[210:211], v[114:115] op_sel:[0,0,0] op_sel_hi:[0,1,1]
    v_pk_fma_f32 v[118:119], v[112:113], v[214:215], v[164:165] op_sel:[1,0,0] op_sel_hi:[0,1,1]
    v_pk_fma_f32 v[112:113], v[112:113], v[212:213], v[118:119]
    v_pk_mul_f32 v[116:117], v[66:67], v[208:209] op_sel:[1,0] op_sel_hi:[1,1]
    v_pk_fma_f32 v[166:167], v[74:75], v[210:211], v[116:117] op_sel:[1,0,0] op_sel_hi:[1,1,1]
    v_pk_fma_f32 v[118:119], v[112:113], v[214:215], v[166:167] op_sel:[1,0,0] op_sel_hi:[0,1,1]
    v_pk_fma_f32 v[112:113], v[112:113], v[212:213], v[118:119]
    v_pk_mul_f32 v[114:115], v[68:69], v[208:209] op_sel:[0,0] op_sel_hi:[0,1]
    v_pk_fma_f32 v[168:169], v[76:77], v[210:211], v[114:115] op_sel:[0,0,0] op_sel_hi:[0,1,1]
    v_pk_fma_f32 v[118:119], v[112:113], v[214:215], v[168:169] op_sel:[1,0,0] op_sel_hi:[0,1,1]
    v_pk_fma_f32 v[112:113], v[112:113], v[212:213], v[118:119]
    v_pk_mul_f32 v[116:117], v[68:69], v[208:209] op_sel:[1,0] op_sel_hi:[1,1]
    v_pk_fma_f32 v[170:171], v[76:77], v[210:211], v[116:117] op_sel:[1,0,0] op_sel_hi:[1,1,1]
    v_pk_fma_f32 v[118:119], v[112:113], v[214:215], v[170:171] op_sel:[1,0,0] op_sel_hi:[0,1,1]
    v_pk_fma_f32 v[112:113], v[112:113], v[212:213], v[118:119]
    v_pk_mul_f32 v[114:115], v[70:71], v[208:209] op_sel:[0,0] op_sel_hi:[0,1]
    v_pk_fma_f32 v[172:173], v[78:79], v[210:211], v[114:115] op_sel:[0,0,0] op_sel_hi:[0,1,1]
    v_pk_fma_f32 v[118:119], v[112:113], v[214:215], v[172:173] op_sel:[1,0,0] op_sel_hi:[0,1,1]
    v_pk_fma_f32 v[112:113], v[112:113], v[212:213], v[118:119]
    v_pk_mul_f32 v[116:117], v[70:71], v[208:209] op_sel:[1,0] op_sel_hi:[1,1]
    v_pk_fma_f32 v[174:175], v[78:79], v[210:211], v[116:117] op_sel:[1,0,0] op_sel_hi:[1,1,1]
    v_pk_fma_f32 v[118:119], v[112:113], v[214:215], v[174:175] op_sel:[1,0,0] op_sel_hi:[0,1,1]
    v_pk_fma_f32 v[112:113], v[112:113], v[212:213], v[118:119]
    v_pk_mul_f32 v[114:115], v[80:81], v[208:209] op_sel:[0,0] op_sel_hi:[0,1]
    v_pk_fma_f32 v[176:177], v[88:89], v[210:211], v[114:115] op_sel:[0,0,0] op_sel_hi:[0,1,1]
    v_pk_fma_f32 v[118:119], v[112:113], v[214:215], v[176:177] op_sel:[1,0,0] op_sel_hi:[0,1,1]
    v_pk_fma_f32 v[112:113], v[112:113], v[212:213], v[118:119]
    v_pk_mul_f32 v[116:117], v[80:81], v[208:209] op_sel:[1,0] op_sel_hi:[1,1]
    v_pk_fma_f32 v[178:179], v[88:89], v[210:211], v[116:117] op_sel:[1,0,0] op_sel_hi:[1,1,1]
    v_pk_fma_f32 v[118:119], v[112:113], v[214:215], v[178:179] op_sel:[1,0,0] op_sel_hi:[0,1,1]
    v_pk_fma_f32 v[112:113], v[112:113], v[212:213], v[118:119]
    v_pk_mul_f32 v[114:115], v[82:83], v[208:209] op_sel:[0,0] op_sel_hi:[0,1]
    v_pk_fma_f32 v[180:181], v[90:91], v[210:211], v[114:115] op_sel:[0,0,0] op_sel_hi:[0,1,1]
    v_pk_fma_f32 v[118:119], v[112:113], v[214:215], v[180:181] op_sel:[1,0,0] op_sel_hi:[0,1,1]
    v_pk_fma_f32 v[112:113], v[112:113], v[212:213], v[118:119]
    v_pk_mul_f32 v[116:117], v[82:83], v[208:209] op_sel:[1,0] op_sel_hi:[1,1]
    v_pk_fma_f32 v[182:183], v[90:91], v[210:211], v[116:117] op_sel:[1,0,0] op_sel_hi:[1,1,1]
    v_pk_fma_f32 v[118:119], v[112:113], v[214:215], v[182:183] op_sel:[1,0,0] op_sel_hi:[0,1,1]
    v_pk_fma_f32 v[112:113], v[112:113], v[212:213], v[118:119]
    v_pk_mul_f32 v[114:115], v[84:85], v[208:209] op_sel:[0,0] op_sel_hi:[0,1]
    v_pk_fma_f32 v[184:185], v[92:93], v[210:211], v[114:115] op_sel:[0,0,0] op_sel_hi:[0,1,1]
    v_pk_fma_f32 v[118:119], v[112:113], v[214:215], v[184:185] op_sel:[1,0,0] op_sel_hi:[0,1,1]
    v_pk_fma_f32 v[112:113], v[112:113], v[212:213], v[118:119]
    v_pk_mul_f32 v[116:117], v[84:85], v[208:209] op_sel:[1,0] op_sel_hi:[1,1]
    v_pk_fma_f32 v[186:187], v[92:93], v[210:211], v[116:117] op_sel:[1,0,0] op_sel_hi:[1,1,1]
    v_pk_fma_f32 v[118:119], v[112:113], v[214:215], v[186:187] op_sel:[1,0,0] op_sel_hi:[0,1,1]
    v_pk_fma_f32 v[112:113], v[112:113], v[212:213], v[118:119]
    v_pk_mul_f32 v[114:115], v[86:87], v[208:209] op_sel:[0,0] op_sel_hi:[0,1]
    v_pk_fma_f32 v[188:189], v[94:95], v[210:211], v[114:115] op_sel:[0,0,0] op_sel_hi:[0,1,1]
    v_pk_fma_f32 v[118:119], v[112:113], v[214:215], v[188:189] op_sel:[1,0,0] op_sel_hi:[0,1,1]
    v_pk_fma_f32 v[112:113], v[112:113], v[212:213], v[118:119]
    v_pk_mul_f32 v[116:117], v[86:87], v[208:209] op_sel:[1,0] op_sel_hi:[1,1]
    v_pk_fma_f32 v[190:191], v[94:95], v[210:211], v[116:117] op_sel:[1,0,0] op_sel_hi:[1,1,1]
    v_pk_fma_f32 v[118:119], v[112:113], v[214:215], v[190:191] op_sel:[1,0,0] op_sel_hi:[0,1,1]
    v_pk_fma_f32 v[112:113], v[112:113], v[212:213], v[118:119]
    v_pk_mul_f32 v[114:115], v[96:97], v[208:209] op_sel:[0,0] op_sel_hi:[0,1]
    v_pk_fma_f32 v[192:193], v[104:105], v[210:211], v[114:115] op_sel:[0,0,0] op_sel_hi:[0,1,1]
    v_pk_fma_f32 v[118:119], v[112:113], v[214:215], v[192:193] op_sel:[1,0,0] op_sel_hi:[0,1,1]
    v_pk_fma_f32 v[112:113], v[112:113], v[212:213], v[118:119]
    v_pk_mul_f32 v[116:117], v[96:97], v[208:209] op_sel:[1,0] op_sel_hi:[1,1]
    v_pk_fma_f32 v[194:195], v[104:105], v[210:211], v[116:117] op_sel:[1,0,0] op_sel_hi:[1,1,1]
    v_pk_fma_f32 v[118:119], v[112:113], v[214:215], v[194:195] op_sel:[1,0,0] op_sel_hi:[0,1,1]
    v_pk_fma_f32 v[112:113], v[112:113], v[212:213], v[118:119]
    v_pk_mul_f32 v[114:115], v[98:99], v[208:209] op_sel:[0,0] op_sel_hi:[0,1]
    v_pk_fma_f32 v[196:197], v[106:107], v[210:211], v[114:115] op_sel:[0,0,0] op_sel_hi:[0,1,1]
    v_pk_fma_f32 v[118:119], v[112:113], v[214:215], v[196:197] op_sel:[1,0,0] op_sel_hi:[0,1,1]
    v_pk_fma_f32 v[112:113], v[112:113], v[212:213], v[118:119]
    v_pk_mul_f32 v[116:117], v[98:99], v[208:209] op_sel:[1,0] op_sel_hi:[1,1]
    v_pk_fma_f32 v[198:199], v[106:107], v[210:211], v[116:117] op_sel:[1,0,0] op_sel_hi:[1,1,1]
    v_pk_fma_f32 v[118:119], v[112:113], v[214:215], v[198:199] op_sel:[1,0,0] op_sel_hi:[0,1,1]
    v_pk_fma_f32 v[112:113], v[112:113], v[212:213], v[118:119]
    v_pk_mul_f32 v[114:115], v[100:101], v[208:209] op_sel:[0,0] op_sel_hi:[0,1]
    v_pk_fma_f32 v[200:201], v[108:109], v[210:211], v[114:115] op_sel:[0,0,0] op_sel_hi:[0,1,1]
    v_pk_fma_f32 v[118:119], v[112:113], v[214:215], v[200:201] op_sel:[1,0,0] op_sel_hi:[0,1,1]
    v_pk_fma_f32 v[112:113], v[112:113], v[212:213], v[118:119]
    v_pk_mul_f32 v[116:117], v[100:101], v[208:209] op_sel:[1,0] op_sel_hi:[1,1]
    v_pk_fma_f32 v[202:203], v[108:109], v[210:211], v[116:117] op_sel:[1,0,0] op_sel_hi:[1,1,1]
    v_pk_fma_f32 v[118:119], v[112:113], v[214:215], v[202:203] op_sel:[1,0,0] op_sel_hi:[0,1,1]
    v_pk_fma_f32 v[112:113], v[112:113], v[212:213], v[118:119]
    v_pk_mul_f32 v[114:115], v[102:103], v[208:209] op_sel:[0,0] op_sel_hi:[0,1]
    v_pk_fma_f32 v[204:205], v[110:111], v[210:211], v[114:115] op_sel:[0,0,0] op_sel_hi:[0,1,1]
    v_pk_fma_f32 v[118:119], v[112:113], v[214:215], v[204:205] op_sel:[1,0,0] op_sel_hi:[0,1,1]
    v_pk_fma_f32 v[112:113], v[112:113], v[212:213], v[118:119]
    v_pk_mul_f32 v[116:117], v[102:103], v[208:209] op_sel:[1,0] op_sel_hi:[1,1]
    v_pk_fma_f32 v[206:207], v[110:111], v[210:211], v[116:117] op_sel:[1,0,0] op_sel_hi:[1,1,1]
    v_pk_fma_f32 v[118:119], v[112:113], v[214:215], v[206:207] op_sel:[1,0,0] op_sel_hi:[0,1,1]
    v_pk_fma_f32 v[112:113], v[112:113], v[212:213], v[118:119]
    s_barrier
    s_lshl_b32 s5, s77, 8
    v_lshl_add_u32 v4, v2, 3, s5
    v_lshl_add_u32 v5, v37, 9, v4
    ds_write_b64 v5, v[112:113]
    s_waitcnt lgkmcnt(0)
    s_barrier
    ds_read_b64 v[120:121], v4 offset:0
    ds_read_b64 v[122:123], v4 offset:512
    ds_read_b64 v[124:125], v4 offset:1024
    ds_read_b64 v[126:127], v4 offset:1536
    ds_read_b64 v[128:129], v4 offset:2048
    ds_read_b64 v[130:131], v4 offset:2560
    ds_read_b64 v[132:133], v4 offset:3072
    ds_read_b64 v[134:135], v4 offset:3584
    v_mov_b32 v136, 0
    v_mov_b32 v137, 0
    v_mov_b32 v138, 1.0
    v_mov_b32 v139, 0
    v_mov_b32 v140, 0
    v_mov_b32 v141, 0
    v_mov_b32 v142, 1.0
    v_mov_b32 v143, 0
    s_waitcnt lgkmcnt(0)
    v_fma_f32 v114, -v29, v137, v120
    v_fma_f32 v115, v29, v136, v121
    v_fma_f32 v136, v28, v136, v114
    v_fma_f32 v137, v28, v137, v115
    v_mul_f32 v116, v139, v29
    v_mul_f32 v117, v138, v29
    v_fma_f32 v116, v138, v28, -v116
    v_fma_f32 v139, v139, v28, v117
    v_mov_b32 v138, v116
    v_cmp_eq_u32 vcc, 1, v37
    s_nop 1
    v_cndmask_b32 v140, v140, v136, vcc
    v_cndmask_b32 v141, v141, v137, vcc
    v_cndmask_b32 v142, v142, v138, vcc
    v_cndmask_b32 v143, v143, v139, vcc
    v_fma_f32 v114, -v29, v137, v122
    v_fma_f32 v115, v29, v136, v123
    v_fma_f32 v136, v28, v136, v114
    v_fma_f32 v137, v28, v137, v115
    v_mul_f32 v116, v139, v29
    v_mul_f32 v117, v138, v29
    v_fma_f32 v116, v138, v28, -v116
    v_fma_f32 v139, v139, v28, v117
    v_mov_b32 v138, v116
    v_cmp_eq_u32 vcc, 2, v37
    s_nop 1
    v_cndmask_b32 v140, v140, v136, vcc
    v_cndmask_b32 v141, v141, v137, vcc
    v_cndmask_b32 v142, v142, v138, vcc
    v_cndmask_b32 v143, v143, v139, vcc
    v_fma_f32 v114, -v29, v137, v124
    v_fma_f32 v115, v29, v136, v125
    v_fma_f32 v136, v28, v136, v114
    v_fma_f32 v137, v28, v137, v115
    v_mul_f32 v116, v139, v29
    v_mul_f32 v117, v138, v29
    v_fma_f32 v116, v138, v28, -v116
    v_fma_f32 v139, v139, v28, v117
    v_mov_b32 v138, v116
    v_cmp_eq_u32 vcc, 3, v37
    s_nop 1
    v_cndmask_b32 v140, v140, v136, vcc
    v_cndmask_b32 v141, v141, v137, vcc
    v_cndmask_b32 v142, v142, v138, vcc
    v_cndmask_b32 v143, v143, v139, vcc
    v_fma_f32 v114, -v29, v137, v126
    v_fma_f32 v115, v29, v136, v127
    v_fma_f32 v136, v28, v136, v114
    v_fma_f32 v137, v28, v137, v115
    v_mul_f32 v116, v139, v29
    v_mul_f32 v117, v138, v29
    v_fma_f32 v116, v138, v28, -v116
    v_fma_f32 v139, v139, v28, v117
    v_mov_b32 v138, v116
    v_cmp_eq_u32 vcc, 4, v37
    s_nop 1
    v_cndmask_b32 v140, v140, v136, vcc
    v_cndmask_b32 v141, v141, v137, vcc
    v_cndmask_b32 v142, v142, v138, vcc
    v_cndmask_b32 v143, v143, v139, vcc
    v_fma_f32 v114, -v29, v137, v128
    v_fma_f32 v115, v29, v136, v129
    v_fma_f32 v136, v28, v136, v114
    v_fma_f32 v137, v28, v137, v115
    v_mul_f32 v116, v139, v29
    v_mul_f32 v117, v138, v29
    v_fma_f32 v116, v138, v28, -v116
    v_fma_f32 v139, v139, v28, v117
    v_mov_b32 v138, v116
    v_cmp_eq_u32 vcc, 5, v37
    s_nop 1
    v_cndmask_b32 v140, v140, v136, vcc
    v_cndmask_b32 v141, v141, v137, vcc
    v_cndmask_b32 v142, v142, v138, vcc
    v_cndmask_b32 v143, v143, v139, vcc
    v_fma_f32 v114, -v29, v137, v130
    v_fma_f32 v115, v29, v136, v131
    v_fma_f32 v136, v28, v136, v114
    v_fma_f32 v137, v28, v137, v115
    v_mul_f32 v116, v139, v29
    v_mul_f32 v117, v138, v29
    v_fma_f32 v116, v138, v28, -v116
    v_fma_f32 v139, v139, v28, v117
    v_mov_b32 v138, v116
    v_cmp_eq_u32 vcc, 6, v37
    s_nop 1
    v_cndmask_b32 v140, v140, v136, vcc
    v_cndmask_b32 v141, v141, v137, vcc
    v_cndmask_b32 v142, v142, v138, vcc
    v_cndmask_b32 v143, v143, v139, vcc
    v_fma_f32 v114, -v29, v137, v132
    v_fma_f32 v115, v29, v136, v133
    v_fma_f32 v136, v28, v136, v114
    v_fma_f32 v137, v28, v137, v115
    v_mul_f32 v116, v139, v29
    v_mul_f32 v117, v138, v29
    v_fma_f32 v116, v138, v28, -v116
    v_fma_f32 v139, v139, v28, v117
    v_mov_b32 v138, v116
    v_cmp_eq_u32 vcc, 7, v37
    s_nop 1
    v_cndmask_b32 v140, v140, v136, vcc
    v_cndmask_b32 v141, v141, v137, vcc
    v_cndmask_b32 v142, v142, v138, vcc
    v_cndmask_b32 v143, v143, v139, vcc
    v_fma_f32 v114, -v29, v137, v134
    v_fma_f32 v115, v29, v136, v135
    v_fma_f32 v136, v28, v136, v114
    v_fma_f32 v137, v28, v137, v115
    s_add_u32 s60, s46, 0x1000000
    s_addc_u32 s61, s47, 0
    s_and_b32 s61, s61, 0xffff
    s_mov_b32 s62, 0x10000
    s_mov_b32 s63, 0x00020000
    v_lshlrev_b32 v6, 3, v32
    s_lshl_b32 s5, s74, 13
    s_cmp_lg_u32 s76, 0
    s_cbranch_scc1 k1b_nopub
    buffer_store_dwordx2 v[136:137], v6, s[60:63], s5 offen sc1
    s_waitcnt vmcnt(0)
k1b_nopub:
    s_barrier
    s_cmp_lg_u32 s64, 0
    s_cbranch_scc1 k1b_nosig
    s_mov_b64 exec, 1
    global_atomic_or v33, v34, s[44:45] sc1
    s_mov_b64 exec, -1
k1b_nosig:
    s_lshl_b32 s7, 1, s74
    s_sub_u32 s7, s7, 1
    s_cmp_lg_u32 s64, 0
    s_cbranch_scc1 k1b_poll_done
    s_mov_b32 s5, 0
k1b_poll_loop:
    global_load_dword v4, v33, s[44:45] sc1
    s_waitcnt vmcnt(0)
    v_readfirstlane_b32 s6, v4
    s_nop 3
    s_and_b32 s6, s6, s7
    s_cmp_eq_u32 s6, s7
    s_cbranch_scc1 k1b_poll_ok
    s_sleep 1
    s_add_u32 s5, s5, 1
    s_cmp_lt_u32 s5, 2097152
    s_cbranch_scc1 k1b_poll_loop
k1b_poll_ok:
k1b_poll_done:
    s_barrier
    buffer_load_dwordx2 v[120:121], v6, s[60:63], 0 offen sc1
    s_mov_b32 s6, 0x2000
    buffer_load_dwordx2 v[122:123], v6, s[60:63], s6 offen sc1
    s_mov_b32 s6, 0x4000
    buffer_load_dwordx2 v[124:125], v6, s[60:63], s6 offen sc1
    s_mov_b32 s6, 0x6000
    buffer_load_dwordx2 v[126:127], v6, s[60:63], s6 offen sc1
    s_mov_b32 s6, 0x8000
    buffer_load_dwordx2 v[128:129], v6, s[60:63], s6 offen sc1
    s_mov_b32 s6, 0xa000
    buffer_load_dwordx2 v[130:131], v6, s[60:63], s6 offen sc1
    s_mov_b32 s6, 0xc000
    buffer_load_dwordx2 v[132:133], v6, s[60:63], s6 offen sc1
    s_mov_b32 s6, 0xe000
    v_mov_b32 v112, 0
    v_mov_b32 v113, 0
    s_waitcnt vmcnt(0)
    s_cmp_le_u32 s74, 0
    s_cbranch_scc1 k1b_hdone
    v_fma_f32 v114, -v31, v113, v120
    v_fma_f32 v115, v31, v112, v121
    v_fma_f32 v112, v30, v112, v114
    v_fma_f32 v113, v30, v113, v115
    s_cmp_le_u32 s74, 1
    s_cbranch_scc1 k1b_hdone
    v_fma_f32 v114, -v31, v113, v122
    v_fma_f32 v115, v31, v112, v123
    v_fma_f32 v112, v30, v112, v114
    v_fma_f32 v113, v30, v113, v115
    s_cmp_le_u32 s74, 2
    s_cbranch_scc1 k1b_hdone
    v_fma_f32 v114, -v31, v113, v124
    v_fma_f32 v115, v31, v112, v125
    v_fma_f32 v112, v30, v112, v114
    v_fma_f32 v113, v30, v113, v115
    s_cmp_le_u32 s74, 3
    s_cbranch_scc1 k1b_hdone
    v_fma_f32 v114, -v31, v113, v126
    v_fma_f32 v115, v31, v112, v127
    v_fma_f32 v112, v30, v112, v114
    v_fma_f32 v113, v30, v113, v115
    s_cmp_le_u32 s74, 4
    s_cbranch_scc1 k1b_hdone
    v_fma_f32 v114, -v31, v113, v128
    v_fma_f32 v115, v31, v112, v129
    v_fma_f32 v112, v30, v112, v114
    v_fma_f32 v113, v30, v113, v115
    s_cmp_le_u32 s74, 5
    s_cbranch_scc1 k1b_hdone
    v_fma_f32 v114, -v31, v113, v130
    v_fma_f32 v115, v31, v112, v131
    v_fma_f32 v112, v30, v112, v114
    v_fma_f32 v113, v30, v113, v115
    s_cmp_le_u32 s74, 6
    s_cbranch_scc1 k1b_hdone
    v_fma_f32 v114, -v31, v113, v132
    v_fma_f32 v115, v31, v112, v133
    v_fma_f32 v112, v30, v112, v114
    v_fma_f32 v113, v30, v113, v115
k1b_hdone:
    v_fma_f32 v114, -v143, v113, v140
    v_fma_f32 v115, v143, v112, v141
    v_fma_f32 v112, v142, v112, v114
    v_fma_f32 v113, v142, v113, v115
    s_add_u32 s60, s46, 0x400000
    s_addc_u32 s61, s47, 0
    s_and_b32 s61, s61, 0xffff
    s_mov_b32 s62, 0x800000
    s_mov_b32 s63, 0x00020000
    v_pk_fma_f32 v[114:115], v[112:113], v[214:215], v[144:145] op_sel:[1,0,0] op_sel_hi:[0,1,1]
    v_pk_fma_f32 v[112:113], v[112:113], v[212:213], v[114:115]
    v_cvt_pk_bf16_f32 v120, v112, -v113
    s_nop 1
    v_mov_b32_dpp v121, v120 quad_perm:[1,0,3,2] row_mask:0xf bank_mask:0xf
    v_perm_b32 v122, v121, v120, v35
    ds_write_b32 v47, v122 offset:0
    v_pk_fma_f32 v[114:115], v[112:113], v[214:215], v[146:147] op_sel:[1,0,0] op_sel_hi:[0,1,1]
    v_pk_fma_f32 v[112:113], v[112:113], v[212:213], v[114:115]
    v_cvt_pk_bf16_f32 v123, v112, -v113
    s_nop 1
    v_mov_b32_dpp v124, v123 quad_perm:[1,0,3,2] row_mask:0xf bank_mask:0xf
    v_perm_b32 v125, v124, v123, v35
    ds_write_b32 v47, v125 offset:256
    v_pk_fma_f32 v[114:115], v[112:113], v[214:215], v[148:149] op_sel:[1,0,0] op_sel_hi:[0,1,1]
    v_pk_fma_f32 v[112:113], v[112:113], v[212:213], v[114:115]
    v_cvt_pk_bf16_f32 v126, v112, -v113
    s_nop 1
    v_mov_b32_dpp v127, v126 quad_perm:[1,0,3,2] row_mask:0xf bank_mask:0xf
    v_perm_b32 v128, v127, v126, v35
    ds_write_b32 v47, v128 offset:512
    v_pk_fma_f32 v[114:115], v[112:113], v[214:215], v[150:151] op_sel:[1,0,0] op_sel_hi:[0,1,1]
    v_pk_fma_f32 v[112:113], v[112:113], v[212:213], v[114:115]
    v_cvt_pk_bf16_f32 v129, v112, -v113
    s_nop 1
    v_mov_b32_dpp v130, v129 quad_perm:[1,0,3,2] row_mask:0xf bank_mask:0xf
    v_perm_b32 v131, v130, v129, v35
    ds_write_b32 v47, v131 offset:768
    v_pk_fma_f32 v[114:115], v[112:113], v[214:215], v[152:153] op_sel:[1,0,0] op_sel_hi:[0,1,1]
    v_pk_fma_f32 v[112:113], v[112:113], v[212:213], v[114:115]
    v_cvt_pk_bf16_f32 v120, v112, -v113
    s_nop 1
    v_mov_b32_dpp v121, v120 quad_perm:[1,0,3,2] row_mask:0xf bank_mask:0xf
    v_perm_b32 v122, v121, v120, v35
    ds_write_b32 v47, v122 offset:1024
    v_pk_fma_f32 v[114:115], v[112:113], v[214:215], v[154:155] op_sel:[1,0,0] op_sel_hi:[0,1,1]
    v_pk_fma_f32 v[112:113], v[112:113], v[212:213], v[114:115]
    v_cvt_pk_bf16_f32 v123, v112, -v113
    s_nop 1
    v_mov_b32_dpp v124, v123 quad_perm:[1,0,3,2] row_mask:0xf bank_mask:0xf
    v_perm_b32 v125, v124, v123, v35
    ds_write_b32 v47, v125 offset:1280
    v_pk_fma_f32 v[114:115], v[112:113], v[214:215], v[156:157] op_sel:[1,0,0] op_sel_hi:[0,1,1]
    v_pk_fma_f32 v[112:113], v[112:113], v[212:213], v[114:115]
    v_cvt_pk_bf16_f32 v126, v112, -v113
    s_nop 1
    v_mov_b32_dpp v127, v126 quad_perm:[1,0,3,2] row_mask:0xf bank_mask:0xf
    v_perm_b32 v128, v127, v126, v35
    ds_write_b32 v47, v128 offset:1536
    v_pk_fma_f32 v[114:115], v[112:113], v[214:215], v[158:159] op_sel:[1,0,0] op_sel_hi:[0,1,1]
    v_pk_fma_f32 v[112:113], v[112:113], v[212:213], v[114:115]
    v_cvt_pk_bf16_f32 v129, v112, -v113
    s_nop 1
    v_mov_b32_dpp v130, v129 quad_perm:[1,0,3,2] row_mask:0xf bank_mask:0xf
    v_perm_b32 v131, v130, v129, v35
    ds_write_b32 v47, v131 offset:1792
    v_pk_fma_f32 v[114:115], v[112:113], v[214:215], v[160:161] op_sel:[1,0,0] op_sel_hi:[0,1,1]
    v_pk_fma_f32 v[112:113], v[112:113], v[212:213], v[114:115]
    v_cvt_pk_bf16_f32 v120, v112, -v113
    s_nop 1
    v_mov_b32_dpp v121, v120 quad_perm:[1,0,3,2] row_mask:0xf bank_mask:0xf
    v_perm_b32 v122, v121, v120, v35
    ds_write_b32 v47, v122 offset:2048
    v_pk_fma_f32 v[114:115], v[112:113], v[214:215], v[162:163] op_sel:[1,0,0] op_sel_hi:[0,1,1]
    v_pk_fma_f32 v[112:113], v[112:113], v[212:213], v[114:115]
    v_cvt_pk_bf16_f32 v123, v112, -v113
    s_nop 1
    v_mov_b32_dpp v124, v123 quad_perm:[1,0,3,2] row_mask:0xf bank_mask:0xf
    v_perm_b32 v125, v124, v123, v35
    ds_write_b32 v47, v125 offset:2304
    v_pk_fma_f32 v[114:115], v[112:113], v[214:215], v[164:165] op_sel:[1,0,0] op_sel_hi:[0,1,1]
    v_pk_fma_f32 v[112:113], v[112:113], v[212:213], v[114:115]
    v_cvt_pk_bf16_f32 v126, v112, -v113
    s_nop 1
    v_mov_b32_dpp v127, v126 quad_perm:[1,0,3,2] row_mask:0xf bank_mask:0xf
    v_perm_b32 v128, v127, v126, v35
    ds_write_b32 v47, v128 offset:2560
    v_pk_fma_f32 v[114:115], v[112:113], v[214:215], v[166:167] op_sel:[1,0,0] op_sel_hi:[0,1,1]
    v_pk_fma_f32 v[112:113], v[112:113], v[212:213], v[114:115]
    v_cvt_pk_bf16_f32 v129, v112, -v113
    s_nop 1
    v_mov_b32_dpp v130, v129 quad_perm:[1,0,3,2] row_mask:0xf bank_mask:0xf
    v_perm_b32 v131, v130, v129, v35
    ds_write_b32 v47, v131 offset:2816
    v_pk_fma_f32 v[114:115], v[112:113], v[214:215], v[168:169] op_sel:[1,0,0] op_sel_hi:[0,1,1]
    v_pk_fma_f32 v[112:113], v[112:113], v[212:213], v[114:115]
    v_cvt_pk_bf16_f32 v120, v112, -v113
    s_nop 1
    v_mov_b32_dpp v121, v120 quad_perm:[1,0,3,2] row_mask:0xf bank_mask:0xf
    v_perm_b32 v122, v121, v120, v35
    ds_write_b32 v47, v122 offset:3072
    v_pk_fma_f32 v[114:115], v[112:113], v[214:215], v[170:171] op_sel:[1,0,0] op_sel_hi:[0,1,1]
    v_pk_fma_f32 v[112:113], v[112:113], v[212:213], v[114:115]
    v_cvt_pk_bf16_f32 v123, v112, -v113
    s_nop 1
    v_mov_b32_dpp v124, v123 quad_perm:[1,0,3,2] row_mask:0xf bank_mask:0xf
    v_perm_b32 v125, v124, v123, v35
    ds_write_b32 v47, v125 offset:3328
    v_pk_fma_f32 v[114:115], v[112:113], v[214:215], v[172:173] op_sel:[1,0,0] op_sel_hi:[0,1,1]
    v_pk_fma_f32 v[112:113], v[112:113], v[212:213], v[114:115]
    v_cvt_pk_bf16_f32 v126, v112, -v113
    s_nop 1
    v_mov_b32_dpp v127, v126 quad_perm:[1,0,3,2] row_mask:0xf bank_mask:0xf
    v_perm_b32 v128, v127, v126, v35
    ds_write_b32 v47, v128 offset:3584
    v_pk_fma_f32 v[114:115], v[112:113], v[214:215], v[174:175] op_sel:[1,0,0] op_sel_hi:[0,1,1]
    v_pk_fma_f32 v[112:113], v[112:113], v[212:213], v[114:115]
    v_cvt_pk_bf16_f32 v129, v112, -v113
    s_nop 1
    v_mov_b32_dpp v130, v129 quad_perm:[1,0,3,2] row_mask:0xf bank_mask:0xf
    v_perm_b32 v131, v130, v129, v35
    ds_write_b32 v47, v131 offset:3840
    v_pk_fma_f32 v[114:115], v[112:113], v[214:215], v[176:177] op_sel:[1,0,0] op_sel_hi:[0,1,1]
    v_pk_fma_f32 v[112:113], v[112:113], v[212:213], v[114:115]
    v_cvt_pk_bf16_f32 v120, v112, -v113
    s_nop 1
    v_mov_b32_dpp v121, v120 quad_perm:[1,0,3,2] row_mask:0xf bank_mask:0xf
    v_perm_b32 v122, v121, v120, v35
    ds_write_b32 v47, v122 offset:4096
    v_pk_fma_f32 v[114:115], v[112:113], v[214:215], v[178:179] op_sel:[1,0,0] op_sel_hi:[0,1,1]
    v_pk_fma_f32 v[112:113], v[112:113], v[212:213], v[114:115]
    v_cvt_pk_bf16_f32 v123, v112, -v113
    s_nop 1
    v_mov_b32_dpp v124, v123 quad_perm:[1,0,3,2] row_mask:0xf bank_mask:0xf
    v_perm_b32 v125, v124, v123, v35
    ds_write_b32 v47, v125 offset:4352
    v_pk_fma_f32 v[114:115], v[112:113], v[214:215], v[180:181] op_sel:[1,0,0] op_sel_hi:[0,1,1]
    v_pk_fma_f32 v[112:113], v[112:113], v[212:213], v[114:115]
    v_cvt_pk_bf16_f32 v126, v112, -v113
    s_nop 1
    v_mov_b32_dpp v127, v126 quad_perm:[1,0,3,2] row_mask:0xf bank_mask:0xf
    v_perm_b32 v128, v127, v126, v35
    ds_write_b32 v47, v128 offset:4608
    v_pk_fma_f32 v[114:115], v[112:113], v[214:215], v[182:183] op_sel:[1,0,0] op_sel_hi:[0,1,1]
    v_pk_fma_f32 v[112:113], v[112:113], v[212:213], v[114:115]
    v_cvt_pk_bf16_f32 v129, v112, -v113
    s_nop 1
    v_mov_b32_dpp v130, v129 quad_perm:[1,0,3,2] row_mask:0xf bank_mask:0xf
    v_perm_b32 v131, v130, v129, v35
    ds_write_b32 v47, v131 offset:4864
    v_pk_fma_f32 v[114:115], v[112:113], v[214:215], v[184:185] op_sel:[1,0,0] op_sel_hi:[0,1,1]
    v_pk_fma_f32 v[112:113], v[112:113], v[212:213], v[114:115]
    v_cvt_pk_bf16_f32 v120, v112, -v113
    s_nop 1
    v_mov_b32_dpp v121, v120 quad_perm:[1,0,3,2] row_mask:0xf bank_mask:0xf
    v_perm_b32 v122, v121, v120, v35
    ds_write_b32 v47, v122 offset:5120
    v_pk_fma_f32 v[114:115], v[112:113], v[214:215], v[186:187] op_sel:[1,0,0] op_sel_hi:[0,1,1]
    v_pk_fma_f32 v[112:113], v[112:113], v[212:213], v[114:115]
    v_cvt_pk_bf16_f32 v123, v112, -v113
    s_nop 1
    v_mov_b32_dpp v124, v123 quad_perm:[1,0,3,2] row_mask:0xf bank_mask:0xf
    v_perm_b32 v125, v124, v123, v35
    ds_write_b32 v47, v125 offset:5376
    v_pk_fma_f32 v[114:115], v[112:113], v[214:215], v[188:189] op_sel:[1,0,0] op_sel_hi:[0,1,1]
    v_pk_fma_f32 v[112:113], v[112:113], v[212:213], v[114:115]
    v_cvt_pk_bf16_f32 v126, v112, -v113
    s_nop 1
    v_mov_b32_dpp v127, v126 quad_perm:[1,0,3,2] row_mask:0xf bank_mask:0xf
    v_perm_b32 v128, v127, v126, v35
    ds_write_b32 v47, v128 offset:5632
    v_pk_fma_f32 v[114:115], v[112:113], v[214:215], v[190:191] op_sel:[1,0,0] op_sel_hi:[0,1,1]
    v_pk_fma_f32 v[112:113], v[112:113], v[212:213], v[114:115]
    v_cvt_pk_bf16_f32 v129, v112, -v113
    s_nop 1
    v_mov_b32_dpp v130, v129 quad_perm:[1,0,3,2] row_mask:0xf bank_mask:0xf
    v_perm_b32 v131, v130, v129, v35
    ds_write_b32 v47, v131 offset:5888
    v_pk_fma_f32 v[114:115], v[112:113], v[214:215], v[192:193] op_sel:[1,0,0] op_sel_hi:[0,1,1]
    v_pk_fma_f32 v[112:113], v[112:113], v[212:213], v[114:115]
    v_cvt_pk_bf16_f32 v120, v112, -v113
    s_nop 1
    v_mov_b32_dpp v121, v120 quad_perm:[1,0,3,2] row_mask:0xf bank_mask:0xf
    v_perm_b32 v122, v121, v120, v35
    ds_write_b32 v47, v122 offset:6144
    v_pk_fma_f32 v[114:115], v[112:113], v[214:215], v[194:195] op_sel:[1,0,0] op_sel_hi:[0,1,1]
    v_pk_fma_f32 v[112:113], v[112:113], v[212:213], v[114:115]
    v_cvt_pk_bf16_f32 v123, v112, -v113
    s_nop 1
    v_mov_b32_dpp v124, v123 quad_perm:[1,0,3,2] row_mask:0xf bank_mask:0xf
    v_perm_b32 v125, v124, v123, v35
    ds_write_b32 v47, v125 offset:6400
    v_pk_fma_f32 v[114:115], v[112:113], v[214:215], v[196:197] op_sel:[1,0,0] op_sel_hi:[0,1,1]
    v_pk_fma_f32 v[112:113], v[112:113], v[212:213], v[114:115]
    v_cvt_pk_bf16_f32 v126, v112, -v113
    s_nop 1
    v_mov_b32_dpp v127, v126 quad_perm:[1,0,3,2] row_mask:0xf bank_mask:0xf
    v_perm_b32 v128, v127, v126, v35
    ds_write_b32 v47, v128 offset:6656
    v_pk_fma_f32 v[114:115], v[112:113], v[214:215], v[198:199] op_sel:[1,0,0] op_sel_hi:[0,1,1]
    v_pk_fma_f32 v[112:113], v[112:113], v[212:213], v[114:115]
    v_cvt_pk_bf16_f32 v129, v112, -v113
    s_nop 1
    v_mov_b32_dpp v130, v129 quad_perm:[1,0,3,2] row_mask:0xf bank_mask:0xf
    v_perm_b32 v131, v130, v129, v35
    ds_write_b32 v47, v131 offset:6912
    v_pk_fma_f32 v[114:115], v[112:113], v[214:215], v[200:201] op_sel:[1,0,0] op_sel_hi:[0,1,1]
    v_pk_fma_f32 v[112:113], v[112:113], v[212:213], v[114:115]
    v_cvt_pk_bf16_f32 v120, v112, -v113
    s_nop 1
    v_mov_b32_dpp v121, v120 quad_perm:[1,0,3,2] row_mask:0xf bank_mask:0xf
    v_perm_b32 v122, v121, v120, v35
    ds_write_b32 v47, v122 offset:7168
    v_pk_fma_f32 v[114:115], v[112:113], v[214:215], v[202:203] op_sel:[1,0,0] op_sel_hi:[0,1,1]
    v_pk_fma_f32 v[112:113], v[112:113], v[212:213], v[114:115]
    v_cvt_pk_bf16_f32 v123, v112, -v113
    s_nop 1
    v_mov_b32_dpp v124, v123 quad_perm:[1,0,3,2] row_mask:0xf bank_mask:0xf
    v_perm_b32 v125, v124, v123, v35
    ds_write_b32 v47, v125 offset:7424
    v_pk_fma_f32 v[114:115], v[112:113], v[214:215], v[204:205] op_sel:[1,0,0] op_sel_hi:[0,1,1]
    v_pk_fma_f32 v[112:113], v[112:113], v[212:213], v[114:115]
    v_cvt_pk_bf16_f32 v126, v112, -v113
    s_nop 1
    v_mov_b32_dpp v127, v126 quad_perm:[1,0,3,2] row_mask:0xf bank_mask:0xf
    v_perm_b32 v128, v127, v126, v35
    ds_write_b32 v47, v128 offset:7680
    v_pk_fma_f32 v[114:115], v[112:113], v[214:215], v[206:207] op_sel:[1,0,0] op_sel_hi:[0,1,1]
    v_pk_fma_f32 v[112:113], v[112:113], v[212:213], v[114:115]
    v_cvt_pk_bf16_f32 v129, v112, -v113
    s_nop 1
    v_mov_b32_dpp v130, v129 quad_perm:[1,0,3,2] row_mask:0xf bank_mask:0xf
    v_perm_b32 v131, v130, v129, v35
    ds_write_b32 v47, v131 offset:7936
    s_waitcnt lgkmcnt(0)
    s_barrier
    s_lshl_b32 s5, s64, 13
    v_lshl_add_u32 v4, v1, 4, s5
    ds_read_b128 v[144:147], v4 offset:0
    ds_read_b128 v[148:151], v4 offset:1024
    ds_read_b128 v[152:155], v4 offset:2048
    ds_read_b128 v[156:159], v4 offset:3072
    ds_read_b128 v[160:163], v4 offset:4096
    ds_read_b128 v[164:167], v4 offset:5120
    ds_read_b128 v[168:171], v4 offset:6144
    ds_read_b128 v[172:175], v4 offset:7168
    s_mov_b32 s5, 0x0
    s_waitcnt lgkmcnt(7)
    buffer_store_dwordx4 v[144:147], v36, s[60:63], s5 offen sc1
    s_mov_b32 s5, 0x4000
    s_waitcnt lgkmcnt(6)
    buffer_store_dwordx4 v[148:151], v36, s[60:63], s5 offen sc1
    s_mov_b32 s5, 0x8000
    s_waitcnt lgkmcnt(5)
    buffer_store_dwordx4 v[152:155], v36, s[60:63], s5 offen sc1
    s_mov_b32 s5, 0xc000
    s_waitcnt lgkmcnt(4)
    buffer_store_dwordx4 v[156:159], v36, s[60:63], s5 offen sc1
    s_mov_b32 s5, 0x10000
    s_waitcnt lgkmcnt(3)
    buffer_store_dwordx4 v[160:163], v36, s[60:63], s5 offen sc1
    s_mov_b32 s5, 0x14000
    s_waitcnt lgkmcnt(2)
    buffer_store_dwordx4 v[164:167], v36, s[60:63], s5 offen sc1
    s_mov_b32 s5, 0x18000
    s_waitcnt lgkmcnt(1)
    buffer_store_dwordx4 v[168:171], v36, s[60:63], s5 offen sc1
    s_mov_b32 s5, 0x1c000
    s_waitcnt lgkmcnt(0)
    buffer_store_dwordx4 v[172:175], v36, s[60:63], s5 offen sc1
    s_lshl_b32 s5, s74, 2
    s_add_u32 s5, s5, 128
    v_mov_b32 v34, s5
    v_mov_b32 v35, 1
    s_waitcnt vmcnt(0) lgkmcnt(0)
    s_barrier
    s_cmp_lt_u32 s64, 4
    s_cbranch_scc1 hob_go
    s_endpgm
hob_go:
    s_cmp_lg_u32 s64, 0
    s_cbranch_scc1 hob_nosig
    s_mov_b64 exec, 1
    global_atomic_add v34, v35, s[44:45] sc1
    s_mov_b64 exec, -1
hob_nosig:
    s_lshl_b32 s74, s74, 1
    s_and_b32 s5, s75, 1
    s_add_u32 s74, s74, s5
    s_lshr_b32 s75, s75, 1
    s_and_b32 s5, s2, 7
    s_lshl_b32 s11, s5, 1
    s_add_u32 s11, s11, 1
    s_lshl_b32 s72, s64, 12
    s_add_u32 s73, s72, 16384
    s_lshl_b32 s70, s11, 7
    s_mov_b32 s71, s70
    s_mov_b32 s10, 0
    s_lshl_b32 s69, s76, 13
    v_bfe_u32 v4, v1, 1, 3
    v_and_b32 v5, 15, v1
    v_lshlrev_b32 v5, 7, v5
    v_add_u32 v5, s69, v5
    v_lshrrev_b32 v8, 4, v1
    v_xor_b32 v8, v8, v4
    v_lshl_add_u32 v8, v8, 4, v5
    v_lshrrev_b32 v9, 4, v1
    v_or_b32 v9, 4, v9
    v_xor_b32 v9, v9, v4
    v_lshl_add_u32 v9, v9, 4, v5
    s_lshl_b32 s5, s74, 7
    s_lshl_b32 s6, s76, 6
    s_add_u32 s5, s5, s6
    s_lshl_b32 s6, s75, 7
    s_lshl_b32 s7, s77, 6
    s_add_u32 s6, s6, s7
    v_lshrrev_b32 v4, 4, v1
    v_add_u32 v4, s5, v4
    v_and_b32 v5, 15, v1
    v_lshl_add_u32 v5, v5, 2, s6
    v_lshlrev_b32 v24, 13, v4
    v_lshl_add_u32 v24, v5, 2, v24
    v_lshlrev_b32 v25, 11, v4
    v_lshl_add_u32 v25, v5, 1, v25
    v_lshlrev_b32 v6, 1, v5
    s_lshl_b32 s5, s64, 14
    v_lshrrev_b32 v26, 4, v1
    v_lshlrev_b32 v26, 10, v26
    v_and_b32 v27, 15, v1
    v_lshl_add_u32 v26, v27, 2, v26
    v_add_u32 v26, s5, v26
    v_lshl_add_u32 v27, v1, 4, s5
    s_mov_b32 s56, s42
    s_and_b32 s57, s43, 0xffff
    s_mov_b32 s58, 0x1000000
    s_mov_b32 s59, 0x00020000
    s_mov_b32 s60, s40
    s_and_b32 s61, s41, 0xffff
    s_mov_b32 s62, 0x800
    s_mov_b32 s63, 0x00020000
    buffer_load_dwordx2 v[32:33], v6, s[60:63], 0 offen
    s_add_u32 s48, s46, 0x400000
    s_addc_u32 s49, s47, 0
    s_and_b32 s49, s49, 0xffff
    s_mov_b32 s50, 0x800000
    s_mov_b32 s51, 0x00020000
    s_mov_b32 s52, s34
    s_and_b32 s53, s35, 0xffff
    s_mov_b32 s54, 0x200000
    s_mov_b32 s55, 0x00020000
    s_mov_b32 s96, s24
    s_and_b32 s97, s25, 0xffff
    s_mov_b32 s98, 0x400000
    s_mov_b32 s99, 0x00020000
    s_mov_b32 s78, 0x0
    buffer_load_dwordx2 v[192:193], v25, s[96:99], s78 offen
    s_mov_b32 s78, 0x2000
    buffer_load_dwordx2 v[194:195], v25, s[96:99], s78 offen
    s_mov_b32 s78, 0x4000
    buffer_load_dwordx2 v[196:197], v25, s[96:99], s78 offen
    s_mov_b32 s78, 0x6000
    buffer_load_dwordx2 v[198:199], v25, s[96:99], s78 offen
    s_mov_b32 s78, 0x8000
    buffer_load_dwordx2 v[200:201], v25, s[96:99], s78 offen
    s_mov_b32 s78, 0xa000
    buffer_load_dwordx2 v[202:203], v25, s[96:99], s78 offen
    s_mov_b32 s78, 0xc000
    buffer_load_dwordx2 v[204:205], v25, s[96:99], s78 offen
    s_mov_b32 s78, 0xe000
    buffer_load_dwordx2 v[206:207], v25, s[96:99], s78 offen
    s_mov_b32 s78, 0x10000
    buffer_load_dwordx2 v[208:209], v25, s[96:99], s78 offen
    s_mov_b32 s78, 0x12000
    buffer_load_dwordx2 v[210:211], v25, s[96:99], s78 offen
    s_mov_b32 s78, 0x14000
    buffer_load_dwordx2 v[212:213], v25, s[96:99], s78 offen
    s_mov_b32 s78, 0x16000
    buffer_load_dwordx2 v[214:215], v25, s[96:99], s78 offen
    s_mov_b32 s78, 0x18000
    buffer_load_dwordx2 v[216:217], v25, s[96:99], s78 offen
    s_mov_b32 s78, 0x1a000
    buffer_load_dwordx2 v[218:219], v25, s[96:99], s78 offen
    s_mov_b32 s78, 0x1c000
    buffer_load_dwordx2 v[220:221], v25, s[96:99], s78 offen
    s_mov_b32 s78, 0x1e000
    buffer_load_dwordx2 v[222:223], v25, s[96:99], s78 offen
    s_lshl_b32 s5, s74, 7
    s_lshl_b32 s78, s64, 5
    s_add_u32 s78, s78, s5
    v_lshrrev_b32 v4, 3, v1
    v_add_u32 v4, s78, v4
    v_lshlrev_b32 v4, 12, v4
    v_lshrrev_b32 v5, 4, v1
    v_and_b32 v6, 7, v1
    v_xor_b32 v5, v5, v6
    v_xor_b32 v6, 0, v5
    v_lshl_add_u32 v16, v6, 4, v4
    v_xor_b32 v6, 4, v5
    v_lshl_add_u32 v17, v6, 4, v4
    v_add_u32 v17, 0x7c00, v17
    v_xor_b32 v6, 0, v5
    v_lshl_add_u32 v18, v6, 4, v4
    v_add_u32 v18, 0xf800, v18
    v_xor_b32 v6, 4, v5
    v_lshl_add_u32 v19, v6, 4, v4
    v_add_u32 v19, 0x17400, v19
    s_lshl_b32 s5, s75, 7
    s_lshl_b32 s78, s64, 5
    s_add_u32 s78, s78, s5
    v_lshrrev_b32 v4, 3, v1
    v_add_u32 v4, s78, v4
    v_lshlrev_b32 v4, 11, v4
    v_lshrrev_b32 v5, 4, v1
    v_and_b32 v6, 7, v1
    v_xor_b32 v5, v5, v6
    v_xor_b32 v6, 0, v5
    v_lshl_add_u32 v20, v6, 4, v4
    v_xor_b32 v6, 4, v5
    v_lshl_add_u32 v21, v6, 4, v4
    v_add_u32 v21, 0x3c00, v21
    v_xor_b32 v6, 0, v5
    v_lshl_add_u32 v22, v6, 4, v4
    v_add_u32 v22, 0x7800, v22
    v_xor_b32 v6, 4, v5
    v_lshl_add_u32 v23, v6, 4, v4
    v_add_u32 v23, 0xb400, v23
    s_lshl_b32 s69, s77, 13
    v_bfe_u32 v4, v1, 1, 3
    v_and_b32 v5, 15, v1
    v_lshlrev_b32 v5, 7, v5
    v_add_u32 v5, s69, v5
    v_add_u32 v5, 0x4000, v5
    v_lshrrev_b32 v12, 4, v1
    v_xor_b32 v12, v12, v4
    v_lshl_add_u32 v12, v12, 4, v5
    v_lshrrev_b32 v13, 4, v1
    v_or_b32 v13, 4, v13
    v_xor_b32 v13, v13, v4
    v_lshl_add_u32 v13, v13, 4, v5
    s_mov_b32 m0, s73
    s_add_u32 s73, s73, 0x8000
    buffer_load_dwordx4 v20, s[52:55], s71 offen offset:0 lds
    buffer_load_dwordx4 v21, s[52:55], s71 offen offset:1024 lds
    buffer_load_dwordx4 v22, s[52:55], s71 offen offset:2048 lds
    buffer_load_dwordx4 v23, s[52:55], s71 offen offset:3072 lds
    s_add_u32 s71, s71, 128
    s_and_b32 s71, s71, 0x7ff
    s_mov_b32 m0, s73
    s_add_u32 s73, s73, 0x8000
    buffer_load_dwordx4 v20, s[52:55], s71 offen offset:0 lds
    buffer_load_dwordx4 v21, s[52:55], s71 offen offset:1024 lds
    buffer_load_dwordx4 v22, s[52:55], s71 offen offset:2048 lds
    buffer_load_dwordx4 v23, s[52:55], s71 offen offset:3072 lds
    s_add_u32 s71, s71, 128
    s_and_b32 s71, s71, 0x7ff
    s_mov_b32 m0, s73
    s_add_u32 s73, s73, 0x8000
    buffer_load_dwordx4 v20, s[52:55], s71 offen offset:0 lds
    buffer_load_dwordx4 v21, s[52:55], s71 offen offset:1024 lds
    buffer_load_dwordx4 v22, s[52:55], s71 offen offset:2048 lds
    buffer_load_dwordx4 v23, s[52:55], s71 offen offset:3072 lds
    s_add_u32 s71, s71, 128
    s_and_b32 s71, s71, 0x7ff
    s_mov_b32 m0, s73
    s_add_u32 s73, s73, 0xfffe8000
    buffer_load_dwordx4 v20, s[52:55], s71 offen offset:0 lds
    buffer_load_dwordx4 v21, s[52:55], s71 offen offset:1024 lds
    buffer_load_dwordx4 v22, s[52:55], s71 offen offset:2048 lds
    buffer_load_dwordx4 v23, s[52:55], s71 offen offset:3072 lds
    s_add_u32 s71, s71, 128
    s_and_b32 s71, s71, 0x7ff
    s_cmp_lg_u32 s64, 0
    s_cbranch_scc1 hob_poll_done
    s_mov_b32 s5, 0
hob_poll_loop:
    global_load_dword v4, v34, s[44:45] sc1
    s_waitcnt vmcnt(0)
    v_readfirstlane_b32 s6, v4
    s_nop 3
    s_cmp_ge_u32 s6, 16
    s_cbranch_scc1 hob_poll_ok
    s_sleep 1
    s_add_u32 s5, s5, 1
    s_cmp_lt_u32 s5, 2097152
    s_cbranch_scc1 hob_poll_loop
hob_poll_ok:
hob_poll_done:
    s_barrier
    s_mov_b32 m0, s72
    s_add_u32 s72, s72, 0x8000
    buffer_load_dwordx4 v16, s[48:51], s70 offen offset:0 sc1 lds
    buffer_load_dwordx4 v17, s[48:51], s70 offen offset:1024 sc1 lds
    buffer_load_dwordx4 v18, s[48:51], s70 offen offset:2048 sc1 lds
    buffer_load_dwordx4 v19, s[48:51], s70 offen offset:3072 sc1 lds
    s_add_u32 s70, s70, 128
    s_and_b32 s70, s70, 0x7ff
    s_or_b32 s70, s70, s10
    s_mov_b32 m0, s72
    s_add_u32 s72, s72, 0x8000
    buffer_load_dwordx4 v16, s[48:51], s70 offen offset:0 sc1 lds
    buffer_load_dwordx4 v17, s[48:51], s70 offen offset:1024 sc1 lds
    buffer_load_dwordx4 v18, s[48:51], s70 offen offset:2048 sc1 lds
    buffer_load_dwordx4 v19, s[48:51], s70 offen offset:3072 sc1 lds
    s_add_u32 s70, s70, 128
    s_and_b32 s70, s70, 0x7ff
    s_or_b32 s70, s70, s10
    s_mov_b32 m0, s72
    s_add_u32 s72, s72, 0x8000
    buffer_load_dwordx4 v16, s[48:51], s70 offen offset:0 sc1 lds
    buffer_load_dwordx4 v17, s[48:51], s70 offen offset:1024 sc1 lds
    buffer_load_dwordx4 v18, s[48:51], s70 offen offset:2048 sc1 lds
    buffer_load_dwordx4 v19, s[48:51], s70 offen offset:3072 sc1 lds
    s_add_u32 s70, s70, 128
    s_and_b32 s70, s70, 0x7ff
    s_or_b32 s70, s70, s10
    s_mov_b32 m0, s72
    s_add_u32 s72, s72, 0xfffe8000
    buffer_load_dwordx4 v16, s[48:51], s70 offen offset:0 sc1 lds
    buffer_load_dwordx4 v17, s[48:51], s70 offen offset:1024 sc1 lds
    buffer_load_dwordx4 v18, s[48:51], s70 offen offset:2048 sc1 lds
    buffer_load_dwordx4 v19, s[48:51], s70 offen offset:3072 sc1 lds
    s_add_u32 s70, s70, 128
    s_and_b32 s70, s70, 0x7ff
    s_or_b32 s70, s70, s10
    s_mov_b32 s67, 0x8000
    s_mov_b32 s68, 0x8000
    s_mov_b32 s79, 0x8000
    s_mov_b32 s9, 0xfffe8000
    s_waitcnt vmcnt(12)
    s_barrier
    ds_read_b128 v[128:131], v8 offset:0
    ds_read_b128 v[144:147], v12 offset:0
    ds_read_b128 v[148:151], v12 offset:2048
    ds_read_b128 v[152:155], v12 offset:4096
    ds_read_b128 v[156:159], v12 offset:6144
    ds_read_b128 v[132:135], v8 offset:2048
    ds_read_b128 v[136:139], v8 offset:4096
    ds_read_b128 v[140:143], v8 offset:6144
    v_add_u32 v8, s67, v8
    v_add_u32 v12, s67, v12
    s_waitcnt lgkmcnt(0)
    v_mfma_f32_16x16x32_bf16 v[64:67], v[128:131], v[144:147], 0
    ds_read_b128 v[160:163], v9 offset:0
    v_mfma_f32_16x16x32_bf16 v[68:71], v[128:131], v[148:151], 0
    ds_read_b128 v[176:179], v13 offset:0
    v_mfma_f32_16x16x32_bf16 v[72:75], v[128:131], v[152:155], 0
    v_mfma_f32_16x16x32_bf16 v[76:79], v[128:131], v[156:159], 0
    ds_read_b128 v[180:183], v13 offset:2048
    v_mfma_f32_16x16x32_bf16 v[80:83], v[132:135], v[144:147], 0
    ds_read_b128 v[184:187], v13 offset:4096
    v_mfma_f32_16x16x32_bf16 v[84:87], v[132:135], v[148:151], 0
    v_mfma_f32_16x16x32_bf16 v[88:91], v[132:135], v[152:155], 0
    ds_read_b128 v[188:191], v13 offset:6144
    v_mfma_f32_16x16x32_bf16 v[92:95], v[132:135], v[156:159], 0
    v_mfma_f32_16x16x32_bf16 v[96:99], v[136:139], v[144:147], 0
    ds_read_b128 v[164:167], v9 offset:2048
    v_mfma_f32_16x16x32_bf16 v[100:103], v[136:139], v[148:151], 0
    ds_read_b128 v[168:171], v9 offset:4096
    v_mfma_f32_16x16x32_bf16 v[104:107], v[136:139], v[152:155], 0
    v_mfma_f32_16x16x32_bf16 v[108:111], v[136:139], v[156:159], 0
    ds_read_b128 v[172:175], v9 offset:6144
    v_mfma_f32_16x16x32_bf16 v[112:115], v[140:143], v[144:147], 0
    v_add_u32 v9, s67, v9
    v_mfma_f32_16x16x32_bf16 v[116:119], v[140:143], v[148:151], 0
    v_mfma_f32_16x16x32_bf16 v[120:123], v[140:143], v[152:155], 0
    v_add_u32 v13, s67, v13
    v_mfma_f32_16x16x32_bf16 v[124:127], v[140:143], v[156:159], 0
    s_waitcnt vmcnt(8) lgkmcnt(0)
    s_barrier
    v_mfma_f32_16x16x32_bf16 v[64:67], v[160:163], v[176:179], v[64:67]
    ds_read_b128 v[128:131], v8 offset:0
    ds_read_b128 v[144:147], v12 offset:0
    v_mfma_f32_16x16x32_bf16 v[68:71], v[160:163], v[180:183], v[68:71]
    ds_read_b128 v[148:151], v12 offset:2048
    v_mfma_f32_16x16x32_bf16 v[72:75], v[160:163], v[184:187], v[72:75]
    ds_read_b128 v[152:155], v12 offset:4096
    v_mfma_f32_16x16x32_bf16 v[76:79], v[160:163], v[188:191], v[76:79]
    ds_read_b128 v[156:159], v12 offset:6144
    v_mfma_f32_16x16x32_bf16 v[80:83], v[164:167], v[176:179], v[80:83]
    ds_read_b128 v[132:135], v8 offset:2048
    v_mfma_f32_16x16x32_bf16 v[84:87], v[164:167], v[180:183], v[84:87]
    ds_read_b128 v[136:139], v8 offset:4096
    ds_read_b128 v[140:143], v8 offset:6144
    v_mfma_f32_16x16x32_bf16 v[88:91], v[164:167], v[184:187], v[88:91]
    v_add_u32 v8, s68, v8
    v_mfma_f32_16x16x32_bf16 v[92:95], v[164:167], v[188:191], v[92:95]
    v_add_u32 v12, s68, v12
    v_mfma_f32_16x16x32_bf16 v[96:99], v[168:171], v[176:179], v[96:99]
    s_mov_b32 m0, s72
    s_add_u32 s72, s72, s67
    buffer_load_dwordx4 v16, s[48:51], s70 offen offset:0 sc1 lds
    v_mfma_f32_16x16x32_bf16 v[100:103], v[168:171], v[180:183], v[100:103]
    buffer_load_dwordx4 v17, s[48:51], s70 offen offset:1024 sc1 lds
    v_mfma_f32_16x16x32_bf16 v[104:107], v[168:171], v[184:187], v[104:107]
    buffer_load_dwordx4 v18, s[48:51], s70 offen offset:2048 sc1 lds
    buffer_load_dwordx4 v19, s[48:51], s70 offen offset:3072 sc1 lds
    s_add_u32 s70, s70, 128
    s_and_b32 s70, s70, 0x7ff
    s_or_b32 s70, s70, s10
    v_mfma_f32_16x16x32_bf16 v[108:111], v[168:171], v[188:191], v[108:111]
    s_mov_b32 s69, s67
    v_mfma_f32_16x16x32_bf16 v[112:115], v[172:175], v[176:179], v[112:115]
    s_mov_b32 s67, s68
    v_mfma_f32_16x16x32_bf16 v[116:119], v[172:175], v[180:183], v[116:119]
    s_mov_b32 s68, s79
    v_mfma_f32_16x16x32_bf16 v[120:123], v[172:175], v[184:187], v[120:123]
    s_mov_b32 s79, s9
    v_mfma_f32_16x16x32_bf16 v[124:127], v[172:175], v[188:191], v[124:127]
    s_mov_b32 s9, s69
    s_waitcnt lgkmcnt(0)
    v_mfma_f32_16x16x32_bf16 v[64:67], v[128:131], v[144:147], v[64:67]
    ds_read_b128 v[160:163], v9 offset:0
    v_mfma_f32_16x16x32_bf16 v[68:71], v[128:131], v[148:151], v[68:71]
    ds_read_b128 v[176:179], v13 offset:0
    v_mfma_f32_16x16x32_bf16 v[72:75], v[128:131], v[152:155], v[72:75]
    ds_read_b128 v[180:183], v13 offset:2048
    v_mfma_f32_16x16x32_bf16 v[76:79], v[128:131], v[156:159], v[76:79]
    ds_read_b128 v[184:187], v13 offset:4096
    v_mfma_f32_16x16x32_bf16 v[80:83], v[132:135], v[144:147], v[80:83]
    ds_read_b128 v[188:191], v13 offset:6144
    v_mfma_f32_16x16x32_bf16 v[84:87], v[132:135], v[148:151], v[84:87]
    ds_read_b128 v[164:167], v9 offset:2048
    v_mfma_f32_16x16x32_bf16 v[88:91], v[132:135], v[152:155], v[88:91]
    ds_read_b128 v[168:171], v9 offset:4096
    v_mfma_f32_16x16x32_bf16 v[92:95], v[132:135], v[156:159], v[92:95]
    v_mfma_f32_16x16x32_bf16 v[96:99], v[136:139], v[144:147], v[96:99]
    ds_read_b128 v[172:175], v9 offset:6144
    v_mfma_f32_16x16x32_bf16 v[100:103], v[136:139], v[148:151], v[100:103]
    v_add_u32 v9, s67, v9
    v_mfma_f32_16x16x32_bf16 v[104:107], v[136:139], v[152:155], v[104:107]
    v_add_u32 v13, s67, v13
    v_mfma_f32_16x16x32_bf16 v[108:111], v[136:139], v[156:159], v[108:111]
    s_mov_b32 m0, s73
    s_add_u32 s73, s73, s9
    buffer_load_dwordx4 v20, s[52:55], s71 offen offset:0 lds
    v_mfma_f32_16x16x32_bf16 v[112:115], v[140:143], v[144:147], v[112:115]
    buffer_load_dwordx4 v21, s[52:55], s71 offen offset:1024 lds
    v_mfma_f32_16x16x32_bf16 v[116:119], v[140:143], v[148:151], v[116:119]
    buffer_load_dwordx4 v22, s[52:55], s71 offen offset:2048 lds
    v_mfma_f32_16x16x32_bf16 v[120:123], v[140:143], v[152:155], v[120:123]
    buffer_load_dwordx4 v23, s[52:55], s71 offen offset:3072 lds
    s_add_u32 s71, s71, 128
    s_and_b32 s71, s71, 0x7ff
    v_mfma_f32_16x16x32_bf16 v[124:127], v[140:143], v[156:159], v[124:127]
    s_waitcnt vmcnt(12) lgkmcnt(0)
    s_barrier
    v_mfma_f32_16x16x32_bf16 v[64:67], v[160:163], v[176:179], v[64:67]
    ds_read_b128 v[128:131], v8 offset:0
    ds_read_b128 v[144:147], v12 offset:0
    v_mfma_f32_16x16x32_bf16 v[68:71], v[160:163], v[180:183], v[68:71]
    ds_read_b128 v[148:151], v12 offset:2048
    v_mfma_f32_16x16x32_bf16 v[72:75], v[160:163], v[184:187], v[72:75]
    ds_read_b128 v[152:155], v12 offset:4096
    v_mfma_f32_16x16x32_bf16 v[76:79], v[160:163], v[188:191], v[76:79]
    ds_read_b128 v[156:159], v12 offset:6144
    v_mfma_f32_16x16x32_bf16 v[80:83], v[164:167], v[176:179], v[80:83]
    ds_read_b128 v[132:135], v8 offset:2048
    v_mfma_f32_16x16x32_bf16 v[84:87], v[164:167], v[180:183], v[84:87]
    ds_read_b128 v[136:139], v8 offset:4096
    ds_read_b128 v[140:143], v8 offset:6144
    v_mfma_f32_16x16x32_bf16 v[88:91], v[164:167], v[184:187], v[88:91]
    v_add_u32 v8, s68, v8
    v_mfma_f32_16x16x32_bf16 v[92:95], v[164:167], v[188:191], v[92:95]
    v_add_u32 v12, s68, v12
    v_mfma_f32_16x16x32_bf16 v[96:99], v[168:171], v[176:179], v[96:99]
    s_mov_b32 m0, s72
    s_add_u32 s72, s72, s67
    buffer_load_dwordx4 v16, s[48:51], s70 offen offset:0 sc1 lds
    v_mfma_f32_16x16x32_bf16 v[100:103], v[168:171], v[180:183], v[100:103]
    buffer_load_dwordx4 v17, s[48:51], s70 offen offset:1024 sc1 lds
    v_mfma_f32_16x16x32_bf16 v[104:107], v[168:171], v[184:187], v[104:107]
    buffer_load_dwordx4 v18, s[48:51], s70 offen offset:2048 sc1 lds
    buffer_load_dwordx4 v19, s[48:51], s70 offen offset:3072 sc1 lds
    s_add_u32 s70, s70, 128
    s_and_b32 s70, s70, 0x7ff
    s_or_b32 s70, s70, s10
    v_mfma_f32_16x16x32_bf16 v[108:111], v[168:171], v[188:191], v[108:111]
    s_mov_b32 s69, s67
    v_mfma_f32_16x16x32_bf16 v[112:115], v[172:175], v[176:179], v[112:115]
    s_mov_b32 s67, s68
    v_mfma_f32_16x16x32_bf16 v[116:119], v[172:175], v[180:183], v[116:119]
    s_mov_b32 s68, s79
    v_mfma_f32_16x16x32_bf16 v[120:123], v[172:175], v[184:187], v[120:123]
    s_mov_b32 s79, s9
    v_mfma_f32_16x16x32_bf16 v[124:127], v[172:175], v[188:191], v[124:127]
    s_mov_b32 s9, s69
    s_mov_b32 s65, 10
p2b_L0:
    s_waitcnt lgkmcnt(0)
    v_mfma_f32_16x16x32_bf16 v[64:67], v[128:131], v[144:147], v[64:67]
    ds_read_b128 v[160:163], v9 offset:0
    v_mfma_f32_16x16x32_bf16 v[68:71], v[128:131], v[148:151], v[68:71]
    ds_read_b128 v[176:179], v13 offset:0
    v_mfma_f32_16x16x32_bf16 v[72:75], v[128:131], v[152:155], v[72:75]
    ds_read_b128 v[180:183], v13 offset:2048
    v_mfma_f32_16x16x32_bf16 v[76:79], v[128:131], v[156:159], v[76:79]
    ds_read_b128 v[184:187], v13 offset:4096
    v_mfma_f32_16x16x32_bf16 v[80:83], v[132:135], v[144:147], v[80:83]
    ds_read_b128 v[188:191], v13 offset:6144
    v_mfma_f32_16x16x32_bf16 v[84:87], v[132:135], v[148:151], v[84:87]
    ds_read_b128 v[164:167], v9 offset:2048
    v_mfma_f32_16x16x32_bf16 v[88:91], v[132:135], v[152:155], v[88:91]
    ds_read_b128 v[168:171], v9 offset:4096
    v_mfma_f32_16x16x32_bf16 v[92:95], v[132:135], v[156:159], v[92:95]
    v_mfma_f32_16x16x32_bf16 v[96:99], v[136:139], v[144:147], v[96:99]
    ds_read_b128 v[172:175], v9 offset:6144
    v_mfma_f32_16x16x32_bf16 v[100:103], v[136:139], v[148:151], v[100:103]
    v_add_u32 v9, s67, v9
    v_mfma_f32_16x16x32_bf16 v[104:107], v[136:139], v[152:155], v[104:107]
    v_add_u32 v13, s67, v13
    v_mfma_f32_16x16x32_bf16 v[108:111], v[136:139], v[156:159], v[108:111]
    s_mov_b32 m0, s73
    s_add_u32 s73, s73, s9
    buffer_load_dwordx4 v20, s[52:55], s71 offen offset:0 lds
    v_mfma_f32_16x16x32_bf16 v[112:115], v[140:143], v[144:147], v[112:115]
    buffer_load_dwordx4 v21, s[52:55], s71 offen offset:1024 lds
    v_mfma_f32_16x16x32_bf16 v[116:119], v[140:143], v[148:151], v[116:119]
    buffer_load_dwordx4 v22, s[52:55], s71 offen offset:2048 lds
    v_mfma_f32_16x16x32_bf16 v[120:123], v[140:143], v[152:155], v[120:123]
    buffer_load_dwordx4 v23, s[52:55], s71 offen offset:3072 lds
    s_add_u32 s71, s71, 128
    s_and_b32 s71, s71, 0x7ff
    v_mfma_f32_16x16x32_bf16 v[124:127], v[140:143], v[156:159], v[124:127]
    s_waitcnt vmcnt(16) lgkmcnt(0)
    s_barrier
    v_mfma_f32_16x16x32_bf16 v[64:67], v[160:163], v[176:179], v[64:67]
    ds_read_b128 v[128:131], v8 offset:0
    ds_read_b128 v[144:147], v12 offset:0
    v_mfma_f32_16x16x32_bf16 v[68:71], v[160:163], v[180:183], v[68:71]
    ds_read_b128 v[148:151], v12 offset:2048
    v_mfma_f32_16x16x32_bf16 v[72:75], v[160:163], v[184:187], v[72:75]
    ds_read_b128 v[152:155], v12 offset:4096
    v_mfma_f32_16x16x32_bf16 v[76:79], v[160:163], v[188:191], v[76:79]
    ds_read_b128 v[156:159], v12 offset:6144
    v_mfma_f32_16x16x32_bf16 v[80:83], v[164:167], v[176:179], v[80:83]
    ds_read_b128 v[132:135], v8 offset:2048
    v_mfma_f32_16x16x32_bf16 v[84:87], v[164:167], v[180:183], v[84:87]
    ds_read_b128 v[136:139], v8 offset:4096
    ds_read_b128 v[140:143], v8 offset:6144
    v_mfma_f32_16x16x32_bf16 v[88:91], v[164:167], v[184:187], v[88:91]
    v_add_u32 v8, s68, v8
    v_mfma_f32_16x16x32_bf16 v[92:95], v[164:167], v[188:191], v[92:95]
    v_add_u32 v12, s68, v12
    v_mfma_f32_16x16x32_bf16 v[96:99], v[168:171], v[176:179], v[96:99]
    s_mov_b32 m0, s72
    s_add_u32 s72, s72, s67
    buffer_load_dwordx4 v16, s[48:51], s70 offen offset:0 sc1 lds
    v_mfma_f32_16x16x32_bf16 v[100:103], v[168:171], v[180:183], v[100:103]
    buffer_load_dwordx4 v17, s[48:51], s70 offen offset:1024 sc1 lds
    v_mfma_f32_16x16x32_bf16 v[104:107], v[168:171], v[184:187], v[104:107]
    buffer_load_dwordx4 v18, s[48:51], s70 offen offset:2048 sc1 lds
    buffer_load_dwordx4 v19, s[48:51], s70 offen offset:3072 sc1 lds
    s_add_u32 s70, s70, 128
    s_and_b32 s70, s70, 0x7ff
    s_or_b32 s70, s70, s10
    v_mfma_f32_16x16x32_bf16 v[108:111], v[168:171], v[188:191], v[108:111]
    s_mov_b32 s69, s67
    v_mfma_f32_16x16x32_bf16 v[112:115], v[172:175], v[176:179], v[112:115]
    s_mov_b32 s67, s68
    v_mfma_f32_16x16x32_bf16 v[116:119], v[172:175], v[180:183], v[116:119]
    s_mov_b32 s68, s79
    v_mfma_f32_16x16x32_bf16 v[120:123], v[172:175], v[184:187], v[120:123]
    s_mov_b32 s79, s9
    v_mfma_f32_16x16x32_bf16 v[124:127], v[172:175], v[188:191], v[124:127]
    s_mov_b32 s9, s69
    s_sub_u32 s65, s65, 1
    s_cmp_lg_u32 s65, 0
    s_cbranch_scc1 p2b_L0
    s_waitcnt lgkmcnt(0)
    v_mfma_f32_16x16x32_bf16 v[64:67], v[128:131], v[144:147], v[64:67]
    ds_read_b128 v[160:163], v9 offset:0
    v_mfma_f32_16x16x32_bf16 v[68:71], v[128:131], v[148:151], v[68:71]
    ds_read_b128 v[176:179], v13 offset:0
    v_mfma_f32_16x16x32_bf16 v[72:75], v[128:131], v[152:155], v[72:75]
    ds_read_b128 v[180:183], v13 offset:2048
    v_mfma_f32_16x16x32_bf16 v[76:79], v[128:131], v[156:159], v[76:79]
    ds_read_b128 v[184:187], v13 offset:4096
    v_mfma_f32_16x16x32_bf16 v[80:83], v[132:135], v[144:147], v[80:83]
    ds_read_b128 v[188:191], v13 offset:6144
    v_mfma_f32_16x16x32_bf16 v[84:87], v[132:135], v[148:151], v[84:87]
    ds_read_b128 v[164:167], v9 offset:2048
    v_mfma_f32_16x16x32_bf16 v[88:91], v[132:135], v[152:155], v[88:91]
    ds_read_b128 v[168:171], v9 offset:4096
    v_mfma_f32_16x16x32_bf16 v[92:95], v[132:135], v[156:159], v[92:95]
    v_mfma_f32_16x16x32_bf16 v[96:99], v[136:139], v[144:147], v[96:99]
    ds_read_b128 v[172:175], v9 offset:6144
    v_mfma_f32_16x16x32_bf16 v[100:103], v[136:139], v[148:151], v[100:103]
    v_add_u32 v9, s67, v9
    v_mfma_f32_16x16x32_bf16 v[104:107], v[136:139], v[152:155], v[104:107]
    v_add_u32 v13, s67, v13
    v_mfma_f32_16x16x32_bf16 v[108:111], v[136:139], v[156:159], v[108:111]
    s_mov_b32 m0, s73
    s_add_u32 s73, s73, s9
    buffer_load_dwordx4 v20, s[52:55], s71 offen offset:0 lds
    v_mfma_f32_16x16x32_bf16 v[112:115], v[140:143], v[144:147], v[112:115]
    buffer_load_dwordx4 v21, s[52:55], s71 offen offset:1024 lds
    v_mfma_f32_16x16x32_bf16 v[116:119], v[140:143], v[148:151], v[116:119]
    buffer_load_dwordx4 v22, s[52:55], s71 offen offset:2048 lds
    v_mfma_f32_16x16x32_bf16 v[120:123], v[140:143], v[152:155], v[120:123]
    buffer_load_dwordx4 v23, s[52:55], s71 offen offset:3072 lds
    s_add_u32 s71, s71, 128
    s_and_b32 s71, s71, 0x7ff
    v_mfma_f32_16x16x32_bf16 v[124:127], v[140:143], v[156:159], v[124:127]
    s_waitcnt vmcnt(16) lgkmcnt(0)
    s_barrier
    v_mfma_f32_16x16x32_bf16 v[64:67], v[160:163], v[176:179], v[64:67]
    ds_read_b128 v[128:131], v8 offset:0
    ds_read_b128 v[144:147], v12 offset:0
    v_mfma_f32_16x16x32_bf16 v[68:71], v[160:163], v[180:183], v[68:71]
    ds_read_b128 v[148:151], v12 offset:2048
    v_mfma_f32_16x16x32_bf16 v[72:75], v[160:163], v[184:187], v[72:75]
    ds_read_b128 v[152:155], v12 offset:4096
    v_mfma_f32_16x16x32_bf16 v[76:79], v[160:163], v[188:191], v[76:79]
    ds_read_b128 v[156:159], v12 offset:6144
    v_mfma_f32_16x16x32_bf16 v[80:83], v[164:167], v[176:179], v[80:83]
    ds_read_b128 v[132:135], v8 offset:2048
    ds_read_b128 v[136:139], v8 offset:4096
    v_mfma_f32_16x16x32_bf16 v[84:87], v[164:167], v[180:183], v[84:87]
    ds_read_b128 v[140:143], v8 offset:6144
    v_mfma_f32_16x16x32_bf16 v[88:91], v[164:167], v[184:187], v[88:91]
    v_add_u32 v8, s68, v8
    v_mfma_f32_16x16x32_bf16 v[92:95], v[164:167], v[188:191], v[92:95]
    v_add_u32 v12, s68, v12
    v_mfma_f32_16x16x32_bf16 v[96:99], v[168:171], v[176:179], v[96:99]
    s_mov_b32 s52, s36
    s_and_b32 s53, s37, 0xffff
    s_mov_b32 s10, 0x800
    s_or_b32 s70, s70, s10
    s_mov_b32 m0, s72
    s_add_u32 s72, s72, s67
    buffer_load_dwordx4 v16, s[48:51], s70 offen offset:0 sc1 lds
    v_mfma_f32_16x16x32_bf16 v[100:103], v[168:171], v[180:183], v[100:103]
    buffer_load_dwordx4 v17, s[48:51], s70 offen offset:1024 sc1 lds
    v_mfma_f32_16x16x32_bf16 v[104:107], v[168:171], v[184:187], v[104:107]
    buffer_load_dwordx4 v18, s[48:51], s70 offen offset:2048 sc1 lds
    v_mfma_f32_16x16x32_bf16 v[108:111], v[168:171], v[188:191], v[108:111]
    buffer_load_dwordx4 v19, s[48:51], s70 offen offset:3072 sc1 lds
    s_add_u32 s70, s70, 128
    s_and_b32 s70, s70, 0x7ff
    s_or_b32 s70, s70, s10
    v_mfma_f32_16x16x32_bf16 v[112:115], v[172:175], v[176:179], v[112:115]
    s_mov_b32 s69, s67
    s_mov_b32 s67, s68
    v_mfma_f32_16x16x32_bf16 v[116:119], v[172:175], v[180:183], v[116:119]
    s_mov_b32 s68, s79
    v_mfma_f32_16x16x32_bf16 v[120:123], v[172:175], v[184:187], v[120:123]
    s_mov_b32 s79, s9
    v_mfma_f32_16x16x32_bf16 v[124:127], v[172:175], v[188:191], v[124:127]
    s_mov_b32 s9, s69
    s_mov_b32 s65, 15
p2b_L1:
    s_waitcnt lgkmcnt(0)
    v_mfma_f32_16x16x32_bf16 v[64:67], v[128:131], v[144:147], v[64:67]
    ds_read_b128 v[160:163], v9 offset:0
    v_mfma_f32_16x16x32_bf16 v[68:71], v[128:131], v[148:151], v[68:71]
    ds_read_b128 v[176:179], v13 offset:0
    v_mfma_f32_16x16x32_bf16 v[72:75], v[128:131], v[152:155], v[72:75]
    ds_read_b128 v[180:183], v13 offset:2048
    v_mfma_f32_16x16x32_bf16 v[76:79], v[128:131], v[156:159], v[76:79]
    ds_read_b128 v[184:187], v13 offset:4096
    v_mfma_f32_16x16x32_bf16 v[80:83], v[132:135], v[144:147], v[80:83]
    ds_read_b128 v[188:191], v13 offset:6144
    v_mfma_f32_16x16x32_bf16 v[84:87], v[132:135], v[148:151], v[84:87]
    ds_read_b128 v[164:167], v9 offset:2048
    v_mfma_f32_16x16x32_bf16 v[88:91], v[132:135], v[152:155], v[88:91]
    ds_read_b128 v[168:171], v9 offset:4096
    v_mfma_f32_16x16x32_bf16 v[92:95], v[132:135], v[156:159], v[92:95]
    v_mfma_f32_16x16x32_bf16 v[96:99], v[136:139], v[144:147], v[96:99]
    ds_read_b128 v[172:175], v9 offset:6144
    v_mfma_f32_16x16x32_bf16 v[100:103], v[136:139], v[148:151], v[100:103]
    v_add_u32 v9, s67, v9
    v_mfma_f32_16x16x32_bf16 v[104:107], v[136:139], v[152:155], v[104:107]
    v_add_u32 v13, s67, v13
    v_mfma_f32_16x16x32_bf16 v[108:111], v[136:139], v[156:159], v[108:111]
    s_mov_b32 m0, s73
    s_add_u32 s73, s73, s9
    buffer_load_dwordx4 v20, s[52:55], s71 offen offset:0 lds
    v_mfma_f32_16x16x32_bf16 v[112:115], v[140:143], v[144:147], v[112:115]
    buffer_load_dwordx4 v21, s[52:55], s71 offen offset:1024 lds
    v_mfma_f32_16x16x32_bf16 v[116:119], v[140:143], v[148:151], v[116:119]
    buffer_load_dwordx4 v22, s[52:55], s71 offen offset:2048 lds
    v_mfma_f32_16x16x32_bf16 v[120:123], v[140:143], v[152:155], v[120:123]
    buffer_load_dwordx4 v23, s[52:55], s71 offen offset:3072 lds
    s_add_u32 s71, s71, 128
    s_and_b32 s71, s71, 0x7ff
    v_mfma_f32_16x16x32_bf16 v[124:127], v[140:143], v[156:159], v[124:127]
    s_waitcnt vmcnt(16) lgkmcnt(0)
    s_barrier
    v_mfma_f32_16x16x32_bf16 v[64:67], v[160:163], v[176:179], v[64:67]
    ds_read_b128 v[128:131], v8 offset:0
    ds_read_b128 v[144:147], v12 offset:0
    v_mfma_f32_16x16x32_bf16 v[68:71], v[160:163], v[180:183], v[68:71]
    ds_read_b128 v[148:151], v12 offset:2048
    v_mfma_f32_16x16x32_bf16 v[72:75], v[160:163], v[184:187], v[72:75]
    ds_read_b128 v[152:155], v12 offset:4096
    v_mfma_f32_16x16x32_bf16 v[76:79], v[160:163], v[188:191], v[76:79]
    ds_read_b128 v[156:159], v12 offset:6144
    v_mfma_f32_16x16x32_bf16 v[80:83], v[164:167], v[176:179], v[80:83]
    ds_read_b128 v[132:135], v8 offset:2048
    v_mfma_f32_16x16x32_bf16 v[84:87], v[164:167], v[180:183], v[84:87]
    ds_read_b128 v[136:139], v8 offset:4096
    ds_read_b128 v[140:143], v8 offset:6144
    v_mfma_f32_16x16x32_bf16 v[88:91], v[164:167], v[184:187], v[88:91]
    v_add_u32 v8, s68, v8
    v_mfma_f32_16x16x32_bf16 v[92:95], v[164:167], v[188:191], v[92:95]
    v_add_u32 v12, s68, v12
    v_mfma_f32_16x16x32_bf16 v[96:99], v[168:171], v[176:179], v[96:99]
    s_mov_b32 m0, s72
    s_add_u32 s72, s72, s67
    buffer_load_dwordx4 v16, s[48:51], s70 offen offset:0 sc1 lds
    v_mfma_f32_16x16x32_bf16 v[100:103], v[168:171], v[180:183], v[100:103]
    buffer_load_dwordx4 v17, s[48:51], s70 offen offset:1024 sc1 lds
    v_mfma_f32_16x16x32_bf16 v[104:107], v[168:171], v[184:187], v[104:107]
    buffer_load_dwordx4 v18, s[48:51], s70 offen offset:2048 sc1 lds
    buffer_load_dwordx4 v19, s[48:51], s70 offen offset:3072 sc1 lds
    s_add_u32 s70, s70, 128
    s_and_b32 s70, s70, 0x7ff
    s_or_b32 s70, s70, s10
    v_mfma_f32_16x16x32_bf16 v[108:111], v[168:171], v[188:191], v[108:111]
    s_mov_b32 s69, s67
    v_mfma_f32_16x16x32_bf16 v[112:115], v[172:175], v[176:179], v[112:115]
    s_mov_b32 s67, s68
    v_mfma_f32_16x16x32_bf16 v[116:119], v[172:175], v[180:183], v[116:119]
    s_mov_b32 s68, s79
    v_mfma_f32_16x16x32_bf16 v[120:123], v[172:175], v[184:187], v[120:123]
    s_mov_b32 s79, s9
    v_mfma_f32_16x16x32_bf16 v[124:127], v[172:175], v[188:191], v[124:127]
    s_mov_b32 s9, s69
    s_sub_u32 s65, s65, 1
    s_cmp_lg_u32 s65, 0
    s_cbranch_scc1 p2b_L1
    s_waitcnt lgkmcnt(0)
    v_mfma_f32_16x16x32_bf16 v[64:67], v[128:131], v[144:147], v[64:67]
    ds_read_b128 v[160:163], v9 offset:0
    v_mfma_f32_16x16x32_bf16 v[68:71], v[128:131], v[148:151], v[68:71]
    ds_read_b128 v[176:179], v13 offset:0
    v_mfma_f32_16x16x32_bf16 v[72:75], v[128:131], v[152:155], v[72:75]
    ds_read_b128 v[180:183], v13 offset:2048
    v_mfma_f32_16x16x32_bf16 v[76:79], v[128:131], v[156:159], v[76:79]
    ds_read_b128 v[184:187], v13 offset:4096
    v_mfma_f32_16x16x32_bf16 v[80:83], v[132:135], v[144:147], v[80:83]
    ds_read_b128 v[188:191], v13 offset:6144
    v_mfma_f32_16x16x32_bf16 v[84:87], v[132:135], v[148:151], v[84:87]
    ds_read_b128 v[164:167], v9 offset:2048
    v_mfma_f32_16x16x32_bf16 v[88:91], v[132:135], v[152:155], v[88:91]
    ds_read_b128 v[168:171], v9 offset:4096
    v_mfma_f32_16x16x32_bf16 v[92:95], v[132:135], v[156:159], v[92:95]
    v_mfma_f32_16x16x32_bf16 v[96:99], v[136:139], v[144:147], v[96:99]
    ds_read_b128 v[172:175], v9 offset:6144
    v_mfma_f32_16x16x32_bf16 v[100:103], v[136:139], v[148:151], v[100:103]
    v_add_u32 v9, s67, v9
    v_mfma_f32_16x16x32_bf16 v[104:107], v[136:139], v[152:155], v[104:107]
    v_add_u32 v13, s67, v13
    v_mfma_f32_16x16x32_bf16 v[108:111], v[136:139], v[156:159], v[108:111]
    s_mov_b32 m0, s73
    s_add_u32 s73, s73, s9
    buffer_load_dwordx4 v20, s[52:55], s71 offen offset:0 lds
    v_mfma_f32_16x16x32_bf16 v[112:115], v[140:143], v[144:147], v[112:115]
    buffer_load_dwordx4 v21, s[52:55], s71 offen offset:1024 lds
    v_mfma_f32_16x16x32_bf16 v[116:119], v[140:143], v[148:151], v[116:119]
    buffer_load_dwordx4 v22, s[52:55], s71 offen offset:2048 lds
    v_mfma_f32_16x16x32_bf16 v[120:123], v[140:143], v[152:155], v[120:123]
    buffer_load_dwordx4 v23, s[52:55], s71 offen offset:3072 lds
    s_add_u32 s71, s71, 128
    s_and_b32 s71, s71, 0x7ff
    v_mfma_f32_16x16x32_bf16 v[124:127], v[140:143], v[156:159], v[124:127]
    s_waitcnt vmcnt(16) lgkmcnt(0)
    s_barrier
    v_mfma_f32_16x16x32_bf16 v[64:67], v[160:163], v[176:179], v[64:67]
    ds_read_b128 v[128:131], v8 offset:0
    v_mfma_f32_16x16x32_bf16 v[68:71], v[160:163], v[180:183], v[68:71]
    ds_read_b128 v[144:147], v12 offset:0
    v_mfma_f32_16x16x32_bf16 v[72:75], v[160:163], v[184:187], v[72:75]
    ds_read_b128 v[148:151], v12 offset:2048
    v_mfma_f32_16x16x32_bf16 v[76:79], v[160:163], v[188:191], v[76:79]
    ds_read_b128 v[152:155], v12 offset:4096
    v_mfma_f32_16x16x32_bf16 v[80:83], v[164:167], v[176:179], v[80:83]
    ds_read_b128 v[156:159], v12 offset:6144
    v_mfma_f32_16x16x32_bf16 v[84:87], v[164:167], v[180:183], v[84:87]
    ds_read_b128 v[132:135], v8 offset:2048
    v_mfma_f32_16x16x32_bf16 v[88:91], v[164:167], v[184:187], v[88:91]
    ds_read_b128 v[136:139], v8 offset:4096
    v_mfma_f32_16x16x32_bf16 v[92:95], v[164:167], v[188:191], v[92:95]
    ds_read_b128 v[140:143], v8 offset:6144
    v_mfma_f32_16x16x32_bf16 v[96:99], v[168:171], v[176:179], v[96:99]
    v_add_u32 v8, s68, v8
    v_mfma_f32_16x16x32_bf16 v[100:103], v[168:171], v[180:183], v[100:103]
    v_add_u32 v12, s68, v12
    v_mfma_f32_16x16x32_bf16 v[104:107], v[168:171], v[184:187], v[104:107]
    s_mov_b32 s69, s67
    v_mfma_f32_16x16x32_bf16 v[108:111], v[168:171], v[188:191], v[108:111]
    s_mov_b32 s67, s68
    v_mfma_f32_16x16x32_bf16 v[112:115], v[172:175], v[176:179], v[112:115]
    s_mov_b32 s68, s79
    v_mfma_f32_16x16x32_bf16 v[116:119], v[172:175], v[180:183], v[116:119]
    s_mov_b32 s79, s9
    v_mfma_f32_16x16x32_bf16 v[120:123], v[172:175], v[184:187], v[120:123]
    s_mov_b32 s9, s69
    v_mfma_f32_16x16x32_bf16 v[124:127], v[172:175], v[188:191], v[124:127]
    s_waitcnt lgkmcnt(0)
    v_mfma_f32_16x16x32_bf16 v[64:67], v[128:131], v[144:147], v[64:67]
    ds_read_b128 v[160:163], v9 offset:0
    v_mfma_f32_16x16x32_bf16 v[68:71], v[128:131], v[148:151], v[68:71]
    ds_read_b128 v[176:179], v13 offset:0
    v_mfma_f32_16x16x32_bf16 v[72:75], v[128:131], v[152:155], v[72:75]
    v_mfma_f32_16x16x32_bf16 v[76:79], v[128:131], v[156:159], v[76:79]
    ds_read_b128 v[180:183], v13 offset:2048
    v_mfma_f32_16x16x32_bf16 v[80:83], v[132:135], v[144:147], v[80:83]
    ds_read_b128 v[184:187], v13 offset:4096
    v_mfma_f32_16x16x32_bf16 v[84:87], v[132:135], v[148:151], v[84:87]
    v_mfma_f32_16x16x32_bf16 v[88:91], v[132:135], v[152:155], v[88:91]
    ds_read_b128 v[188:191], v13 offset:6144
    v_mfma_f32_16x16x32_bf16 v[92:95], v[132:135], v[156:159], v[92:95]
    v_mfma_f32_16x16x32_bf16 v[96:99], v[136:139], v[144:147], v[96:99]
    ds_read_b128 v[164:167], v9 offset:2048
    v_mfma_f32_16x16x32_bf16 v[100:103], v[136:139], v[148:151], v[100:103]
    ds_read_b128 v[168:171], v9 offset:4096
    v_mfma_f32_16x16x32_bf16 v[104:107], v[136:139], v[152:155], v[104:107]
    v_mfma_f32_16x16x32_bf16 v[108:111], v[136:139], v[156:159], v[108:111]
    ds_read_b128 v[172:175], v9 offset:6144
    v_mfma_f32_16x16x32_bf16 v[112:115], v[140:143], v[144:147], v[112:115]
    v_add_u32 v9, s67, v9
    v_mfma_f32_16x16x32_bf16 v[116:119], v[140:143], v[148:151], v[116:119]
    v_mfma_f32_16x16x32_bf16 v[120:123], v[140:143], v[152:155], v[120:123]
    v_add_u32 v13, s67, v13
    v_mfma_f32_16x16x32_bf16 v[124:127], v[140:143], v[156:159], v[124:127]
    s_waitcnt vmcnt(8) lgkmcnt(0)
    s_barrier
    v_mfma_f32_16x16x32_bf16 v[64:67], v[160:163], v[176:179], v[64:67]
    ds_read_b128 v[128:131], v8 offset:0
    v_mfma_f32_16x16x32_bf16 v[68:71], v[160:163], v[180:183], v[68:71]
    ds_read_b128 v[144:147], v12 offset:0
    v_mfma_f32_16x16x32_bf16 v[72:75], v[160:163], v[184:187], v[72:75]
    ds_read_b128 v[148:151], v12 offset:2048
    v_mfma_f32_16x16x32_bf16 v[76:79], v[160:163], v[188:191], v[76:79]
    ds_read_b128 v[152:155], v12 offset:4096
    v_mfma_f32_16x16x32_bf16 v[80:83], v[164:167], v[176:179], v[80:83]
    ds_read_b128 v[156:159], v12 offset:6144
    v_mfma_f32_16x16x32_bf16 v[84:87], v[164:167], v[180:183], v[84:87]
    ds_read_b128 v[132:135], v8 offset:2048
    v_mfma_f32_16x16x32_bf16 v[88:91], v[164:167], v[184:187], v[88:91]
    ds_read_b128 v[136:139], v8 offset:4096
    v_mfma_f32_16x16x32_bf16 v[92:95], v[164:167], v[188:191], v[92:95]
    ds_read_b128 v[140:143], v8 offset:6144
    v_mfma_f32_16x16x32_bf16 v[96:99], v[168:171], v[176:179], v[96:99]
    v_add_u32 v8, s68, v8
    v_mfma_f32_16x16x32_bf16 v[100:103], v[168:171], v[180:183], v[100:103]
    v_add_u32 v12, s68, v12
    v_mfma_f32_16x16x32_bf16 v[104:107], v[168:171], v[184:187], v[104:107]
    s_mov_b32 s69, s67
    v_mfma_f32_16x16x32_bf16 v[108:111], v[168:171], v[188:191], v[108:111]
    s_mov_b32 s67, s68
    v_mfma_f32_16x16x32_bf16 v[112:115], v[172:175], v[176:179], v[112:115]
    s_mov_b32 s68, s79
    v_mfma_f32_16x16x32_bf16 v[116:119], v[172:175], v[180:183], v[116:119]
    s_mov_b32 s79, s9
    v_mfma_f32_16x16x32_bf16 v[120:123], v[172:175], v[184:187], v[120:123]
    s_mov_b32 s9, s69
    v_mfma_f32_16x16x32_bf16 v[124:127], v[172:175], v[188:191], v[124:127]
    s_waitcnt lgkmcnt(0)
    v_mfma_f32_16x16x32_bf16 v[64:67], v[128:131], v[144:147], v[64:67]
    ds_read_b128 v[160:163], v9 offset:0
    v_mfma_f32_16x16x32_bf16 v[68:71], v[128:131], v[148:151], v[68:71]
    ds_read_b128 v[176:179], v13 offset:0
    v_mfma_f32_16x16x32_bf16 v[72:75], v[128:131], v[152:155], v[72:75]
    v_mfma_f32_16x16x32_bf16 v[76:79], v[128:131], v[156:159], v[76:79]
    ds_read_b128 v[180:183], v13 offset:2048
    v_mfma_f32_16x16x32_bf16 v[80:83], v[132:135], v[144:147], v[80:83]
    ds_read_b128 v[184:187], v13 offset:4096
    v_mfma_f32_16x16x32_bf16 v[84:87], v[132:135], v[148:151], v[84:87]
    v_mfma_f32_16x16x32_bf16 v[88:91], v[132:135], v[152:155], v[88:91]
    ds_read_b128 v[188:191], v13 offset:6144
    v_mfma_f32_16x16x32_bf16 v[92:95], v[132:135], v[156:159], v[92:95]
    v_mfma_f32_16x16x32_bf16 v[96:99], v[136:139], v[144:147], v[96:99]
    ds_read_b128 v[164:167], v9 offset:2048
    v_mfma_f32_16x16x32_bf16 v[100:103], v[136:139], v[148:151], v[100:103]
    ds_read_b128 v[168:171], v9 offset:4096
    v_mfma_f32_16x16x32_bf16 v[104:107], v[136:139], v[152:155], v[104:107]
    v_mfma_f32_16x16x32_bf16 v[108:111], v[136:139], v[156:159], v[108:111]
    ds_read_b128 v[172:175], v9 offset:6144
    v_mfma_f32_16x16x32_bf16 v[112:115], v[140:143], v[144:147], v[112:115]
    v_add_u32 v9, s67, v9
    v_mfma_f32_16x16x32_bf16 v[116:119], v[140:143], v[148:151], v[116:119]
    v_mfma_f32_16x16x32_bf16 v[120:123], v[140:143], v[152:155], v[120:123]
    v_add_u32 v13, s67, v13
    v_mfma_f32_16x16x32_bf16 v[124:127], v[140:143], v[156:159], v[124:127]
    s_waitcnt vmcnt(0) lgkmcnt(0)
    s_barrier
    v_mfma_f32_16x16x32_bf16 v[64:67], v[160:163], v[176:179], v[64:67]
    ds_read_b128 v[128:131], v8 offset:0
    v_mfma_f32_16x16x32_bf16 v[68:71], v[160:163], v[180:183], v[68:71]
    ds_read_b128 v[144:147], v12 offset:0
    v_mfma_f32_16x16x32_bf16 v[72:75], v[160:163], v[184:187], v[72:75]
    ds_read_b128 v[148:151], v12 offset:2048
    v_mfma_f32_16x16x32_bf16 v[76:79], v[160:163], v[188:191], v[76:79]
    ds_read_b128 v[152:155], v12 offset:4096
    v_mfma_f32_16x16x32_bf16 v[80:83], v[164:167], v[176:179], v[80:83]
    ds_read_b128 v[156:159], v12 offset:6144
    v_mfma_f32_16x16x32_bf16 v[84:87], v[164:167], v[180:183], v[84:87]
    ds_read_b128 v[132:135], v8 offset:2048
    v_mfma_f32_16x16x32_bf16 v[88:91], v[164:167], v[184:187], v[88:91]
    ds_read_b128 v[136:139], v8 offset:4096
    v_mfma_f32_16x16x32_bf16 v[92:95], v[164:167], v[188:191], v[92:95]
    ds_read_b128 v[140:143], v8 offset:6144
    v_mfma_f32_16x16x32_bf16 v[96:99], v[168:171], v[176:179], v[96:99]
    v_add_u32 v8, s68, v8
    v_mfma_f32_16x16x32_bf16 v[100:103], v[168:171], v[180:183], v[100:103]
    v_add_u32 v12, s68, v12
    v_mfma_f32_16x16x32_bf16 v[104:107], v[168:171], v[184:187], v[104:107]
    s_mov_b32 s69, s67
    v_mfma_f32_16x16x32_bf16 v[108:111], v[168:171], v[188:191], v[108:111]
    s_mov_b32 s67, s68
    v_mfma_f32_16x16x32_bf16 v[112:115], v[172:175], v[176:179], v[112:115]
    s_mov_b32 s68, s79
    v_mfma_f32_16x16x32_bf16 v[116:119], v[172:175], v[180:183], v[116:119]
    s_mov_b32 s79, s9
    v_mfma_f32_16x16x32_bf16 v[120:123], v[172:175], v[184:187], v[120:123]
    s_mov_b32 s9, s69
    v_mfma_f32_16x16x32_bf16 v[124:127], v[172:175], v[188:191], v[124:127]
    s_waitcnt lgkmcnt(0)
    v_mfma_f32_16x16x32_bf16 v[64:67], v[128:131], v[144:147], v[64:67]
    ds_read_b128 v[160:163], v9 offset:0
    v_mfma_f32_16x16x32_bf16 v[68:71], v[128:131], v[148:151], v[68:71]
    ds_read_b128 v[176:179], v13 offset:0
    v_mfma_f32_16x16x32_bf16 v[72:75], v[128:131], v[152:155], v[72:75]
    v_mfma_f32_16x16x32_bf16 v[76:79], v[128:131], v[156:159], v[76:79]
    ds_read_b128 v[180:183], v13 offset:2048
    v_mfma_f32_16x16x32_bf16 v[80:83], v[132:135], v[144:147], v[80:83]
    ds_read_b128 v[184:187], v13 offset:4096
    v_mfma_f32_16x16x32_bf16 v[84:87], v[132:135], v[148:151], v[84:87]
    v_mfma_f32_16x16x32_bf16 v[88:91], v[132:135], v[152:155], v[88:91]
    ds_read_b128 v[188:191], v13 offset:6144
    v_mfma_f32_16x16x32_bf16 v[92:95], v[132:135], v[156:159], v[92:95]
    v_mfma_f32_16x16x32_bf16 v[96:99], v[136:139], v[144:147], v[96:99]
    ds_read_b128 v[164:167], v9 offset:2048
    v_mfma_f32_16x16x32_bf16 v[100:103], v[136:139], v[148:151], v[100:103]
    ds_read_b128 v[168:171], v9 offset:4096
    v_mfma_f32_16x16x32_bf16 v[104:107], v[136:139], v[152:155], v[104:107]
    v_mfma_f32_16x16x32_bf16 v[108:111], v[136:139], v[156:159], v[108:111]
    ds_read_b128 v[172:175], v9 offset:6144
    v_mfma_f32_16x16x32_bf16 v[112:115], v[140:143], v[144:147], v[112:115]
    v_add_u32 v9, s67, v9
    v_mfma_f32_16x16x32_bf16 v[116:119], v[140:143], v[148:151], v[116:119]
    v_mfma_f32_16x16x32_bf16 v[120:123], v[140:143], v[152:155], v[120:123]
    v_add_u32 v13, s67, v13
    v_mfma_f32_16x16x32_bf16 v[124:127], v[140:143], v[156:159], v[124:127]
    s_waitcnt lgkmcnt(0)
    v_mfma_f32_16x16x32_bf16 v[64:67], v[160:163], v[176:179], v[64:67]
    v_mfma_f32_16x16x32_bf16 v[68:71], v[160:163], v[180:183], v[68:71]
    v_mfma_f32_16x16x32_bf16 v[72:75], v[160:163], v[184:187], v[72:75]
    v_mfma_f32_16x16x32_bf16 v[76:79], v[160:163], v[188:191], v[76:79]
    v_mfma_f32_16x16x32_bf16 v[80:83], v[164:167], v[176:179], v[80:83]
    v_mfma_f32_16x16x32_bf16 v[84:87], v[164:167], v[180:183], v[84:87]
    v_mfma_f32_16x16x32_bf16 v[88:91], v[164:167], v[184:187], v[88:91]
    v_mfma_f32_16x16x32_bf16 v[92:95], v[164:167], v[188:191], v[92:95]
    v_mfma_f32_16x16x32_bf16 v[96:99], v[168:171], v[176:179], v[96:99]
    v_mfma_f32_16x16x32_bf16 v[100:103], v[168:171], v[180:183], v[100:103]
    v_mfma_f32_16x16x32_bf16 v[104:107], v[168:171], v[184:187], v[104:107]
    v_mfma_f32_16x16x32_bf16 v[108:111], v[168:171], v[188:191], v[108:111]
    v_mfma_f32_16x16x32_bf16 v[112:115], v[172:175], v[176:179], v[112:115]
    v_mfma_f32_16x16x32_bf16 v[116:119], v[172:175], v[180:183], v[116:119]
    v_mfma_f32_16x16x32_bf16 v[120:123], v[172:175], v[184:187], v[120:123]
    v_mfma_f32_16x16x32_bf16 v[124:127], v[172:175], v[188:191], v[124:127]
    v_add_u32 v24, 0x1000, v24
    v_lshlrev_b32 v28, 16, v32
    v_and_b32 v29, 0xffff0000, v32
    v_lshlrev_b32 v30, 16, v33
    v_and_b32 v31, 0xffff0000, v33
    ds_write_b32 v26, v64 offset:0
    ds_write_b32 v26, v65 offset:256
    ds_write_b32 v26, v66 offset:512
    ds_write_b32 v26, v67 offset:768
    ds_write_b32 v26, v68 offset:64
    ds_write_b32 v26, v69 offset:320
    ds_write_b32 v26, v70 offset:576
    ds_write_b32 v26, v71 offset:832
    ds_write_b32 v26, v72 offset:128
    ds_write_b32 v26, v73 offset:384
    ds_write_b32 v26, v74 offset:640
    ds_write_b32 v26, v75 offset:896
    ds_write_b32 v26, v76 offset:192
    ds_write_b32 v26, v77 offset:448
    ds_write_b32 v26, v78 offset:704
    ds_write_b32 v26, v79 offset:960
    ds_write_b32 v26, v80 offset:4096
    ds_write_b32 v26, v81 offset:4352
    ds_write_b32 v26, v82 offset:4608
    ds_write_b32 v26, v83 offset:4864
    ds_write_b32 v26, v84 offset:4160
    ds_write_b32 v26, v85 offset:4416
    ds_write_b32 v26, v86 offset:4672
    ds_write_b32 v26, v87 offset:4928
    ds_write_b32 v26, v88 offset:4224
    ds_write_b32 v26, v89 offset:4480
    ds_write_b32 v26, v90 offset:4736
    ds_write_b32 v26, v91 offset:4992
    ds_write_b32 v26, v92 offset:4288
    ds_write_b32 v26, v93 offset:4544
    ds_write_b32 v26, v94 offset:4800
    ds_write_b32 v26, v95 offset:5056
    ds_write_b32 v26, v96 offset:8192
    ds_write_b32 v26, v97 offset:8448
    ds_write_b32 v26, v98 offset:8704
    ds_write_b32 v26, v99 offset:8960
    ds_write_b32 v26, v100 offset:8256
    ds_write_b32 v26, v101 offset:8512
    ds_write_b32 v26, v102 offset:8768
    ds_write_b32 v26, v103 offset:9024
    ds_write_b32 v26, v104 offset:8320
    ds_write_b32 v26, v105 offset:8576
    ds_write_b32 v26, v106 offset:8832
    ds_write_b32 v26, v107 offset:9088
    ds_write_b32 v26, v108 offset:8384
    ds_write_b32 v26, v109 offset:8640
    ds_write_b32 v26, v110 offset:8896
    ds_write_b32 v26, v111 offset:9152
    ds_write_b32 v26, v112 offset:12288
    ds_write_b32 v26, v113 offset:12544
    ds_write_b32 v26, v114 offset:12800
    ds_write_b32 v26, v115 offset:13056
    ds_write_b32 v26, v116 offset:12352
    ds_write_b32 v26, v117 offset:12608
    ds_write_b32 v26, v118 offset:12864
    ds_write_b32 v26, v119 offset:13120
    ds_write_b32 v26, v120 offset:12416
    ds_write_b32 v26, v121 offset:12672
    ds_write_b32 v26, v122 offset:12928
    ds_write_b32 v26, v123 offset:13184
    ds_write_b32 v26, v124 offset:12480
    ds_write_b32 v26, v125 offset:12736
    ds_write_b32 v26, v126 offset:12992
    ds_write_b32 v26, v127 offset:13248
    s_waitcnt lgkmcnt(0)
    ds_read_b128 v[128:131], v27 offset:0
    ds_read_b128 v[132:135], v27 offset:1024
    ds_read_b128 v[136:139], v27 offset:2048
    ds_read_b128 v[140:143], v27 offset:3072
    ds_read_b128 v[144:147], v27 offset:4096
    ds_read_b128 v[148:151], v27 offset:5120
    ds_read_b128 v[152:155], v27 offset:6144
    ds_read_b128 v[156:159], v27 offset:7168
    ds_read_b128 v[160:163], v27 offset:8192
    ds_read_b128 v[164:167], v27 offset:9216
    ds_read_b128 v[168:171], v27 offset:10240
    ds_read_b128 v[172:175], v27 offset:11264
    ds_read_b128 v[176:179], v27 offset:12288
    ds_read_b128 v[180:183], v27 offset:13312
    ds_read_b128 v[184:187], v27 offset:14336
    ds_read_b128 v[188:191], v27 offset:15360
    v_lshlrev_b32 v64, 16, v192
    v_and_b32 v65, 0xffff0000, v192
    v_lshlrev_b32 v66, 16, v193
    v_and_b32 v67, 0xffff0000, v193
    s_mov_b32 s78, 0x0
    s_waitcnt lgkmcnt(15)
    v_pk_fma_f32 v[128:129], v[64:65], v[28:29], v[128:129]
    v_pk_fma_f32 v[130:131], v[66:67], v[30:31], v[130:131]
    buffer_store_dwordx4 v[128:131], v24, s[56:59], s78 offen
    v_lshlrev_b32 v68, 16, v194
    v_and_b32 v69, 0xffff0000, v194
    v_lshlrev_b32 v70, 16, v195
    v_and_b32 v71, 0xffff0000, v195
    s_mov_b32 s78, 0x8000
    s_waitcnt lgkmcnt(14)
    v_pk_fma_f32 v[132:133], v[68:69], v[28:29], v[132:133]
    v_pk_fma_f32 v[134:135], v[70:71], v[30:31], v[134:135]
    buffer_store_dwordx4 v[132:135], v24, s[56:59], s78 offen
    v_lshlrev_b32 v72, 16, v196
    v_and_b32 v73, 0xffff0000, v196
    v_lshlrev_b32 v74, 16, v197
    v_and_b32 v75, 0xffff0000, v197
    s_mov_b32 s78, 0x10000
    s_waitcnt lgkmcnt(13)
    v_pk_fma_f32 v[136:137], v[72:73], v[28:29], v[136:137]
    v_pk_fma_f32 v[138:139], v[74:75], v[30:31], v[138:139]
    buffer_store_dwordx4 v[136:139], v24, s[56:59], s78 offen
    v_lshlrev_b32 v76, 16, v198
    v_and_b32 v77, 0xffff0000, v198
    v_lshlrev_b32 v78, 16, v199
    v_and_b32 v79, 0xffff0000, v199
    s_mov_b32 s78, 0x18000
    s_waitcnt lgkmcnt(12)
    v_pk_fma_f32 v[140:141], v[76:77], v[28:29], v[140:141]
    v_pk_fma_f32 v[142:143], v[78:79], v[30:31], v[142:143]
    buffer_store_dwordx4 v[140:143], v24, s[56:59], s78 offen
    v_lshlrev_b32 v64, 16, v200
    v_and_b32 v65, 0xffff0000, v200
    v_lshlrev_b32 v66, 16, v201
    v_and_b32 v67, 0xffff0000, v201
    s_mov_b32 s78, 0x20000
    s_waitcnt lgkmcnt(11)
    v_pk_fma_f32 v[144:145], v[64:65], v[28:29], v[144:145]
    v_pk_fma_f32 v[146:147], v[66:67], v[30:31], v[146:147]
    buffer_store_dwordx4 v[144:147], v24, s[56:59], s78 offen
    v_lshlrev_b32 v68, 16, v202
    v_and_b32 v69, 0xffff0000, v202
    v_lshlrev_b32 v70, 16, v203
    v_and_b32 v71, 0xffff0000, v203
    s_mov_b32 s78, 0x28000
    s_waitcnt lgkmcnt(10)
    v_pk_fma_f32 v[148:149], v[68:69], v[28:29], v[148:149]
    v_pk_fma_f32 v[150:151], v[70:71], v[30:31], v[150:151]
    buffer_store_dwordx4 v[148:151], v24, s[56:59], s78 offen
    v_lshlrev_b32 v72, 16, v204
    v_and_b32 v73, 0xffff0000, v204
    v_lshlrev_b32 v74, 16, v205
    v_and_b32 v75, 0xffff0000, v205
    s_mov_b32 s78, 0x30000
    s_waitcnt lgkmcnt(9)
    v_pk_fma_f32 v[152:153], v[72:73], v[28:29], v[152:153]
    v_pk_fma_f32 v[154:155], v[74:75], v[30:31], v[154:155]
    buffer_store_dwordx4 v[152:155], v24, s[56:59], s78 offen
    v_lshlrev_b32 v76, 16, v206
    v_and_b32 v77, 0xffff0000, v206
    v_lshlrev_b32 v78, 16, v207
    v_and_b32 v79, 0xffff0000, v207
    s_mov_b32 s78, 0x38000
    s_waitcnt lgkmcnt(8)
    v_pk_fma_f32 v[156:157], v[76:77], v[28:29], v[156:157]
    v_pk_fma_f32 v[158:159], v[78:79], v[30:31], v[158:159]
    buffer_store_dwordx4 v[156:159], v24, s[56:59], s78 offen
    v_lshlrev_b32 v64, 16, v208
    v_and_b32 v65, 0xffff0000, v208
    v_lshlrev_b32 v66, 16, v209
    v_and_b32 v67, 0xffff0000, v209
    s_mov_b32 s78, 0x40000
    s_waitcnt lgkmcnt(7)
    v_pk_fma_f32 v[160:161], v[64:65], v[28:29], v[160:161]
    v_pk_fma_f32 v[162:163], v[66:67], v[30:31], v[162:163]
    buffer_store_dwordx4 v[160:163], v24, s[56:59], s78 offen
    v_lshlrev_b32 v68, 16, v210
    v_and_b32 v69, 0xffff0000, v210
    v_lshlrev_b32 v70, 16, v211
    v_and_b32 v71, 0xffff0000, v211
    s_mov_b32 s78, 0x48000
    s_waitcnt lgkmcnt(6)
    v_pk_fma_f32 v[164:165], v[68:69], v[28:29], v[164:165]
    v_pk_fma_f32 v[166:167], v[70:71], v[30:31], v[166:167]
    buffer_store_dwordx4 v[164:167], v24, s[56:59], s78 offen
    v_lshlrev_b32 v72, 16, v212
    v_and_b32 v73, 0xffff0000, v212
    v_lshlrev_b32 v74, 16, v213
    v_and_b32 v75, 0xffff0000, v213
    s_mov_b32 s78, 0x50000
    s_waitcnt lgkmcnt(5)
    v_pk_fma_f32 v[168:169], v[72:73], v[28:29], v[168:169]
    v_pk_fma_f32 v[170:171], v[74:75], v[30:31], v[170:171]
    buffer_store_dwordx4 v[168:171], v24, s[56:59], s78 offen
    v_lshlrev_b32 v76, 16, v214
    v_and_b32 v77, 0xffff0000, v214
    v_lshlrev_b32 v78, 16, v215
    v_and_b32 v79, 0xffff0000, v215
    s_mov_b32 s78, 0x58000
    s_waitcnt lgkmcnt(4)
    v_pk_fma_f32 v[172:173], v[76:77], v[28:29], v[172:173]
    v_pk_fma_f32 v[174:175], v[78:79], v[30:31], v[174:175]
    buffer_store_dwordx4 v[172:175], v24, s[56:59], s78 offen
    v_lshlrev_b32 v64, 16, v216
    v_and_b32 v65, 0xffff0000, v216
    v_lshlrev_b32 v66, 16, v217
    v_and_b32 v67, 0xffff0000, v217
    s_mov_b32 s78, 0x60000
    s_waitcnt lgkmcnt(3)
    v_pk_fma_f32 v[176:177], v[64:65], v[28:29], v[176:177]
    v_pk_fma_f32 v[178:179], v[66:67], v[30:31], v[178:179]
    buffer_store_dwordx4 v[176:179], v24, s[56:59], s78 offen
    v_lshlrev_b32 v68, 16, v218
    v_and_b32 v69, 0xffff0000, v218
    v_lshlrev_b32 v70, 16, v219
    v_and_b32 v71, 0xffff0000, v219
    s_mov_b32 s78, 0x68000
    s_waitcnt lgkmcnt(2)
    v_pk_fma_f32 v[180:181], v[68:69], v[28:29], v[180:181]
    v_pk_fma_f32 v[182:183], v[70:71], v[30:31], v[182:183]
    buffer_store_dwordx4 v[180:183], v24, s[56:59], s78 offen
    v_lshlrev_b32 v72, 16, v220
    v_and_b32 v73, 0xffff0000, v220
    v_lshlrev_b32 v74, 16, v221
    v_and_b32 v75, 0xffff0000, v221
    s_mov_b32 s78, 0x70000
    s_waitcnt lgkmcnt(1)
    v_pk_fma_f32 v[184:185], v[72:73], v[28:29], v[184:185]
    v_pk_fma_f32 v[186:187], v[74:75], v[30:31], v[186:187]
    buffer_store_dwordx4 v[184:187], v24, s[56:59], s78 offen
    v_lshlrev_b32 v76, 16, v222
    v_and_b32 v77, 0xffff0000, v222
    v_lshlrev_b32 v78, 16, v223
    v_and_b32 v79, 0xffff0000, v223
    s_mov_b32 s78, 0x78000
    s_waitcnt lgkmcnt(0)
    v_pk_fma_f32 v[188:189], v[76:77], v[28:29], v[188:189]
    v_pk_fma_f32 v[190:191], v[78:79], v[30:31], v[190:191]
    buffer_store_dwordx4 v[188:191], v24, s[56:59], s78 offen
    s_endpgm
concat_heads__linear_kernel_hedgehog__ssm_conv_s5__prompt_kernel_exit:
    s_endpgm
.section .rodata,"a"
.p2align 6
.amdhsa_kernel concat_heads__linear_kernel_hedgehog__ssm_conv_s5__prompt_kernel
  .amdhsa_next_free_vgpr 256
  .amdhsa_next_free_sgpr 102
  .amdhsa_accum_offset 256
  .amdhsa_group_segment_fixed_size 0
  .amdhsa_kernarg_size 128
  .amdhsa_user_sgpr_count 2
  .amdhsa_user_sgpr_kernarg_segment_ptr 1
  .amdhsa_system_sgpr_workgroup_id_x 1
.end_amdhsa_kernel
```
